```python
import torch

def _softmax(x, axis=-1):
    return torch.softmax(x, dim=axis)
def _gelu(x):
    return torch.nn.functional.gelu(x, approximate="tanh")
def _silu(x):
    return torch.nn.functional.silu(x)
def _sigmoid(x):
    return torch.sigmoid(x)
def _layernorm(x, axis=-1, eps=1e-5):
    m = x.mean(dim=axis, keepdim=True)
    v = x.var(dim=axis, keepdim=True, unbiased=False)
    return (x - m) / torch.sqrt(v + eps)
def _scatter_add(tgt, idx, src, axis=0):
    return tgt.clone().index_add_(axis, idx, src)
def _segment_sum(src, seg, n):
    out = torch.zeros((n,) + src.shape[1:], dtype=src.dtype)
    return out.index_add_(0, seg, src)
def _pad(x, pw):
    flat = tuple(v for pair in reversed(pw) for v in pair)
    return torch.nn.functional.pad(x, flat)

kernel_name = 'parallel_sum__spectral_gfnet__glu_gated_reglu__prompt'

def setup_inputs():

    _w = (lambda a: (lambda t: t.to(torch.bfloat16) if t.is_floating_point() else t)(torch.as_tensor(a)))
    def _A_setup():
        B, S, D = 1, 2048, 448
        Df = D // 2 + 1
        return {
            "x": _w((lambda *s: torch.randn(*s, dtype=torch.bfloat16) * 0.05)(B, S, D)),
            "w_r": _w((lambda *s: torch.randn(*s, dtype=torch.bfloat16) * 0.4)(S, Df) * 0.02),
            "w_i": _w((lambda *s: torch.randn(*s, dtype=torch.bfloat16) * 0.4)(S, Df) * 0.02),
        }
    _A_in = _A_setup()

    def _B_setup():
        B, S, D, F = 1, 2048, 448, 1792
        return {
            "x": _w((lambda *s: torch.randn(*s, dtype=torch.bfloat16) * 0.05)(B, S, D)),
            "W_gate": _w((lambda *s: torch.randn(*s, dtype=torch.bfloat16) * 0.2)(D, F) * (2.0 / D) ** 0.5),
            "W_up": _w((lambda *s: torch.randn(*s, dtype=torch.bfloat16) * 0.2)(D, F) * (2.0 / D) ** 0.5),
            "W_down": _w((lambda *s: torch.randn(*s, dtype=torch.bfloat16) * 0.2)(F, D) * (1.0 / F) ** 0.5),
        }
    _B_in = _B_setup()

    return {
        "A_x": _A_in["x"],
        "A_w_r": _A_in["w_r"],
        "A_w_i": _A_in["w_i"],
        "B_x": _B_in["x"],
        "B_W_gate": _B_in["W_gate"],
        "B_W_up": _B_in["W_up"],
        "B_W_down": _B_in["W_down"],
    }

def reference(A_x, A_w_r, A_w_i, B_x, B_W_gate, B_W_up, B_W_down):
    def _A_ref(x, w_r, w_i):
        B, S, D = x.shape
        X = (lambda x, axes=(-2,-1): torch.fft.rfft2(x.float(), dim=axes))(x, axes=(-2, -1))
        W = w_r + 1j * w_i
        X = X * W
        y = (lambda x, s, axes=(-2,-1): torch.fft.irfft2(x, s=s, dim=axes).to(torch.bfloat16))(X, (S, D), axes=(-2, -1))
        return y

    def _B_ref(x, W_gate, W_up, W_down):
        gate = torch.einsum("bsd,df->bsf", x, W_gate)
        up = torch.einsum("bsd,df->bsf", x, W_up)
        gate = gate * (lambda x, dt: x.to(dt))(gate > 0, gate.dtype)
        h = gate * up
        return torch.einsum("bsf,fd->bsd", h, W_down)

    x = A_x
    xn = _layernorm(x, axis=-1)
    return x + _A_ref(xn, A_w_r, A_w_i) + _B_ref(xn, B_W_gate, B_W_up, B_W_down)
```

```asm
; @launch kernel=k1_kernel grid=(256,1,1) block=(512,1,1) lds=163840
.amdgcn_target "amdgcn-amd-amdhsa--gfx950"
.text
.p2align 8
k1_kernel:
    s_cmp_ge_u32 s2, 0x100
    s_cbranch_scc1 K_END
    s_load_dwordx4 s[4:7], s[0:1], 0
    s_load_dwordx2 s[8:9], s[0:1], 16
    s_load_dwordx4 s[12:15], s[0:1], 32
    s_load_dwordx8 s[16:23], s[0:1], 48
    v_and_b32 v1, 63, v0
    v_lshrrev_b32 v12, 6, v0
    s_nop 0
    v_readfirstlane_b32 s3, v12
    s_getpc_b64 s[36:37]
    s_add_u32 s36, s36, k1_kernel@rel32@lo+4
    s_addc_u32 s37, s37, k1_kernel@rel32@hi+12
    s_mov_b32 s38, K_CEND-k1_kernel
    s_mov_b32 s39, 0x20000
    v_lshlrev_b32 v13, 7, v0
    buffer_load_dword v96, v13, s[36:39], 0 offen
    s_and_b32 s52, s2, 7
    s_bfe_u32 s53, s2, 0x20003
    s_lshr_b32 s54, s2, 5
    s_and_b32 s55, s52, 1
    s_lshl_b32 s55, s55, 2
    s_add_u32 s55, s55, s53
    s_mov_b32 s66, 0
    v_lshlrev_b32 v3, 4, v1
    s_getpc_b64 s[10:11]
    s_add_u32 s10, s10, TABS@rel32@lo+4
    s_addc_u32 s11, s11, TABS@rel32@hi+12
    s_mov_b32 s48, s10
    s_mov_b32 s49, s11
    s_mov_b32 s50, 0xcd700
    s_mov_b32 s51, 0x20000
    s_and_b32 s57, s3, 3
    s_lshl_b32 s58, s57, 11
    s_cmp_eq_u32 s54, 0
    s_cbranch_scc1 K_AUX
    s_sub_u32 s54, s54, 1
    s_lshr_b32 s59, s52, 1
    s_mul_i32 s56, s59, 7
    s_add_u32 s56, s56, s54
    s_lshl_b32 s67, s54, 1
    s_mul_i32 s59, s53, 5
    s_add_u32 s67, s67, s59
    s_sub_u32 s59, s67, 20
    s_cmp_ge_u32 s67, 20
    s_cselect_b32 s67, s59, s67
    s_mul_i32 s59, s53, 2
    s_add_u32 s10, s54, s59
    s_sub_u32 s59, s10, 8
    s_cmp_ge_u32 s10, 8
    s_cselect_b32 s10, s59, s10
    s_cmp_ge_u32 s3, 4
    s_cbranch_scc1 K_HELP
    v_bfe_u32 v13, v1, 2, 2
    v_bfe_u32 v4, v1, 4, 1
    v_lshlrev_b32 v4, 5, v4
    v_and_b32 v12, 3, v1
    v_lshl_add_u32 v4, v12, 3, v4
    v_lshl_add_u32 v4, v13, 7, v4
    v_lshrrev_b32 v13, 1, v13
    v_lshl_add_u32 v4, v13, 6, v4
    v_lshrrev_b32 v12, 5, v1
    v_lshl_add_u32 v4, v12, 10, v4
    v_add_u32 v4, 0x8000, v4
    v_xor_b32 v5, 64, v4
    v_and_b32 v12, 31, v1
    v_lshrrev_b32 v13, 5, v1
    v_bfe_u32 v14, v1, 1, 3
    v_xor_b32 v13, v13, v14
    v_lshlrev_b32 v13, 4, v13
    v_lshl_add_u32 v12, v12, 7, v13
    s_lshl_b32 s59, s3, 13
    v_add_u32 v6, s59, v12
    v_xor_b32 v7, 32, v6
    v_xor_b32 v8, 64, v6
    v_xor_b32 v9, 0x60, v6
    v_lshrrev_b32 v12, 3, v1
    v_and_b32 v13, 7, v1
    v_lshlrev_b32 v0, 1, v12
    v_and_b32 v0, 4, v0
    v_xor_b32 v13, v13, v0
    v_lshlrev_b32 v13, 4, v13
    v_mul_u32_u24 v0, 0x380, v12
    s_lshl_b32 s59, s54, 7
    v_add3_u32 v0, v0, s59, v13
    v_mov_b32 v12, 0
    v_lshlrev_b32 v13, 2, v1
    v_add_u32 v13, 0x27c00, v13
    ds_write_b32 v13, v12
    s_waitcnt lgkmcnt(0)
    s_mov_b32 s24, s4
    s_mov_b32 s25, s5
    s_mov_b32 s26, 0x1c0000
    s_mov_b32 s27, 0x20000
    s_mov_b32 s44, s22
    s_mov_b32 s45, s23
    s_mov_b32 s46, 0x1000000
    s_mov_b32 s47, 0x20000
    s_mov_b32 s40, s16
    s_mov_b32 s41, s17
    s_mov_b32 s42, 0x188000
    s_mov_b32 s43, 0x20000
    s_mov_b32 s28, s18
    s_mov_b32 s29, s19
    s_mov_b32 s30, 0x1c0000
    s_mov_b32 s31, 0x20000
    s_lshl_b32 s59, s53, 2
    s_add_u32 s59, s59, s3
    s_mul_i32 s59, s59, 0x70
    v_min_u32 v12, 27, v1
    v_add_u32 v12, s59, v12
    v_mul_u32_u24 v12, 0x380, v12
    s_lshl_b32 s60, s54, 7
    v_add_u32 v99, s60, v12
    v_lshrrev_b32 v12, 3, v1
    v_and_b32 v13, 7, v1
    v_lshlrev_b32 v13, 4, v13
    v_lshl_add_u32 v12, v12, 13, v13
    s_and_b32 s60, s55, 1
    s_lshl_b32 s61, s56, 1
    s_add_u32 s61, s61, s60
    s_cmp_eq_u32 s61, 1
    s_cselect_b32 vcc_lo, 0xff, 0
    s_mov_b32 vcc_hi, 0
    v_add_u32 v13, 0x1bff80, v12
    v_cndmask_b32 v12, v12, v13, vcc
    s_lshl_b32 s60, s60, 7
    s_lshl_b32 s59, s56, 16
    s_add_u32 s59, s59, s60
    s_lshr_b32 s60, s55, 1
    s_lshl_b32 s60, s60, 11
    s_add_u32 s59, s59, s60
    s_lshl_b32 s60, s3, 9
    s_add_u32 s59, s59, s60
    s_add_u32 s59, s59, 0xc00000
    v_mov_b32 v104, -1
    v_mov_b32 v105, -1
    v_mov_b32 v106, -1
    v_mov_b32 v107, -1
    buffer_store_dwordx4 v[104:107], v12, s[44:47], s59 offen sc1
    buffer_store_dwordx4 v[104:107], v12, s[44:47], s59 offen offset:256 sc1
    s_lshl_b32 s4, s55, 2
    s_add_u32 s4, s4, s3
    s_mul_i32 s4, s4, 0xe0
    s_lshl_b32 s59, s56, 2
    s_add_u32 s4, s4, s59
    s_lshl_b32 s4, s4, 10
    s_lshl_b32 s59, s57, 2
    s_add_u32 s59, s59, 0x27c00
    v_mov_b32 v94, s59
    v_and_b32 v95, 3, v1
    v_lshlrev_b32 v95, 2, v95
    v_add_u32 v95, 0x27c00, v95
    s_barrier
    s_waitcnt vmcnt(2)
    s_mov_b32 s59, 0
    s_branch CW0_P0
CW0_P:
    s_sleep 1
CW0_P0:
    ds_read_b32 v92, v95 offset:48
    s_add_u32 s59, s59, 1
    s_waitcnt lgkmcnt(0)
    v_cmp_gt_u32 vcc, 1, v92
    s_cmp_ge_u32 s59, 0x8000
    s_cbranch_scc1 CW0_G
    s_nop 2
    s_cbranch_vccnz CW0_P
CW0_G:
    ds_read_b128 v[48:51], v6
    ds_read_b128 v[52:55], v6 offset:4096
    ds_read_b64_tr_b16 v[16:17], v4
    ds_read_b64_tr_b16 v[18:19], v4 offset:512
    ds_read_b64_tr_b16 v[20:21], v5
    ds_read_b64_tr_b16 v[22:23], v5 offset:512
    ds_read_b64_tr_b16 v[24:25], v4 offset:8192
    ds_read_b64_tr_b16 v[26:27], v4 offset:8704
    ds_read_b64_tr_b16 v[28:29], v5 offset:8192
    ds_read_b64_tr_b16 v[30:31], v5 offset:8704
    ds_read_b128 v[56:59], v7
    ds_read_b128 v[60:63], v7 offset:4096
    s_waitcnt lgkmcnt(8)
    v_mfma_f32_32x32x16_bf16 v[128:143], v[16:19], v[48:51], 0
    ds_read_b64_tr_b16 v[32:33], v4 offset:2048
    ds_read_b64_tr_b16 v[34:35], v4 offset:2560
    v_mfma_f32_32x32x16_bf16 v[192:207], v[16:19], v[52:55], 0
    ds_read_b64_tr_b16 v[36:37], v5 offset:2048
    s_waitcnt lgkmcnt(9)
    v_mfma_f32_32x32x16_bf16 v[144:159], v[20:23], v[48:51], 0
    ds_read_b64_tr_b16 v[38:39], v5 offset:2560
    v_mfma_f32_32x32x16_bf16 v[208:223], v[20:23], v[52:55], 0
    ds_read_b64_tr_b16 v[40:41], v4 offset:10240
    s_waitcnt lgkmcnt(9)
    v_mfma_f32_32x32x16_bf16 v[160:175], v[24:27], v[48:51], 0
    ds_read_b64_tr_b16 v[42:43], v4 offset:10752
    v_mfma_f32_32x32x16_bf16 v[224:239], v[24:27], v[52:55], 0
    ds_read_b64_tr_b16 v[44:45], v5 offset:10240
    s_waitcnt lgkmcnt(9)
    v_mfma_f32_32x32x16_bf16 v[176:191], v[28:31], v[48:51], 0
    ds_read_b64_tr_b16 v[46:47], v5 offset:10752
    v_mfma_f32_32x32x16_bf16 v[240:255], v[28:31], v[52:55], 0
    ds_read_b128 v[48:51], v8
    ds_read_b128 v[52:55], v8 offset:4096
    s_waitcnt lgkmcnt(8)
    v_mfma_f32_32x32x16_bf16 v[128:143], v[32:35], v[56:59], v[128:143]
    ds_read_b64_tr_b16 v[16:17], v4 offset:4096
    ds_read_b64_tr_b16 v[18:19], v4 offset:4608
    v_mfma_f32_32x32x16_bf16 v[192:207], v[32:35], v[60:63], v[192:207]
    ds_read_b64_tr_b16 v[20:21], v5 offset:4096
    s_waitcnt lgkmcnt(9)
    v_mfma_f32_32x32x16_bf16 v[144:159], v[36:39], v[56:59], v[144:159]
    ds_read_b64_tr_b16 v[22:23], v5 offset:4608
    v_mfma_f32_32x32x16_bf16 v[208:223], v[36:39], v[60:63], v[208:223]
    ds_read_b64_tr_b16 v[24:25], v4 offset:12288
    s_waitcnt lgkmcnt(9)
    v_mfma_f32_32x32x16_bf16 v[160:175], v[40:43], v[56:59], v[160:175]
    ds_read_b64_tr_b16 v[26:27], v4 offset:12800
    v_mfma_f32_32x32x16_bf16 v[224:239], v[40:43], v[60:63], v[224:239]
    ds_read_b64_tr_b16 v[28:29], v5 offset:12288
    s_waitcnt lgkmcnt(9)
    v_mfma_f32_32x32x16_bf16 v[176:191], v[44:47], v[56:59], v[176:191]
    ds_read_b64_tr_b16 v[30:31], v5 offset:12800
    v_mfma_f32_32x32x16_bf16 v[240:255], v[44:47], v[60:63], v[240:255]
    ds_read_b32 v92, v95 offset:48
    ds_read_b128 v[56:59], v9
    s_waitcnt lgkmcnt(8)
    v_mfma_f32_32x32x16_bf16 v[128:143], v[16:19], v[48:51], v[128:143]
    ds_read_b128 v[60:63], v9 offset:4096
    ds_read_b64_tr_b16 v[32:33], v4 offset:6144
    v_mfma_f32_32x32x16_bf16 v[192:207], v[16:19], v[52:55], v[192:207]
    ds_read_b64_tr_b16 v[34:35], v4 offset:6656
    ds_read_b64_tr_b16 v[36:37], v5 offset:6144
    s_waitcnt lgkmcnt(10)
    v_mfma_f32_32x32x16_bf16 v[144:159], v[20:23], v[48:51], v[144:159]
    ds_read_b64_tr_b16 v[38:39], v5 offset:6656
    ds_read_b64_tr_b16 v[40:41], v4 offset:14336
    v_mfma_f32_32x32x16_bf16 v[208:223], v[20:23], v[52:55], v[208:223]
    ds_read_b64_tr_b16 v[42:43], v4 offset:14848
    s_waitcnt lgkmcnt(11)
    v_mfma_f32_32x32x16_bf16 v[160:175], v[24:27], v[48:51], v[160:175]
    ds_read_b64_tr_b16 v[44:45], v5 offset:14336
    v_mfma_f32_32x32x16_bf16 v[224:239], v[24:27], v[52:55], v[224:239]
    ds_read_b64_tr_b16 v[46:47], v5 offset:14848
    s_waitcnt lgkmcnt(11)
    v_mfma_f32_32x32x16_bf16 v[176:191], v[28:31], v[48:51], v[176:191]
    s_waitcnt vmcnt(0)
    v_mov_b32 v93, 3
    s_mov_b64 exec, 1
    ds_write_b32 v94, v93 offset:64
    s_mov_b64 exec, -1
    s_waitcnt lgkmcnt(11)
    v_cmp_gt_u32 vcc, 2, v92
    v_mfma_f32_32x32x16_bf16 v[240:255], v[28:31], v[52:55], v[240:255]
    v_add_u32 v4, 0xc000, v4
    v_add_u32 v5, 0xc000, v5
    v_add_u32 v6, 0xc000, v6
    v_add_u32 v7, 0xc000, v7
    v_add_u32 v8, 0xc000, v8
    v_add_u32 v9, 0xc000, v9
    s_cbranch_vccz CW1_G
    s_mov_b32 s59, 0
CW1_P:
    ds_read_b32 v92, v95 offset:48
    s_add_u32 s59, s59, 1
    s_waitcnt lgkmcnt(0)
    v_cmp_gt_u32 vcc, 2, v92
    s_cmp_ge_u32 s59, 0x8000
    s_cbranch_scc1 CW1_G
    s_nop 4
    s_cbranch_vccnz CW1_P
CW1_G:
    ds_read_b128 v[48:51], v6
    ds_read_b128 v[52:55], v6 offset:4096
    s_waitcnt lgkmcnt(9)
    v_mfma_f32_32x32x16_bf16 v[128:143], v[32:35], v[56:59], v[128:143]
    ds_read_b64_tr_b16 v[16:17], v4
    ds_read_b64_tr_b16 v[18:19], v4 offset:512
    v_mfma_f32_32x32x16_bf16 v[192:207], v[32:35], v[60:63], v[192:207]
    ds_read_b64_tr_b16 v[20:21], v5
    s_waitcnt lgkmcnt(10)
    v_mfma_f32_32x32x16_bf16 v[144:159], v[36:39], v[56:59], v[144:159]
    ds_read_b64_tr_b16 v[22:23], v5 offset:512
    v_mfma_f32_32x32x16_bf16 v[208:223], v[36:39], v[60:63], v[208:223]
    ds_read_b64_tr_b16 v[24:25], v4 offset:8192
    s_waitcnt lgkmcnt(10)
    v_mfma_f32_32x32x16_bf16 v[160:175], v[40:43], v[56:59], v[160:175]
    ds_read_b64_tr_b16 v[26:27], v4 offset:8704
    v_mfma_f32_32x32x16_bf16 v[224:239], v[40:43], v[60:63], v[224:239]
    ds_read_b64_tr_b16 v[28:29], v5 offset:8192
    s_waitcnt lgkmcnt(10)
    v_mfma_f32_32x32x16_bf16 v[176:191], v[44:47], v[56:59], v[176:191]
    ds_read_b64_tr_b16 v[30:31], v5 offset:8704
    v_mfma_f32_32x32x16_bf16 v[240:255], v[44:47], v[60:63], v[240:255]
    ds_read_b128 v[56:59], v7
    ds_read_b128 v[60:63], v7 offset:4096
    s_waitcnt lgkmcnt(8)
    v_mfma_f32_32x32x16_bf16 v[128:143], v[16:19], v[48:51], v[128:143]
    ds_read_b64_tr_b16 v[32:33], v4 offset:2048
    ds_read_b64_tr_b16 v[34:35], v4 offset:2560
    v_mfma_f32_32x32x16_bf16 v[192:207], v[16:19], v[52:55], v[192:207]
    ds_read_b64_tr_b16 v[36:37], v5 offset:2048
    s_waitcnt lgkmcnt(9)
    v_mfma_f32_32x32x16_bf16 v[144:159], v[20:23], v[48:51], v[144:159]
    ds_read_b64_tr_b16 v[38:39], v5 offset:2560
    v_mfma_f32_32x32x16_bf16 v[208:223], v[20:23], v[52:55], v[208:223]
    ds_read_b64_tr_b16 v[40:41], v4 offset:10240
    s_waitcnt lgkmcnt(9)
    v_mfma_f32_32x32x16_bf16 v[160:175], v[24:27], v[48:51], v[160:175]
    ds_read_b64_tr_b16 v[42:43], v4 offset:10752
    v_mfma_f32_32x32x16_bf16 v[224:239], v[24:27], v[52:55], v[224:239]
    ds_read_b64_tr_b16 v[44:45], v5 offset:10240
    s_waitcnt lgkmcnt(9)
    v_mfma_f32_32x32x16_bf16 v[176:191], v[28:31], v[48:51], v[176:191]
    ds_read_b64_tr_b16 v[46:47], v5 offset:10752
    v_mfma_f32_32x32x16_bf16 v[240:255], v[28:31], v[52:55], v[240:255]
    ds_read_b128 v[48:51], v8
    ds_read_b128 v[52:55], v8 offset:4096
    s_waitcnt lgkmcnt(8)
    v_mfma_f32_32x32x16_bf16 v[128:143], v[32:35], v[56:59], v[128:143]
    ds_read_b64_tr_b16 v[16:17], v4 offset:4096
    ds_read_b64_tr_b16 v[18:19], v4 offset:4608
    v_mfma_f32_32x32x16_bf16 v[192:207], v[32:35], v[60:63], v[192:207]
    ds_read_b64_tr_b16 v[20:21], v5 offset:4096
    s_waitcnt lgkmcnt(9)
    v_mfma_f32_32x32x16_bf16 v[144:159], v[36:39], v[56:59], v[144:159]
    ds_read_b64_tr_b16 v[22:23], v5 offset:4608
    v_mfma_f32_32x32x16_bf16 v[208:223], v[36:39], v[60:63], v[208:223]
    ds_read_b64_tr_b16 v[24:25], v4 offset:12288
    s_waitcnt lgkmcnt(9)
    v_mfma_f32_32x32x16_bf16 v[160:175], v[40:43], v[56:59], v[160:175]
    ds_read_b64_tr_b16 v[26:27], v4 offset:12800
    v_mfma_f32_32x32x16_bf16 v[224:239], v[40:43], v[60:63], v[224:239]
    ds_read_b64_tr_b16 v[28:29], v5 offset:12288
    s_waitcnt lgkmcnt(9)
    v_mfma_f32_32x32x16_bf16 v[176:191], v[44:47], v[56:59], v[176:191]
    ds_read_b64_tr_b16 v[30:31], v5 offset:12800
    v_mfma_f32_32x32x16_bf16 v[240:255], v[44:47], v[60:63], v[240:255]
    ds_read_b32 v92, v95 offset:48
    ds_read_b128 v[56:59], v9
    s_waitcnt lgkmcnt(8)
    v_mfma_f32_32x32x16_bf16 v[128:143], v[16:19], v[48:51], v[128:143]
    ds_read_b128 v[60:63], v9 offset:4096
    ds_read_b64_tr_b16 v[32:33], v4 offset:6144
    v_mfma_f32_32x32x16_bf16 v[192:207], v[16:19], v[52:55], v[192:207]
    ds_read_b64_tr_b16 v[34:35], v4 offset:6656
    ds_read_b64_tr_b16 v[36:37], v5 offset:6144
    s_waitcnt lgkmcnt(10)
    v_mfma_f32_32x32x16_bf16 v[144:159], v[20:23], v[48:51], v[144:159]
    ds_read_b64_tr_b16 v[38:39], v5 offset:6656
    ds_read_b64_tr_b16 v[40:41], v4 offset:14336
    v_mfma_f32_32x32x16_bf16 v[208:223], v[20:23], v[52:55], v[208:223]
    ds_read_b64_tr_b16 v[42:43], v4 offset:14848
    s_waitcnt lgkmcnt(11)
    v_mfma_f32_32x32x16_bf16 v[160:175], v[24:27], v[48:51], v[160:175]
    ds_read_b64_tr_b16 v[44:45], v5 offset:14336
    v_mfma_f32_32x32x16_bf16 v[224:239], v[24:27], v[52:55], v[224:239]
    ds_read_b64_tr_b16 v[46:47], v5 offset:14848
    s_waitcnt lgkmcnt(11)
    v_mfma_f32_32x32x16_bf16 v[176:191], v[28:31], v[48:51], v[176:191]
    v_mov_b32 v93, 4
    s_mov_b64 exec, 1
    ds_write_b32 v94, v93 offset:64
    s_mov_b64 exec, -1
    s_waitcnt lgkmcnt(11)
    v_cmp_gt_u32 vcc, 3, v92
    v_mfma_f32_32x32x16_bf16 v[240:255], v[28:31], v[52:55], v[240:255]
    v_add_u32 v4, 0xc000, v4
    v_add_u32 v5, 0xc000, v5
    v_add_u32 v6, 0xc000, v6
    v_add_u32 v7, 0xc000, v7
    v_add_u32 v8, 0xc000, v8
    v_add_u32 v9, 0xc000, v9
    s_cbranch_vccz CW2_G
    s_mov_b32 s59, 0
CW2_P:
    ds_read_b32 v92, v95 offset:48
    s_add_u32 s59, s59, 1
    s_waitcnt lgkmcnt(0)
    v_cmp_gt_u32 vcc, 3, v92
    s_cmp_ge_u32 s59, 0x8000
    s_cbranch_scc1 CW2_G
    s_nop 4
    s_cbranch_vccnz CW2_P
CW2_G:
    ds_read_b128 v[48:51], v6
    ds_read_b128 v[52:55], v6 offset:4096
    s_waitcnt lgkmcnt(9)
    v_mfma_f32_32x32x16_bf16 v[128:143], v[32:35], v[56:59], v[128:143]
    ds_read_b64_tr_b16 v[16:17], v4
    ds_read_b64_tr_b16 v[18:19], v4 offset:512
    v_mfma_f32_32x32x16_bf16 v[192:207], v[32:35], v[60:63], v[192:207]
    ds_read_b64_tr_b16 v[20:21], v5
    s_waitcnt lgkmcnt(10)
    v_mfma_f32_32x32x16_bf16 v[144:159], v[36:39], v[56:59], v[144:159]
    ds_read_b64_tr_b16 v[22:23], v5 offset:512
    v_mfma_f32_32x32x16_bf16 v[208:223], v[36:39], v[60:63], v[208:223]
    ds_read_b64_tr_b16 v[24:25], v4 offset:8192
    s_waitcnt lgkmcnt(10)
    v_mfma_f32_32x32x16_bf16 v[160:175], v[40:43], v[56:59], v[160:175]
    ds_read_b64_tr_b16 v[26:27], v4 offset:8704
    v_mfma_f32_32x32x16_bf16 v[224:239], v[40:43], v[60:63], v[224:239]
    ds_read_b64_tr_b16 v[28:29], v5 offset:8192
    s_waitcnt lgkmcnt(10)
    v_mfma_f32_32x32x16_bf16 v[176:191], v[44:47], v[56:59], v[176:191]
    ds_read_b64_tr_b16 v[30:31], v5 offset:8704
    v_mfma_f32_32x32x16_bf16 v[240:255], v[44:47], v[60:63], v[240:255]
    ds_read_b128 v[56:59], v7
    ds_read_b128 v[60:63], v7 offset:4096
    s_waitcnt lgkmcnt(8)
    v_mfma_f32_32x32x16_bf16 v[128:143], v[16:19], v[48:51], v[128:143]
    ds_read_b64_tr_b16 v[32:33], v4 offset:2048
    ds_read_b64_tr_b16 v[34:35], v4 offset:2560
    v_mfma_f32_32x32x16_bf16 v[192:207], v[16:19], v[52:55], v[192:207]
    ds_read_b64_tr_b16 v[36:37], v5 offset:2048
    s_waitcnt lgkmcnt(9)
    v_mfma_f32_32x32x16_bf16 v[144:159], v[20:23], v[48:51], v[144:159]
    ds_read_b64_tr_b16 v[38:39], v5 offset:2560
    v_mfma_f32_32x32x16_bf16 v[208:223], v[20:23], v[52:55], v[208:223]
    ds_read_b64_tr_b16 v[40:41], v4 offset:10240
    s_waitcnt lgkmcnt(9)
    v_mfma_f32_32x32x16_bf16 v[160:175], v[24:27], v[48:51], v[160:175]
    ds_read_b64_tr_b16 v[42:43], v4 offset:10752
    v_mfma_f32_32x32x16_bf16 v[224:239], v[24:27], v[52:55], v[224:239]
    ds_read_b64_tr_b16 v[44:45], v5 offset:10240
    s_waitcnt lgkmcnt(9)
    v_mfma_f32_32x32x16_bf16 v[176:191], v[28:31], v[48:51], v[176:191]
    ds_read_b64_tr_b16 v[46:47], v5 offset:10752
    v_mfma_f32_32x32x16_bf16 v[240:255], v[28:31], v[52:55], v[240:255]
    ds_read_b128 v[48:51], v8
    ds_read_b128 v[52:55], v8 offset:4096
    s_waitcnt lgkmcnt(8)
    v_mfma_f32_32x32x16_bf16 v[128:143], v[32:35], v[56:59], v[128:143]
    ds_read_b64_tr_b16 v[16:17], v4 offset:4096
    ds_read_b64_tr_b16 v[18:19], v4 offset:4608
    v_mfma_f32_32x32x16_bf16 v[192:207], v[32:35], v[60:63], v[192:207]
    ds_read_b64_tr_b16 v[20:21], v5 offset:4096
    s_waitcnt lgkmcnt(9)
    v_mfma_f32_32x32x16_bf16 v[144:159], v[36:39], v[56:59], v[144:159]
    ds_read_b64_tr_b16 v[22:23], v5 offset:4608
    v_mfma_f32_32x32x16_bf16 v[208:223], v[36:39], v[60:63], v[208:223]
    ds_read_b64_tr_b16 v[24:25], v4 offset:12288
    s_waitcnt lgkmcnt(9)
    v_mfma_f32_32x32x16_bf16 v[160:175], v[40:43], v[56:59], v[160:175]
    ds_read_b64_tr_b16 v[26:27], v4 offset:12800
    v_mfma_f32_32x32x16_bf16 v[224:239], v[40:43], v[60:63], v[224:239]
    ds_read_b64_tr_b16 v[28:29], v5 offset:12288
    s_waitcnt lgkmcnt(9)
    v_mfma_f32_32x32x16_bf16 v[176:191], v[44:47], v[56:59], v[176:191]
    ds_read_b64_tr_b16 v[30:31], v5 offset:12800
    v_mfma_f32_32x32x16_bf16 v[240:255], v[44:47], v[60:63], v[240:255]
    ds_read_b32 v92, v95 offset:48
    ds_read_b128 v[56:59], v9
    s_waitcnt lgkmcnt(8)
    v_mfma_f32_32x32x16_bf16 v[128:143], v[16:19], v[48:51], v[128:143]
    ds_read_b128 v[60:63], v9 offset:4096
    ds_read_b64_tr_b16 v[32:33], v4 offset:6144
    v_mfma_f32_32x32x16_bf16 v[192:207], v[16:19], v[52:55], v[192:207]
    ds_read_b64_tr_b16 v[34:35], v4 offset:6656
    ds_read_b64_tr_b16 v[36:37], v5 offset:6144
    s_waitcnt lgkmcnt(10)
    v_mfma_f32_32x32x16_bf16 v[144:159], v[20:23], v[48:51], v[144:159]
    ds_read_b64_tr_b16 v[38:39], v5 offset:6656
    ds_read_b64_tr_b16 v[40:41], v4 offset:14336
    v_mfma_f32_32x32x16_bf16 v[208:223], v[20:23], v[52:55], v[208:223]
    ds_read_b64_tr_b16 v[42:43], v4 offset:14848
    s_waitcnt lgkmcnt(11)
    v_mfma_f32_32x32x16_bf16 v[160:175], v[24:27], v[48:51], v[160:175]
    ds_read_b64_tr_b16 v[44:45], v5 offset:14336
    v_mfma_f32_32x32x16_bf16 v[224:239], v[24:27], v[52:55], v[224:239]
    ds_read_b64_tr_b16 v[46:47], v5 offset:14848
    s_waitcnt lgkmcnt(11)
    v_mfma_f32_32x32x16_bf16 v[176:191], v[28:31], v[48:51], v[176:191]
    v_mov_b32 v93, 5
    s_mov_b64 exec, 1
    ds_write_b32 v94, v93 offset:64
    s_mov_b64 exec, -1
    s_waitcnt lgkmcnt(11)
    v_cmp_gt_u32 vcc, 4, v92
    v_mfma_f32_32x32x16_bf16 v[240:255], v[28:31], v[52:55], v[240:255]
    v_add_u32 v4, 0xfffe8000, v4
    v_add_u32 v5, 0xfffe8000, v5
    v_add_u32 v6, 0xfffe8000, v6
    v_add_u32 v7, 0xfffe8000, v7
    v_add_u32 v8, 0xfffe8000, v8
    v_add_u32 v9, 0xfffe8000, v9
    s_cbranch_vccz CW3_G
    s_mov_b32 s59, 0
CW3_P:
    ds_read_b32 v92, v95 offset:48
    s_add_u32 s59, s59, 1
    s_waitcnt lgkmcnt(0)
    v_cmp_gt_u32 vcc, 4, v92
    s_cmp_ge_u32 s59, 0x8000
    s_cbranch_scc1 CW3_G
    s_nop 4
    s_cbranch_vccnz CW3_P
CW3_G:
    ds_read_b128 v[48:51], v6
    ds_read_b128 v[52:55], v6 offset:4096
    s_waitcnt lgkmcnt(9)
    v_mfma_f32_32x32x16_bf16 v[128:143], v[32:35], v[56:59], v[128:143]
    ds_read_b64_tr_b16 v[16:17], v4
    ds_read_b64_tr_b16 v[18:19], v4 offset:512
    v_mfma_f32_32x32x16_bf16 v[192:207], v[32:35], v[60:63], v[192:207]
    ds_read_b64_tr_b16 v[20:21], v5
    s_waitcnt lgkmcnt(10)
    v_mfma_f32_32x32x16_bf16 v[144:159], v[36:39], v[56:59], v[144:159]
    ds_read_b64_tr_b16 v[22:23], v5 offset:512
    v_mfma_f32_32x32x16_bf16 v[208:223], v[36:39], v[60:63], v[208:223]
    ds_read_b64_tr_b16 v[24:25], v4 offset:8192
    s_waitcnt lgkmcnt(10)
    v_mfma_f32_32x32x16_bf16 v[160:175], v[40:43], v[56:59], v[160:175]
    ds_read_b64_tr_b16 v[26:27], v4 offset:8704
    v_mfma_f32_32x32x16_bf16 v[224:239], v[40:43], v[60:63], v[224:239]
    ds_read_b64_tr_b16 v[28:29], v5 offset:8192
    s_waitcnt lgkmcnt(10)
    v_mfma_f32_32x32x16_bf16 v[176:191], v[44:47], v[56:59], v[176:191]
    ds_read_b64_tr_b16 v[30:31], v5 offset:8704
    v_mfma_f32_32x32x16_bf16 v[240:255], v[44:47], v[60:63], v[240:255]
    ds_read_b128 v[56:59], v7
    ds_read_b128 v[60:63], v7 offset:4096
    s_waitcnt lgkmcnt(8)
    v_mfma_f32_32x32x16_bf16 v[128:143], v[16:19], v[48:51], v[128:143]
    ds_read_b64_tr_b16 v[32:33], v4 offset:2048
    ds_read_b64_tr_b16 v[34:35], v4 offset:2560
    v_mfma_f32_32x32x16_bf16 v[192:207], v[16:19], v[52:55], v[192:207]
    ds_read_b64_tr_b16 v[36:37], v5 offset:2048
    s_waitcnt lgkmcnt(9)
    v_mfma_f32_32x32x16_bf16 v[144:159], v[20:23], v[48:51], v[144:159]
    ds_read_b64_tr_b16 v[38:39], v5 offset:2560
    v_mfma_f32_32x32x16_bf16 v[208:223], v[20:23], v[52:55], v[208:223]
    ds_read_b64_tr_b16 v[40:41], v4 offset:10240
    s_waitcnt lgkmcnt(9)
    v_mfma_f32_32x32x16_bf16 v[160:175], v[24:27], v[48:51], v[160:175]
    ds_read_b64_tr_b16 v[42:43], v4 offset:10752
    v_mfma_f32_32x32x16_bf16 v[224:239], v[24:27], v[52:55], v[224:239]
    ds_read_b64_tr_b16 v[44:45], v5 offset:10240
    s_waitcnt lgkmcnt(9)
    v_mfma_f32_32x32x16_bf16 v[176:191], v[28:31], v[48:51], v[176:191]
    ds_read_b64_tr_b16 v[46:47], v5 offset:10752
    v_mfma_f32_32x32x16_bf16 v[240:255], v[28:31], v[52:55], v[240:255]
    ds_read_b128 v[48:51], v8
    ds_read_b128 v[52:55], v8 offset:4096
    s_waitcnt lgkmcnt(8)
    v_mfma_f32_32x32x16_bf16 v[128:143], v[32:35], v[56:59], v[128:143]
    ds_read_b64_tr_b16 v[16:17], v4 offset:4096
    ds_read_b64_tr_b16 v[18:19], v4 offset:4608
    v_mfma_f32_32x32x16_bf16 v[192:207], v[32:35], v[60:63], v[192:207]
    ds_read_b64_tr_b16 v[20:21], v5 offset:4096
    s_waitcnt lgkmcnt(9)
    v_mfma_f32_32x32x16_bf16 v[144:159], v[36:39], v[56:59], v[144:159]
    ds_read_b64_tr_b16 v[22:23], v5 offset:4608
    v_mfma_f32_32x32x16_bf16 v[208:223], v[36:39], v[60:63], v[208:223]
    ds_read_b64_tr_b16 v[24:25], v4 offset:12288
    s_waitcnt lgkmcnt(9)
    v_mfma_f32_32x32x16_bf16 v[160:175], v[40:43], v[56:59], v[160:175]
    ds_read_b64_tr_b16 v[26:27], v4 offset:12800
    v_mfma_f32_32x32x16_bf16 v[224:239], v[40:43], v[60:63], v[224:239]
    ds_read_b64_tr_b16 v[28:29], v5 offset:12288
    s_waitcnt lgkmcnt(9)
    v_mfma_f32_32x32x16_bf16 v[176:191], v[44:47], v[56:59], v[176:191]
    ds_read_b64_tr_b16 v[30:31], v5 offset:12800
    v_mfma_f32_32x32x16_bf16 v[240:255], v[44:47], v[60:63], v[240:255]
    ds_read_b32 v92, v95 offset:48
    ds_read_b128 v[56:59], v9
    s_waitcnt lgkmcnt(8)
    v_mfma_f32_32x32x16_bf16 v[128:143], v[16:19], v[48:51], v[128:143]
    ds_read_b128 v[60:63], v9 offset:4096
    ds_read_b64_tr_b16 v[32:33], v4 offset:6144
    v_mfma_f32_32x32x16_bf16 v[192:207], v[16:19], v[52:55], v[192:207]
    ds_read_b64_tr_b16 v[34:35], v4 offset:6656
    ds_read_b64_tr_b16 v[36:37], v5 offset:6144
    s_waitcnt lgkmcnt(10)
    v_mfma_f32_32x32x16_bf16 v[144:159], v[20:23], v[48:51], v[144:159]
    ds_read_b64_tr_b16 v[38:39], v5 offset:6656
    ds_read_b64_tr_b16 v[40:41], v4 offset:14336
    v_mfma_f32_32x32x16_bf16 v[208:223], v[20:23], v[52:55], v[208:223]
    ds_read_b64_tr_b16 v[42:43], v4 offset:14848
    s_waitcnt lgkmcnt(11)
    v_mfma_f32_32x32x16_bf16 v[160:175], v[24:27], v[48:51], v[160:175]
    ds_read_b64_tr_b16 v[44:45], v5 offset:14336
    v_mfma_f32_32x32x16_bf16 v[224:239], v[24:27], v[52:55], v[224:239]
    ds_read_b64_tr_b16 v[46:47], v5 offset:14848
    s_waitcnt lgkmcnt(11)
    v_mfma_f32_32x32x16_bf16 v[176:191], v[28:31], v[48:51], v[176:191]
    v_mov_b32 v93, 6
    s_mov_b64 exec, 1
    ds_write_b32 v94, v93 offset:64
    s_mov_b64 exec, -1
    s_waitcnt lgkmcnt(11)
    v_cmp_gt_u32 vcc, 5, v92
    v_mfma_f32_32x32x16_bf16 v[240:255], v[28:31], v[52:55], v[240:255]
    v_add_u32 v4, 0xc000, v4
    v_add_u32 v5, 0xc000, v5
    v_add_u32 v6, 0xc000, v6
    v_add_u32 v7, 0xc000, v7
    v_add_u32 v8, 0xc000, v8
    v_add_u32 v9, 0xc000, v9
    s_cbranch_vccz CW4_G
    s_mov_b32 s59, 0
CW4_P:
    ds_read_b32 v92, v95 offset:48
    s_add_u32 s59, s59, 1
    s_waitcnt lgkmcnt(0)
    v_cmp_gt_u32 vcc, 5, v92
    s_cmp_ge_u32 s59, 0x8000
    s_cbranch_scc1 CW4_G
    s_nop 4
    s_cbranch_vccnz CW4_P
CW4_G:
    ds_read_b128 v[48:51], v6
    ds_read_b128 v[52:55], v6 offset:4096
    s_waitcnt lgkmcnt(9)
    v_mfma_f32_32x32x16_bf16 v[128:143], v[32:35], v[56:59], v[128:143]
    s_mov_b32 s5, 0
    buffer_load_dword v100, v99, s[40:43], s5 offen
    ds_read_b64_tr_b16 v[16:17], v4
    ds_read_b64_tr_b16 v[18:19], v4 offset:512
    v_mfma_f32_32x32x16_bf16 v[192:207], v[32:35], v[60:63], v[192:207]
    ds_read_b64_tr_b16 v[20:21], v5
    s_waitcnt lgkmcnt(10)
    v_mfma_f32_32x32x16_bf16 v[144:159], v[36:39], v[56:59], v[144:159]
    ds_read_b64_tr_b16 v[22:23], v5 offset:512
    v_mfma_f32_32x32x16_bf16 v[208:223], v[36:39], v[60:63], v[208:223]
    ds_read_b64_tr_b16 v[24:25], v4 offset:8192
    s_waitcnt lgkmcnt(10)
    v_mfma_f32_32x32x16_bf16 v[160:175], v[40:43], v[56:59], v[160:175]
    ds_read_b64_tr_b16 v[26:27], v4 offset:8704
    v_mfma_f32_32x32x16_bf16 v[224:239], v[40:43], v[60:63], v[224:239]
    ds_read_b64_tr_b16 v[28:29], v5 offset:8192
    s_waitcnt lgkmcnt(10)
    v_mfma_f32_32x32x16_bf16 v[176:191], v[44:47], v[56:59], v[176:191]
    ds_read_b64_tr_b16 v[30:31], v5 offset:8704
    v_mfma_f32_32x32x16_bf16 v[240:255], v[44:47], v[60:63], v[240:255]
    ds_read_b128 v[56:59], v7
    ds_read_b128 v[60:63], v7 offset:4096
    s_waitcnt lgkmcnt(8)
    v_mfma_f32_32x32x16_bf16 v[128:143], v[16:19], v[48:51], v[128:143]
    ds_read_b64_tr_b16 v[32:33], v4 offset:2048
    ds_read_b64_tr_b16 v[34:35], v4 offset:2560
    v_mfma_f32_32x32x16_bf16 v[192:207], v[16:19], v[52:55], v[192:207]
    ds_read_b64_tr_b16 v[36:37], v5 offset:2048
    s_waitcnt lgkmcnt(9)
    v_mfma_f32_32x32x16_bf16 v[144:159], v[20:23], v[48:51], v[144:159]
    ds_read_b64_tr_b16 v[38:39], v5 offset:2560
    v_mfma_f32_32x32x16_bf16 v[208:223], v[20:23], v[52:55], v[208:223]
    ds_read_b64_tr_b16 v[40:41], v4 offset:10240
    s_waitcnt lgkmcnt(9)
    v_mfma_f32_32x32x16_bf16 v[160:175], v[24:27], v[48:51], v[160:175]
    ds_read_b64_tr_b16 v[42:43], v4 offset:10752
    v_mfma_f32_32x32x16_bf16 v[224:239], v[24:27], v[52:55], v[224:239]
    ds_read_b64_tr_b16 v[44:45], v5 offset:10240
    s_waitcnt lgkmcnt(9)
    v_mfma_f32_32x32x16_bf16 v[176:191], v[28:31], v[48:51], v[176:191]
    ds_read_b64_tr_b16 v[46:47], v5 offset:10752
    v_mfma_f32_32x32x16_bf16 v[240:255], v[28:31], v[52:55], v[240:255]
    ds_read_b128 v[48:51], v8
    ds_read_b128 v[52:55], v8 offset:4096
    s_waitcnt lgkmcnt(8)
    v_mfma_f32_32x32x16_bf16 v[128:143], v[32:35], v[56:59], v[128:143]
    s_mov_b32 s5, 0x6200
    buffer_load_dword v100, v99, s[40:43], s5 offen
    ds_read_b64_tr_b16 v[16:17], v4 offset:4096
    ds_read_b64_tr_b16 v[18:19], v4 offset:4608
    v_mfma_f32_32x32x16_bf16 v[192:207], v[32:35], v[60:63], v[192:207]
    ds_read_b64_tr_b16 v[20:21], v5 offset:4096
    s_waitcnt lgkmcnt(9)
    v_mfma_f32_32x32x16_bf16 v[144:159], v[36:39], v[56:59], v[144:159]
    ds_read_b64_tr_b16 v[22:23], v5 offset:4608
    v_mfma_f32_32x32x16_bf16 v[208:223], v[36:39], v[60:63], v[208:223]
    ds_read_b64_tr_b16 v[24:25], v4 offset:12288
    s_waitcnt lgkmcnt(9)
    v_mfma_f32_32x32x16_bf16 v[160:175], v[40:43], v[56:59], v[160:175]
    ds_read_b64_tr_b16 v[26:27], v4 offset:12800
    v_mfma_f32_32x32x16_bf16 v[224:239], v[40:43], v[60:63], v[224:239]
    ds_read_b64_tr_b16 v[28:29], v5 offset:12288
    s_waitcnt lgkmcnt(9)
    v_mfma_f32_32x32x16_bf16 v[176:191], v[44:47], v[56:59], v[176:191]
    ds_read_b64_tr_b16 v[30:31], v5 offset:12800
    v_mfma_f32_32x32x16_bf16 v[240:255], v[44:47], v[60:63], v[240:255]
    ds_read_b32 v92, v95 offset:48
    ds_read_b128 v[56:59], v9
    s_waitcnt lgkmcnt(8)
    v_mfma_f32_32x32x16_bf16 v[128:143], v[16:19], v[48:51], v[128:143]
    ds_read_b128 v[60:63], v9 offset:4096
    ds_read_b64_tr_b16 v[32:33], v4 offset:6144
    v_mfma_f32_32x32x16_bf16 v[192:207], v[16:19], v[52:55], v[192:207]
    ds_read_b64_tr_b16 v[34:35], v4 offset:6656
    ds_read_b64_tr_b16 v[36:37], v5 offset:6144
    s_waitcnt lgkmcnt(10)
    v_mfma_f32_32x32x16_bf16 v[144:159], v[20:23], v[48:51], v[144:159]
    ds_read_b64_tr_b16 v[38:39], v5 offset:6656
    ds_read_b64_tr_b16 v[40:41], v4 offset:14336
    v_mfma_f32_32x32x16_bf16 v[208:223], v[20:23], v[52:55], v[208:223]
    ds_read_b64_tr_b16 v[42:43], v4 offset:14848
    s_waitcnt lgkmcnt(11)
    v_mfma_f32_32x32x16_bf16 v[160:175], v[24:27], v[48:51], v[160:175]
    ds_read_b64_tr_b16 v[44:45], v5 offset:14336
    v_mfma_f32_32x32x16_bf16 v[224:239], v[24:27], v[52:55], v[224:239]
    ds_read_b64_tr_b16 v[46:47], v5 offset:14848
    s_waitcnt lgkmcnt(11)
    v_mfma_f32_32x32x16_bf16 v[176:191], v[28:31], v[48:51], v[176:191]
    v_mov_b32 v93, 7
    s_mov_b64 exec, 1
    ds_write_b32 v94, v93 offset:64
    s_mov_b64 exec, -1
    s_waitcnt lgkmcnt(11)
    v_cmp_gt_u32 vcc, 6, v92
    v_mfma_f32_32x32x16_bf16 v[240:255], v[28:31], v[52:55], v[240:255]
    v_add_u32 v4, 0xc000, v4
    v_add_u32 v5, 0xc000, v5
    v_add_u32 v6, 0xc000, v6
    v_add_u32 v7, 0xc000, v7
    v_add_u32 v8, 0xc000, v8
    v_add_u32 v9, 0xc000, v9
    s_cbranch_vccz CW5_G
    s_mov_b32 s59, 0
CW5_P:
    ds_read_b32 v92, v95 offset:48
    s_add_u32 s59, s59, 1
    s_waitcnt lgkmcnt(0)
    v_cmp_gt_u32 vcc, 6, v92
    s_cmp_ge_u32 s59, 0x8000
    s_cbranch_scc1 CW5_G
    s_nop 4
    s_cbranch_vccnz CW5_P
CW5_G:
    ds_read_b128 v[48:51], v6
    ds_read_b128 v[52:55], v6 offset:4096
    s_waitcnt lgkmcnt(9)
    v_mfma_f32_32x32x16_bf16 v[128:143], v[32:35], v[56:59], v[128:143]
    s_mov_b32 s5, 0xc400
    buffer_load_dword v100, v99, s[40:43], s5 offen
    ds_read_b64_tr_b16 v[16:17], v4
    ds_read_b64_tr_b16 v[18:19], v4 offset:512
    v_mfma_f32_32x32x16_bf16 v[192:207], v[32:35], v[60:63], v[192:207]
    ds_read_b64_tr_b16 v[20:21], v5
    s_waitcnt lgkmcnt(10)
    v_mfma_f32_32x32x16_bf16 v[144:159], v[36:39], v[56:59], v[144:159]
    ds_read_b64_tr_b16 v[22:23], v5 offset:512
    v_mfma_f32_32x32x16_bf16 v[208:223], v[36:39], v[60:63], v[208:223]
    ds_read_b64_tr_b16 v[24:25], v4 offset:8192
    s_waitcnt lgkmcnt(10)
    v_mfma_f32_32x32x16_bf16 v[160:175], v[40:43], v[56:59], v[160:175]
    ds_read_b64_tr_b16 v[26:27], v4 offset:8704
    v_mfma_f32_32x32x16_bf16 v[224:239], v[40:43], v[60:63], v[224:239]
    ds_read_b64_tr_b16 v[28:29], v5 offset:8192
    s_waitcnt lgkmcnt(10)
    v_mfma_f32_32x32x16_bf16 v[176:191], v[44:47], v[56:59], v[176:191]
    ds_read_b64_tr_b16 v[30:31], v5 offset:8704
    v_mfma_f32_32x32x16_bf16 v[240:255], v[44:47], v[60:63], v[240:255]
    ds_read_b128 v[56:59], v7
    ds_read_b128 v[60:63], v7 offset:4096
    s_waitcnt lgkmcnt(8)
    v_mfma_f32_32x32x16_bf16 v[128:143], v[16:19], v[48:51], v[128:143]
    ds_read_b64_tr_b16 v[32:33], v4 offset:2048
    ds_read_b64_tr_b16 v[34:35], v4 offset:2560
    v_mfma_f32_32x32x16_bf16 v[192:207], v[16:19], v[52:55], v[192:207]
    ds_read_b64_tr_b16 v[36:37], v5 offset:2048
    s_waitcnt lgkmcnt(9)
    v_mfma_f32_32x32x16_bf16 v[144:159], v[20:23], v[48:51], v[144:159]
    ds_read_b64_tr_b16 v[38:39], v5 offset:2560
    v_mfma_f32_32x32x16_bf16 v[208:223], v[20:23], v[52:55], v[208:223]
    ds_read_b64_tr_b16 v[40:41], v4 offset:10240
    s_waitcnt lgkmcnt(9)
    v_mfma_f32_32x32x16_bf16 v[160:175], v[24:27], v[48:51], v[160:175]
    ds_read_b64_tr_b16 v[42:43], v4 offset:10752
    v_mfma_f32_32x32x16_bf16 v[224:239], v[24:27], v[52:55], v[224:239]
    ds_read_b64_tr_b16 v[44:45], v5 offset:10240
    s_waitcnt lgkmcnt(9)
    v_mfma_f32_32x32x16_bf16 v[176:191], v[28:31], v[48:51], v[176:191]
    ds_read_b64_tr_b16 v[46:47], v5 offset:10752
    v_mfma_f32_32x32x16_bf16 v[240:255], v[28:31], v[52:55], v[240:255]
    ds_read_b128 v[48:51], v8
    ds_read_b128 v[52:55], v8 offset:4096
    s_waitcnt lgkmcnt(8)
    v_mfma_f32_32x32x16_bf16 v[128:143], v[32:35], v[56:59], v[128:143]
    s_mov_b32 s5, 0x12600
    buffer_load_dword v100, v99, s[40:43], s5 offen
    ds_read_b64_tr_b16 v[16:17], v4 offset:4096
    ds_read_b64_tr_b16 v[18:19], v4 offset:4608
    v_mfma_f32_32x32x16_bf16 v[192:207], v[32:35], v[60:63], v[192:207]
    ds_read_b64_tr_b16 v[20:21], v5 offset:4096
    s_waitcnt lgkmcnt(9)
    v_mfma_f32_32x32x16_bf16 v[144:159], v[36:39], v[56:59], v[144:159]
    ds_read_b64_tr_b16 v[22:23], v5 offset:4608
    v_mfma_f32_32x32x16_bf16 v[208:223], v[36:39], v[60:63], v[208:223]
    ds_read_b64_tr_b16 v[24:25], v4 offset:12288
    s_waitcnt lgkmcnt(9)
    v_mfma_f32_32x32x16_bf16 v[160:175], v[40:43], v[56:59], v[160:175]
    ds_read_b64_tr_b16 v[26:27], v4 offset:12800
    v_mfma_f32_32x32x16_bf16 v[224:239], v[40:43], v[60:63], v[224:239]
    ds_read_b64_tr_b16 v[28:29], v5 offset:12288
    s_waitcnt lgkmcnt(9)
    v_mfma_f32_32x32x16_bf16 v[176:191], v[44:47], v[56:59], v[176:191]
    ds_read_b64_tr_b16 v[30:31], v5 offset:12800
    v_mfma_f32_32x32x16_bf16 v[240:255], v[44:47], v[60:63], v[240:255]
    ds_read_b32 v92, v95 offset:48
    ds_read_b128 v[56:59], v9
    s_waitcnt lgkmcnt(8)
    v_mfma_f32_32x32x16_bf16 v[128:143], v[16:19], v[48:51], v[128:143]
    ds_read_b128 v[60:63], v9 offset:4096
    ds_read_b64_tr_b16 v[32:33], v4 offset:6144
    v_mfma_f32_32x32x16_bf16 v[192:207], v[16:19], v[52:55], v[192:207]
    ds_read_b64_tr_b16 v[34:35], v4 offset:6656
    ds_read_b64_tr_b16 v[36:37], v5 offset:6144
    s_waitcnt lgkmcnt(10)
    v_mfma_f32_32x32x16_bf16 v[144:159], v[20:23], v[48:51], v[144:159]
    ds_read_b64_tr_b16 v[38:39], v5 offset:6656
    ds_read_b64_tr_b16 v[40:41], v4 offset:14336
    v_mfma_f32_32x32x16_bf16 v[208:223], v[20:23], v[52:55], v[208:223]
    ds_read_b64_tr_b16 v[42:43], v4 offset:14848
    s_waitcnt lgkmcnt(11)
    v_mfma_f32_32x32x16_bf16 v[160:175], v[24:27], v[48:51], v[160:175]
    ds_read_b64_tr_b16 v[44:45], v5 offset:14336
    v_mfma_f32_32x32x16_bf16 v[224:239], v[24:27], v[52:55], v[224:239]
    ds_read_b64_tr_b16 v[46:47], v5 offset:14848
    s_waitcnt lgkmcnt(11)
    v_mfma_f32_32x32x16_bf16 v[176:191], v[28:31], v[48:51], v[176:191]
    v_mov_b32 v93, 8
    s_mov_b64 exec, 1
    ds_write_b32 v94, v93 offset:64
    s_mov_b64 exec, -1
    s_waitcnt lgkmcnt(11)
    v_cmp_gt_u32 vcc, 7, v92
    v_mfma_f32_32x32x16_bf16 v[240:255], v[28:31], v[52:55], v[240:255]
    v_add_u32 v4, 0xfffe8000, v4
    v_add_u32 v5, 0xfffe8000, v5
    v_add_u32 v6, 0xfffe8000, v6
    v_add_u32 v7, 0xfffe8000, v7
    v_add_u32 v8, 0xfffe8000, v8
    v_add_u32 v9, 0xfffe8000, v9
    s_cbranch_vccz CW6_G
    s_mov_b32 s59, 0
CW6_P:
    ds_read_b32 v92, v95 offset:48
    s_add_u32 s59, s59, 1
    s_waitcnt lgkmcnt(0)
    v_cmp_gt_u32 vcc, 7, v92
    s_cmp_ge_u32 s59, 0x8000
    s_cbranch_scc1 CW6_G
    s_nop 4
    s_cbranch_vccnz CW6_P
CW6_G:
    ds_read_b128 v[48:51], v6
    s_waitcnt lgkmcnt(8)
    v_mfma_f32_32x32x16_bf16 v[128:143], v[32:35], v[56:59], v[128:143]
    ds_read_b128 v[52:55], v6 offset:4096
    v_mfma_f32_32x32x16_bf16 v[192:207], v[32:35], v[60:63], v[192:207]
    ds_read_b64_tr_b16 v[16:17], v4
    s_waitcnt lgkmcnt(8)
    v_mfma_f32_32x32x16_bf16 v[144:159], v[36:39], v[56:59], v[144:159]
    ds_read_b64_tr_b16 v[18:19], v4 offset:512
    v_mfma_f32_32x32x16_bf16 v[208:223], v[36:39], v[60:63], v[208:223]
    ds_read_b64_tr_b16 v[24:25], v4 offset:8192
    s_waitcnt lgkmcnt(8)
    v_mfma_f32_32x32x16_bf16 v[160:175], v[40:43], v[56:59], v[160:175]
    ds_read_b64_tr_b16 v[26:27], v4 offset:8704
    v_mfma_f32_32x32x16_bf16 v[224:239], v[40:43], v[60:63], v[224:239]
    s_waitcnt lgkmcnt(7)
    v_mfma_f32_32x32x16_bf16 v[176:191], v[44:47], v[56:59], v[176:191]
    v_mfma_f32_32x32x16_bf16 v[240:255], v[44:47], v[60:63], v[240:255]
    ds_read_b128 v[56:59], v7
    ds_read_b128 v[60:63], v7 offset:4096
    s_waitcnt lgkmcnt(4)
    v_mfma_f32_32x32x16_bf16 v[128:143], v[16:19], v[48:51], v[128:143]
    ds_read_b64_tr_b16 v[32:33], v4 offset:2048
    ds_read_b64_tr_b16 v[34:35], v4 offset:2560
    v_mfma_f32_32x32x16_bf16 v[192:207], v[16:19], v[52:55], v[192:207]
    ds_read_b64_tr_b16 v[40:41], v4 offset:10240
    s_waitcnt lgkmcnt(5)
    v_mfma_f32_32x32x16_bf16 v[160:175], v[24:27], v[48:51], v[160:175]
    ds_read_b64_tr_b16 v[42:43], v4 offset:10752
    v_mfma_f32_32x32x16_bf16 v[224:239], v[24:27], v[52:55], v[224:239]
    ds_read_b128 v[48:51], v8
    ds_read_b128 v[52:55], v8 offset:4096
    s_waitcnt lgkmcnt(4)
    v_mfma_f32_32x32x16_bf16 v[128:143], v[32:35], v[56:59], v[128:143]
    ds_read_b64_tr_b16 v[16:17], v4 offset:4096
    ds_read_b64_tr_b16 v[18:19], v4 offset:4608
    v_mfma_f32_32x32x16_bf16 v[192:207], v[32:35], v[60:63], v[192:207]
    ds_read_b64_tr_b16 v[24:25], v4 offset:12288
    s_waitcnt lgkmcnt(5)
    v_mfma_f32_32x32x16_bf16 v[160:175], v[40:43], v[56:59], v[160:175]
    ds_read_b64_tr_b16 v[26:27], v4 offset:12800
    v_mfma_f32_32x32x16_bf16 v[224:239], v[40:43], v[60:63], v[224:239]
    s_waitcnt vmcnt(0)
    v_and_b32 v95, 0xfffffff7, v95
    ds_read_b32 v92, v95 offset:112
    s_waitcnt lgkmcnt(3)
    v_mfma_f32_32x32x16_bf16 v[128:143], v[16:19], v[48:51], v[128:143]
    ds_read_b128 v[56:59], v9
    ds_read_b128 v[60:63], v9 offset:4096
    v_mfma_f32_32x32x16_bf16 v[192:207], v[16:19], v[52:55], v[192:207]
    ds_read_b64_tr_b16 v[32:33], v4 offset:6144
    ds_read_b64_tr_b16 v[34:35], v4 offset:6656
    s_waitcnt lgkmcnt(5)
    v_mfma_f32_32x32x16_bf16 v[160:175], v[24:27], v[48:51], v[160:175]
    ds_read_b64_tr_b16 v[40:41], v4 offset:14336
    ds_read_b64_tr_b16 v[42:43], v4 offset:14848
    s_waitcnt lgkmcnt(6)
    v_cmp_gt_u32 vcc, 1, v92
    v_mfma_f32_32x32x16_bf16 v[224:239], v[24:27], v[52:55], v[224:239]
    s_nop 3
    s_cbranch_vccz CWS_G
    s_mov_b32 s59, 0
CWS_P:
    ds_read_b32 v92, v95 offset:112
    s_add_u32 s59, s59, 1
    s_waitcnt lgkmcnt(0)
    v_cmp_gt_u32 vcc, 1, v92
    s_cmp_ge_u32 s59, 0x8000
    s_cbranch_scc1 CWS_G
    s_nop 4
    s_cbranch_vccnz CWS_P
CWS_G:
    ds_read_b128 v[48:51], v6
    ds_read_b128 v[52:55], v6 offset:4096
    s_waitcnt lgkmcnt(4)
    v_mfma_f32_32x32x16_bf16 v[128:143], v[32:35], v[56:59], v[128:143]
    v_and_b32 v12, 31, v1
    v_lshlrev_b32 v12, 3, v12
    s_lshl_b32 s59, s3, 9
    s_add_u32 s59, s59, 0x26800
    v_add_u32 v13, s59, v12
    ds_read_b64 v[64:65], v13
    ds_read_b64 v[66:67], v13 offset:256
    v_add_u32 v14, 0x27800, v12
    ds_read_b64 v[72:73], v14
    ds_read_b64 v[74:75], v14 offset:256
    ds_read_b64 v[76:77], v14 offset:512
    ds_read_b64 v[78:79], v14 offset:768
    ds_read_b64_tr_b16 v[20:21], v5
    ds_read_b64_tr_b16 v[22:23], v5 offset:512
    v_mfma_f32_32x32x16_bf16 v[192:207], v[32:35], v[60:63], v[192:207]
    ds_read_b64_tr_b16 v[28:29], v5 offset:8192
    s_waitcnt lgkmcnt(11)
    v_mfma_f32_32x32x16_bf16 v[160:175], v[40:43], v[56:59], v[160:175]
    ds_read_b64_tr_b16 v[30:31], v5 offset:8704
    v_mfma_f32_32x32x16_bf16 v[224:239], v[40:43], v[60:63], v[224:239]
    s_waitcnt lgkmcnt(8)
    s_mov_b32 vcc_lo, 0xffffffff
    s_mov_b32 vcc_hi, 0x0
    v_xor_b32 v12, 0x80000000, v64
    v_cndmask_b32 v12, 0, v12, vcc
    v_lshrrev_b32 v85, 16, v12
    v_or_b32 v84, v12, v85
    v_mov_b32 v86, 0
    v_mov_b32 v87, 0
    v_mul_f32 v68, v65, v65
    v_mul_f32 v69, v65, v65
    v_xor_b32 v12, 0x80000000, v66
    v_cndmask_b32 v12, 0, v12, vcc
    v_lshrrev_b32 v89, 16, v12
    v_or_b32 v88, v12, v89
    v_mov_b32 v90, 0
    v_mov_b32 v91, 0
    v_mul_f32 v70, v67, v67
    v_mul_f32 v71, v67, v67
    v_mov_b32 v80, 0
    v_mov_b32 v81, 0
    s_waitcnt lgkmcnt(4)
    v_mfma_f32_32x32x16_bf16 v[128:143], v[72:75], v[84:87], v[128:143]
    v_mfma_f32_32x32x16_bf16 v[192:207], v[72:75], v[88:91], v[192:207]
    v_mfma_f32_32x32x16_bf16 v[160:175], v[76:79], v[84:87], v[160:175]
    v_mfma_f32_32x32x16_bf16 v[224:239], v[76:79], v[88:91], v[224:239]
    s_setprio 3
    ds_read_b128 v[56:59], v7
    ds_read_b128 v[60:63], v7 offset:4096
    s_waitcnt lgkmcnt(4)
    v_mfma_f32_32x32x16_bf16 v[144:159], v[20:23], v[48:51], v[144:159]
    s_nop 5
    v_mul_f32 v160, v160, v68
    v_mul_f32 v161, v161, v68
    ds_read_b64_tr_b16 v[36:37], v5 offset:2048
    ds_read_b64_tr_b16 v[38:39], v5 offset:2560
    v_mfma_f32_32x32x16_bf16 v[208:223], v[20:23], v[52:55], v[208:223]
    v_max_f32 v128, 0, v128
    v_max_f32 v129, 0, v129
    v_mul_f32 v128, v128, v160
    v_mul_f32 v129, v129, v161
    v_cvt_pk_bf16_f32 v96, v128, v129
    v_mul_f32 v162, v162, v68
    ds_read_b64_tr_b16 v[44:45], v5 offset:10240
    s_waitcnt lgkmcnt(5)
    v_mfma_f32_32x32x16_bf16 v[176:191], v[28:31], v[48:51], v[176:191]
    v_mul_f32 v163, v163, v68
    v_max_f32 v130, 0, v130
    v_max_f32 v131, 0, v131
    v_mul_f32 v130, v130, v162
    v_mul_f32 v131, v131, v163
    v_cvt_pk_bf16_f32 v97, v130, v131
    ds_read_b64_tr_b16 v[46:47], v5 offset:10752
    v_mfma_f32_32x32x16_bf16 v[240:255], v[28:31], v[52:55], v[240:255]
    v_mul_f32 v164, v164, v68
    v_mul_f32 v165, v165, v68
    v_max_f32 v132, 0, v132
    v_max_f32 v133, 0, v133
    v_mul_f32 v132, v132, v164
    v_mul_f32 v133, v133, v165
    ds_read_b128 v[48:51], v8
    ds_read_b128 v[52:55], v8 offset:4096
    s_waitcnt lgkmcnt(4)
    v_mfma_f32_32x32x16_bf16 v[144:159], v[36:39], v[56:59], v[144:159]
    v_cvt_pk_bf16_f32 v98, v132, v133
    v_mul_f32 v166, v166, v68
    v_mul_f32 v167, v167, v68
    v_max_f32 v134, 0, v134
    v_max_f32 v135, 0, v135
    v_mul_f32 v134, v134, v166
    ds_read_b64_tr_b16 v[20:21], v5 offset:4096
    ds_read_b64_tr_b16 v[22:23], v5 offset:4608
    v_mfma_f32_32x32x16_bf16 v[208:223], v[36:39], v[60:63], v[208:223]
    v_mul_f32 v135, v135, v167
    v_cvt_pk_bf16_f32 v99, v134, v135
    v_permlane32_swap_b32 v96, v98
    s_nop 0
    v_permlane32_swap_b32 v97, v99
    buffer_store_dwordx4 v[96:99], v3, s[44:47], s4 offen sc1
    v_mul_f32 v168, v168, v68
    ds_read_b64_tr_b16 v[28:29], v5 offset:12288
    s_waitcnt lgkmcnt(5)
    v_mfma_f32_32x32x16_bf16 v[176:191], v[44:47], v[56:59], v[176:191]
    v_mul_f32 v169, v169, v68
    v_max_f32 v136, 0, v136
    v_max_f32 v137, 0, v137
    v_mul_f32 v136, v136, v168
    v_mul_f32 v137, v137, v169
    v_cvt_pk_bf16_f32 v100, v136, v137
    ds_read_b64_tr_b16 v[30:31], v5 offset:12800
    v_mfma_f32_32x32x16_bf16 v[240:255], v[44:47], v[60:63], v[240:255]
    v_mul_f32 v170, v170, v68
    v_mul_f32 v171, v171, v68
    v_max_f32 v138, 0, v138
    v_max_f32 v139, 0, v139
    v_mul_f32 v138, v138, v170
    v_mul_f32 v139, v139, v171
    ds_read_b128 v[56:59], v9
    ds_read_b128 v[60:63], v9 offset:4096
    s_waitcnt lgkmcnt(4)
    v_mfma_f32_32x32x16_bf16 v[144:159], v[20:23], v[48:51], v[144:159]
    v_cvt_pk_bf16_f32 v101, v138, v139
    v_mul_f32 v172, v172, v68
    v_mul_f32 v173, v173, v68
    v_max_f32 v140, 0, v140
    v_max_f32 v141, 0, v141
    v_mul_f32 v140, v140, v172
    ds_read_b64_tr_b16 v[36:37], v5 offset:6144
    ds_read_b64_tr_b16 v[38:39], v5 offset:6656
    v_mfma_f32_32x32x16_bf16 v[208:223], v[20:23], v[52:55], v[208:223]
    v_mul_f32 v141, v141, v173
    v_cvt_pk_bf16_f32 v102, v140, v141
    v_mul_f32 v174, v174, v68
    v_mul_f32 v175, v175, v68
    v_max_f32 v142, 0, v142
    v_max_f32 v143, 0, v143
    ds_read_b64_tr_b16 v[44:45], v5 offset:14336
    ds_read_b64_tr_b16 v[46:47], v5 offset:14848
    s_waitcnt lgkmcnt(6)
    v_mfma_f32_32x32x16_bf16 v[176:191], v[28:31], v[48:51], v[176:191]
    v_mul_f32 v142, v142, v174
    v_mul_f32 v143, v143, v175
    v_cvt_pk_bf16_f32 v103, v142, v143
    v_permlane32_swap_b32 v100, v102
    s_nop 0
    v_permlane32_swap_b32 v101, v103
    buffer_store_dwordx4 v[100:103], v3, s[44:47], s4 offen offset:1024 sc1
    v_mov_b32 v93, 9
    s_mov_b64 exec, 1
    ds_write_b32 v94, v93 offset:64
    s_mov_b64 exec, -1
    v_mfma_f32_32x32x16_bf16 v[240:255], v[28:31], v[52:55], v[240:255]
    v_mul_f32 v224, v224, v70
    v_mul_f32 v225, v225, v70
    v_max_f32 v192, 0, v192
    v_max_f32 v193, 0, v193
    v_mul_f32 v192, v192, v224
    v_mul_f32 v193, v193, v225
    s_waitcnt lgkmcnt(3)
    v_mfma_f32_32x32x16_bf16 v[144:159], v[36:39], v[56:59], v[144:159]
    v_cvt_pk_bf16_f32 v112, v192, v193
    v_mul_f32 v226, v226, v70
    v_mul_f32 v227, v227, v70
    v_max_f32 v194, 0, v194
    v_max_f32 v195, 0, v195
    v_mul_f32 v194, v194, v226
    v_mfma_f32_32x32x16_bf16 v[208:223], v[36:39], v[60:63], v[208:223]
    v_mul_f32 v195, v195, v227
    v_cvt_pk_bf16_f32 v113, v194, v195
    v_mul_f32 v228, v228, v70
    v_mul_f32 v229, v229, v70
    v_max_f32 v196, 0, v196
    v_max_f32 v197, 0, v197
    s_waitcnt lgkmcnt(1)
    v_mfma_f32_32x32x16_bf16 v[176:191], v[44:47], v[56:59], v[176:191]
    v_mul_f32 v196, v196, v228
    v_mul_f32 v197, v197, v229
    v_cvt_pk_bf16_f32 v114, v196, v197
    v_mul_f32 v230, v230, v70
    v_mul_f32 v231, v231, v70
    v_max_f32 v198, 0, v198
    v_mfma_f32_32x32x16_bf16 v[240:255], v[44:47], v[60:63], v[240:255]
    v_max_f32 v199, 0, v199
    v_mul_f32 v198, v198, v230
    v_mul_f32 v199, v199, v231
    v_cvt_pk_bf16_f32 v115, v198, v199
    v_permlane32_swap_b32 v112, v114
    s_nop 0
    v_permlane32_swap_b32 v113, v115
    s_setprio 3
    v_mfma_f32_32x32x16_bf16 v[144:159], v[74:77], v[84:87], v[144:159]
    v_mfma_f32_32x32x16_bf16 v[208:223], v[74:77], v[88:91], v[208:223]
    v_mfma_f32_32x32x16_bf16 v[176:191], v[78:81], v[84:87], v[176:191]
    v_mfma_f32_32x32x16_bf16 v[240:255], v[78:81], v[88:91], v[240:255]
    s_add_u32 s59, s4, 0x1c000
    buffer_store_dwordx4 v[112:115], v3, s[44:47], s59 offen sc1
    v_mul_f32 v232, v232, v70
    v_mul_f32 v233, v233, v70
    v_max_f32 v200, 0, v200
    v_max_f32 v201, 0, v201
    v_mul_f32 v200, v200, v232
    v_mul_f32 v201, v201, v233
    v_cvt_pk_bf16_f32 v116, v200, v201
    v_mul_f32 v234, v234, v70
    v_mul_f32 v235, v235, v70
    v_max_f32 v202, 0, v202
    v_max_f32 v203, 0, v203
    v_mul_f32 v202, v202, v234
    v_mul_f32 v203, v203, v235
    v_cvt_pk_bf16_f32 v117, v202, v203
    v_mul_f32 v236, v236, v70
    v_mul_f32 v237, v237, v70
    v_max_f32 v204, 0, v204
    v_max_f32 v205, 0, v205
    v_mul_f32 v204, v204, v236
    v_mul_f32 v205, v205, v237
    v_cvt_pk_bf16_f32 v118, v204, v205
    v_mul_f32 v238, v238, v70
    v_mul_f32 v239, v239, v70
    v_max_f32 v206, 0, v206
    v_max_f32 v207, 0, v207
    v_mul_f32 v206, v206, v238
    v_mul_f32 v207, v207, v239
    v_cvt_pk_bf16_f32 v119, v206, v207
    v_permlane32_swap_b32 v116, v118
    s_nop 0
    v_permlane32_swap_b32 v117, v119
    s_add_u32 s59, s4, 0x1c000
    buffer_store_dwordx4 v[116:119], v3, s[44:47], s59 offen offset:1024 sc1
    v_pk_mul_f32 v[176:177], v[176:177], v[68:69]
    v_max_f32 v144, 0, v144
    v_max_f32 v145, 0, v145
    v_pk_mul_f32 v[144:145], v[144:145], v[176:177]
    v_cvt_pk_bf16_f32 v104, v144, v145
    v_pk_mul_f32 v[178:179], v[178:179], v[68:69]
    v_max_f32 v146, 0, v146
    v_max_f32 v147, 0, v147
    v_pk_mul_f32 v[146:147], v[146:147], v[178:179]
    v_cvt_pk_bf16_f32 v105, v146, v147
    v_pk_mul_f32 v[180:181], v[180:181], v[68:69]
    v_max_f32 v148, 0, v148
    v_max_f32 v149, 0, v149
    v_pk_mul_f32 v[148:149], v[148:149], v[180:181]
    v_cvt_pk_bf16_f32 v106, v148, v149
    v_pk_mul_f32 v[182:183], v[182:183], v[68:69]
    v_max_f32 v150, 0, v150
    v_max_f32 v151, 0, v151
    v_pk_mul_f32 v[150:151], v[150:151], v[182:183]
    v_cvt_pk_bf16_f32 v107, v150, v151
    v_permlane32_swap_b32 v104, v106
    s_nop 0
    v_permlane32_swap_b32 v105, v107
    buffer_store_dwordx4 v[104:107], v3, s[44:47], s4 offen offset:2048 sc1
    v_pk_mul_f32 v[184:185], v[184:185], v[68:69]
    v_max_f32 v152, 0, v152
    v_max_f32 v153, 0, v153
    v_pk_mul_f32 v[152:153], v[152:153], v[184:185]
    v_cvt_pk_bf16_f32 v108, v152, v153
    v_pk_mul_f32 v[186:187], v[186:187], v[68:69]
    v_max_f32 v154, 0, v154
    v_max_f32 v155, 0, v155
    v_pk_mul_f32 v[154:155], v[154:155], v[186:187]
    v_cvt_pk_bf16_f32 v109, v154, v155
    v_pk_mul_f32 v[188:189], v[188:189], v[68:69]
    v_max_f32 v156, 0, v156
    v_max_f32 v157, 0, v157
    v_pk_mul_f32 v[156:157], v[156:157], v[188:189]
    v_cvt_pk_bf16_f32 v110, v156, v157
    v_pk_mul_f32 v[190:191], v[190:191], v[68:69]
    v_max_f32 v158, 0, v158
    v_max_f32 v159, 0, v159
    v_pk_mul_f32 v[158:159], v[158:159], v[190:191]
    v_cvt_pk_bf16_f32 v111, v158, v159
    v_permlane32_swap_b32 v108, v110
    s_nop 0
    v_permlane32_swap_b32 v109, v111
    buffer_store_dwordx4 v[108:111], v3, s[44:47], s4 offen offset:3072 sc1
    v_pk_mul_f32 v[240:241], v[240:241], v[70:71]
    v_max_f32 v208, 0, v208
    v_max_f32 v209, 0, v209
    v_pk_mul_f32 v[208:209], v[208:209], v[240:241]
    v_cvt_pk_bf16_f32 v120, v208, v209
    v_pk_mul_f32 v[242:243], v[242:243], v[70:71]
    v_max_f32 v210, 0, v210
    v_max_f32 v211, 0, v211
    v_pk_mul_f32 v[210:211], v[210:211], v[242:243]
    v_cvt_pk_bf16_f32 v121, v210, v211
    v_pk_mul_f32 v[244:245], v[244:245], v[70:71]
    v_max_f32 v212, 0, v212
    v_max_f32 v213, 0, v213
    v_pk_mul_f32 v[212:213], v[212:213], v[244:245]
    v_cvt_pk_bf16_f32 v122, v212, v213
    v_pk_mul_f32 v[246:247], v[246:247], v[70:71]
    v_max_f32 v214, 0, v214
    v_max_f32 v215, 0, v215
    v_pk_mul_f32 v[214:215], v[214:215], v[246:247]
    v_cvt_pk_bf16_f32 v123, v214, v215
    v_permlane32_swap_b32 v120, v122
    s_nop 0
    v_permlane32_swap_b32 v121, v123
    s_add_u32 s59, s4, 0x1c000
    buffer_store_dwordx4 v[120:123], v3, s[44:47], s59 offen offset:2048 sc1
    v_pk_mul_f32 v[248:249], v[248:249], v[70:71]
    v_max_f32 v216, 0, v216
    v_max_f32 v217, 0, v217
    v_pk_mul_f32 v[216:217], v[216:217], v[248:249]
    v_cvt_pk_bf16_f32 v124, v216, v217
    v_pk_mul_f32 v[250:251], v[250:251], v[70:71]
    v_max_f32 v218, 0, v218
    v_max_f32 v219, 0, v219
    v_pk_mul_f32 v[218:219], v[218:219], v[250:251]
    v_cvt_pk_bf16_f32 v125, v218, v219
    v_pk_mul_f32 v[252:253], v[252:253], v[70:71]
    v_max_f32 v220, 0, v220
    v_max_f32 v221, 0, v221
    v_pk_mul_f32 v[220:221], v[220:221], v[252:253]
    v_cvt_pk_bf16_f32 v126, v220, v221
    v_pk_mul_f32 v[254:255], v[254:255], v[70:71]
    v_max_f32 v222, 0, v222
    v_max_f32 v223, 0, v223
    v_pk_mul_f32 v[222:223], v[222:223], v[254:255]
    v_cvt_pk_bf16_f32 v127, v222, v223
    v_permlane32_swap_b32 v124, v126
    s_nop 0
    v_permlane32_swap_b32 v125, v127
    s_add_u32 s59, s4, 0x1c000
    buffer_store_dwordx4 v[124:127], v3, s[44:47], s59 offen offset:3072 sc1
    v_and_b32 v12, 7, v1
    v_lshlrev_b32 v12, 2, v12
    v_add_u32 v12, 0x27c00, v12
    s_mov_b32 s59, 0
LW_1_P:
    ds_read_b32 v13, v12 offset:64
    s_add_u32 s59, s59, 1
    s_waitcnt lgkmcnt(0)
    v_cmp_gt_u32 vcc, 8, v13
    s_cmp_ge_u32 s59, 0x8000
    s_cbranch_scc1 LW_1_G
    s_nop 2
    s_cbranch_vccnz LW_1_P
LW_1_G:
    s_add_u32 s61, s67, 6
    s_sub_u32 s59, s61, 20
    s_cmp_ge_u32 s61, 20
    s_cselect_b32 s61, s59, s61
    s_mul_i32 s59, s57, 20
    s_add_u32 s61, s61, s59
    s_mul_i32 s61, s61, 0x3800
    s_add_u32 m0, s58, 0x18000
    s_nop 0
    buffer_load_dwordx4 v0, s[40:43], s61 offen lds
    s_add_u32 s61, s61, 0x1c00
    s_add_u32 m0, s58, 0x18400
    s_nop 0
    buffer_load_dwordx4 v0, s[40:43], s61 offen lds
    s_add_u32 s61, s67, 7
    s_sub_u32 s59, s61, 20
    s_cmp_ge_u32 s61, 20
    s_cselect_b32 s61, s59, s61
    s_mul_i32 s59, s57, 20
    s_add_u32 s61, s61, s59
    s_mul_i32 s61, s61, 0x3800
    s_add_u32 m0, s58, 0x1a000
    s_nop 0
    buffer_load_dwordx4 v0, s[40:43], s61 offen lds
    s_add_u32 s61, s61, 0x1c00
    s_add_u32 m0, s58, 0x1a400
    s_nop 0
    buffer_load_dwordx4 v0, s[40:43], s61 offen lds
    s_add_u32 s61, s67, 8
    s_sub_u32 s59, s61, 20
    s_cmp_ge_u32 s61, 20
    s_cselect_b32 s61, s59, s61
    s_mul_i32 s59, s57, 20
    s_add_u32 s61, s61, s59
    s_mul_i32 s61, s61, 0x3800
    s_add_u32 m0, s58, 0x1c000
    s_nop 0
    buffer_load_dwordx4 v0, s[40:43], s61 offen lds
    s_add_u32 s61, s61, 0x1c00
    s_add_u32 m0, s58, 0x1c400
    s_nop 0
    buffer_load_dwordx4 v0, s[40:43], s61 offen lds
    v_bfe_u32 v13, v1, 2, 2
    v_bfe_u32 v4, v1, 4, 1
    v_lshlrev_b32 v4, 5, v4
    v_and_b32 v12, 3, v1
    v_lshl_add_u32 v4, v12, 3, v4
    v_lshl_add_u32 v4, v13, 7, v4
    v_lshrrev_b32 v13, 1, v13
    v_lshl_add_u32 v4, v13, 6, v4
    v_lshrrev_b32 v12, 5, v1
    v_lshl_add_u32 v4, v12, 10, v4
    v_add_u32 v4, s58, v4
    v_xor_b32 v5, 64, v4
    v_add_u32 v7, s58, v3
    v_bfe_u32 v13, v1, 2, 2
    v_bfe_u32 v14, v1, 4, 1
    v_lshlrev_b32 v14, 6, v14
    v_and_b32 v12, 3, v1
    v_lshl_add_u32 v14, v12, 4, v14
    v_lshrrev_b32 v12, 1, v13
    v_lshlrev_b32 v12, 6, v12
    v_xor_b32 v14, v14, v12
    v_lshl_add_u32 v14, v13, 7, v14
    v_lshrrev_b32 v12, 5, v1
    v_lshl_add_u32 v14, v12, 10, v14
    s_add_u32 s59, s58, 0xa000
    v_add_u32 v6, s59, v14
    v_lshrrev_b32 v12, 4, v1
    v_lshlrev_b32 v2, 13, v12
    v_bfe_u32 v13, v1, 3, 1
    v_lshl_add_u32 v2, v13, 7, v2
    v_lshlrev_b32 v12, 2, v12
    v_and_b32 v12, 4, v12
    v_and_b32 v13, 7, v1
    v_xor_b32 v13, v13, v12
    v_lshl_add_u32 v2, v13, 4, v2
    v_bfe_u32 v12, v1, 3, 2
    v_lshrrev_b32 v13, 5, v1
    v_lshl_add_u32 v12, v12, 6, v13
    v_mul_u32_u24 v12, 0x380, v12
    v_and_b32 v13, 7, v1
    v_lshl_add_u32 v12, v13, 4, v12
    s_lshl_b32 s59, s55, 8
    s_lshr_b32 s60, s52, 1
    s_lshl_b32 s60, s60, 4
    s_add_u32 s59, s59, s60
    s_lshl_b32 s60, s3, 1
    s_add_u32 s59, s59, s60
    s_mul_i32 s59, s59, 0x380
    s_lshl_b32 s60, s54, 7
    s_add_u32 s59, s59, s60
    v_add_u32 v8, s59, v12
    v_lshrrev_b32 v12, 3, v1
    s_lshl_b32 s59, s57, 3
    v_add_u32 v12, s59, v12
    v_lshlrev_b32 v14, 1, v13
    v_xor_b32 v12, v12, v14
    v_lshlrev_b32 v9, 4, v12
    v_and_b32 v12, 1, v1
    v_lshl_add_u32 v9, v12, 10, v9
    v_bfe_u32 v12, v1, 1, 1
    v_lshl_add_u32 v9, v12, 13, v9
    v_bfe_u32 v12, v1, 2, 1
    v_lshl_add_u32 v9, v12, 15, v9
    v_add_u32 v9, 0xc000, v9
    s_lshr_b32 s59, s52, 1
    s_lshl_b32 s59, s59, 4
    s_add_u32 s59, s59, s55
    s_mul_i32 s101, s59, 0x1c000
    s_mov_b32 s12, 0x36124925
    s_mov_b32 s13, 0xb6124925
    s_mul_i32 s59, s57, 24
    v_lshrrev_b32 v254, 5, v1
    v_lshl_add_u32 v254, v254, 2, s59
    v_cvt_f32_u32 v254, v254
    s_lshl_b32 s59, s54, 6
    v_and_b32 v252, 31, v1
    v_add_u32 v252, s59, v252
    v_cvt_f32_u32 v252, v252
    v_add_f32 v253, 0x42000000, v252
    v_mul_f32 v238, v252, v254
    v_mul_f32 v255, 0x3b124925, v238
    v_floor_f32 v255, v255
    v_fmamk_f32 v238, v255, 0xc3e00000, v238
    v_mul_f32 v238, 0x3b124925, v238
    v_cos_f32 v236, v238
    v_sin_f32 v237, v238
    v_mul_f32 v238, 0x3b124925, v252
    v_cos_f32 v240, v238
    v_sin_f32 v241, v238
    v_mul_f32 v238, 0x3c924925, v252
    v_cos_f32 v242, v238
    v_sin_f32 v243, v238
    v_pk_mul_f32 v[236:237], v[236:237], s[12:13]
    v_mul_f32 v246, v253, v254
    v_mul_f32 v255, 0x3b124925, v246
    v_floor_f32 v255, v255
    v_fmamk_f32 v246, v255, 0xc3e00000, v246
    v_mul_f32 v246, 0x3b124925, v246
    v_cos_f32 v244, v246
    v_sin_f32 v245, v246
    v_mul_f32 v246, 0x3b124925, v253
    v_cos_f32 v248, v246
    v_sin_f32 v249, v246
    v_mul_f32 v246, 0x3c924925, v253
    v_cos_f32 v250, v246
    v_sin_f32 v251, v246
    v_pk_mul_f32 v[244:245], v[244:245], s[12:13]
    v_cvt_pk_bf16_f32 v208, v236, v237
    v_cvt_pk_bf16_f32 v212, v244, v245
    s_cmp_eq_u32 s57, 0
    s_cselect_b32 vcc_lo, -1, 0
    s_mov_b32 vcc_hi, 0
    v_lshlrev_b32 v252, 31, v1
    v_or_b32 v252, 0x35923592, v252
    v_cndmask_b32 v208, v208, v252, vcc
    v_cndmask_b32 v212, v212, v252, vcc
    v_pk_mul_f32 v[252:253], v[236:237], v[240:241] op_sel_hi:[1,0]
    v_pk_mul_f32 v[254:255], v[244:245], v[248:249] op_sel_hi:[1,0]
    v_pk_fma_f32 v[238:239], v[236:237], v[240:241], v[252:253] op_sel:[1,1,0] op_sel_hi:[0,1,1] neg_hi:[0,1,0]
    v_pk_fma_f32 v[246:247], v[244:245], v[248:249], v[254:255] op_sel:[1,1,0] op_sel_hi:[0,1,1] neg_hi:[0,1,0]
    v_cvt_pk_bf16_f32 v209, v238, v239
    v_cvt_pk_bf16_f32 v213, v246, v247
    v_pk_mul_f32 v[252:253], v[238:239], v[240:241] op_sel_hi:[1,0]
    v_pk_mul_f32 v[254:255], v[246:247], v[248:249] op_sel_hi:[1,0]
    v_pk_fma_f32 v[238:239], v[238:239], v[240:241], v[252:253] op_sel:[1,1,0] op_sel_hi:[0,1,1] neg_hi:[0,1,0]
    v_pk_fma_f32 v[246:247], v[246:247], v[248:249], v[254:255] op_sel:[1,1,0] op_sel_hi:[0,1,1] neg_hi:[0,1,0]
    v_cvt_pk_bf16_f32 v210, v238, v239
    v_cvt_pk_bf16_f32 v214, v246, v247
    v_pk_mul_f32 v[252:253], v[238:239], v[240:241] op_sel_hi:[1,0]
    v_pk_mul_f32 v[254:255], v[246:247], v[248:249] op_sel_hi:[1,0]
    v_pk_fma_f32 v[238:239], v[238:239], v[240:241], v[252:253] op_sel:[1,1,0] op_sel_hi:[0,1,1] neg_hi:[0,1,0]
    v_pk_fma_f32 v[246:247], v[246:247], v[248:249], v[254:255] op_sel:[1,1,0] op_sel_hi:[0,1,1] neg_hi:[0,1,0]
    v_cvt_pk_bf16_f32 v211, v238, v239
    v_cvt_pk_bf16_f32 v215, v246, v247
    v_pk_mul_f32 v[252:253], v[236:237], v[242:243] op_sel_hi:[1,0]
    v_pk_mul_f32 v[254:255], v[244:245], v[250:251] op_sel_hi:[1,0]
    v_pk_fma_f32 v[236:237], v[236:237], v[242:243], v[252:253] op_sel:[1,1,0] op_sel_hi:[0,1,1] neg_hi:[0,1,0]
    v_pk_fma_f32 v[244:245], v[244:245], v[250:251], v[254:255] op_sel:[1,1,0] op_sel_hi:[0,1,1] neg_hi:[0,1,0]
    v_cvt_pk_bf16_f32 v216, v236, v237
    v_cvt_pk_bf16_f32 v220, v244, v245
    v_pk_mul_f32 v[252:253], v[236:237], v[240:241] op_sel_hi:[1,0]
    v_pk_mul_f32 v[254:255], v[244:245], v[248:249] op_sel_hi:[1,0]
    v_pk_fma_f32 v[238:239], v[236:237], v[240:241], v[252:253] op_sel:[1,1,0] op_sel_hi:[0,1,1] neg_hi:[0,1,0]
    v_pk_fma_f32 v[246:247], v[244:245], v[248:249], v[254:255] op_sel:[1,1,0] op_sel_hi:[0,1,1] neg_hi:[0,1,0]
    v_cvt_pk_bf16_f32 v217, v238, v239
    v_cvt_pk_bf16_f32 v221, v246, v247
    s_lshl_b32 s59, s55, 2
    s_add_u32 s59, s59, s3
    s_mul_i32 s59, s59, 28
    s_add_u32 s59, s59, s56
    s_lshl_b32 s59, s59, 7
    s_add_u32 s59, s59, 0xe80000
    v_mov_b32 v12, 0
    v_mov_b32 v13, 1
    s_waitcnt vmcnt(6)
    s_mov_b64 exec, 1
    buffer_store_dword v13, v12, s[44:47], s59 offen sc1
    s_mov_b64 exec, -1
    s_setprio 0
    v_and_b32 v12, 3, v1
    v_lshlrev_b32 v12, 2, v12
    v_add_u32 v12, 0x27c00, v12
    s_mov_b32 s59, 0
    s_branch LW_2_P0
LW_2_P:
    s_sleep 1
LW_2_P0:
    ds_read_b32 v13, v12 offset:160
    s_add_u32 s59, s59, 1
    s_waitcnt lgkmcnt(0)
    v_cmp_gt_u32 vcc, 1, v13
    s_cmp_ge_u32 s59, 0x8000
    s_cbranch_scc1 LW_2_G
    s_nop 2
    s_cbranch_vccnz LW_2_P
LW_2_G:
    s_add_u32 s61, s67, 9
    s_sub_u32 s59, s61, 20
    s_cmp_ge_u32 s61, 20
    s_cselect_b32 s61, s59, s61
    s_mul_i32 s59, s57, 20
    s_add_u32 s61, s61, s59
    s_mul_i32 s61, s61, 0x3800
    s_add_u32 m0, s58, 0x1e000
    s_nop 0
    buffer_load_dwordx4 v0, s[40:43], s61 offen lds
    s_add_u32 s61, s61, 0x1c00
    s_add_u32 m0, s58, 0x1e400
    s_nop 0
    buffer_load_dwordx4 v0, s[40:43], s61 offen lds
    s_add_u32 s61, s67, 10
    s_sub_u32 s59, s61, 20
    s_cmp_ge_u32 s61, 20
    s_cselect_b32 s61, s59, s61
    s_mul_i32 s59, s57, 20
    s_add_u32 s61, s61, s59
    s_mul_i32 s61, s61, 0x3800
    s_add_u32 m0, s58, 0x20000
    s_nop 0
    buffer_load_dwordx4 v0, s[40:43], s61 offen lds
    s_add_u32 s61, s61, 0x1c00
    s_add_u32 m0, s58, 0x20400
    s_nop 0
    buffer_load_dwordx4 v0, s[40:43], s61 offen lds
    s_add_u32 s61, s67, 11
    s_sub_u32 s59, s61, 20
    s_cmp_ge_u32 s61, 20
    s_cselect_b32 s61, s59, s61
    s_mul_i32 s59, s57, 20
    s_add_u32 s61, s61, s59
    s_mul_i32 s61, s61, 0x3800
    s_add_u32 m0, s58, 0x22000
    s_nop 0
    buffer_load_dwordx4 v0, s[40:43], s61 offen lds
    s_add_u32 s61, s61, 0x1c00
    s_add_u32 m0, s58, 0x22400
    s_nop 0
    buffer_load_dwordx4 v0, s[40:43], s61 offen lds
    v_and_b32 v12, 7, v1
    v_lshlrev_b32 v12, 2, v12
    v_add_u32 v12, 0x27c00, v12
    s_mov_b32 s59, 0
LW_3_P:
    ds_read_b32 v13, v12 offset:64
    s_add_u32 s59, s59, 1
    s_waitcnt lgkmcnt(0)
    v_cmp_gt_u32 vcc, 9, v13
    s_cmp_ge_u32 s59, 0x8000
    s_cbranch_scc1 LW_3_G
    s_nop 2
    s_cbranch_vccnz LW_3_P
LW_3_G:
    s_add_u32 s61, s67, 12
    s_sub_u32 s59, s61, 20
    s_cmp_ge_u32 s61, 20
    s_cselect_b32 s61, s59, s61
    s_mul_i32 s59, s57, 20
    s_add_u32 s61, s61, s59
    s_mul_i32 s61, s61, 0x3800
    s_add_u32 m0, s58, 0
    s_nop 0
    buffer_load_dwordx4 v0, s[40:43], s61 offen lds
    s_add_u32 s61, s61, 0x1c00
    s_add_u32 m0, s58, 0x400
    s_nop 0
    buffer_load_dwordx4 v0, s[40:43], s61 offen lds
    s_add_u32 s61, s67, 13
    s_sub_u32 s59, s61, 20
    s_cmp_ge_u32 s61, 20
    s_cselect_b32 s61, s59, s61
    s_mul_i32 s59, s57, 20
    s_add_u32 s61, s61, s59
    s_mul_i32 s61, s61, 0x3800
    s_add_u32 m0, s58, 0x2000
    s_nop 0
    buffer_load_dwordx4 v0, s[40:43], s61 offen lds
    s_add_u32 s61, s61, 0x1c00
    s_add_u32 m0, s58, 0x2400
    s_nop 0
    buffer_load_dwordx4 v0, s[40:43], s61 offen lds
    s_add_u32 s61, s67, 14
    s_sub_u32 s59, s61, 20
    s_cmp_ge_u32 s61, 20
    s_cselect_b32 s61, s59, s61
    s_mul_i32 s59, s57, 20
    s_add_u32 s61, s61, s59
    s_mul_i32 s61, s61, 0x3800
    s_add_u32 m0, s58, 0x4000
    s_nop 0
    buffer_load_dwordx4 v0, s[40:43], s61 offen lds
    s_add_u32 s61, s61, 0x1c00
    s_add_u32 m0, s58, 0x4400
    s_nop 0
    buffer_load_dwordx4 v0, s[40:43], s61 offen lds
    s_add_u32 s61, s67, 15
    s_sub_u32 s59, s61, 20
    s_cmp_ge_u32 s61, 20
    s_cselect_b32 s61, s59, s61
    s_mul_i32 s59, s57, 20
    s_add_u32 s61, s61, s59
    s_mul_i32 s61, s61, 0x3800
    s_add_u32 m0, s58, 0x6000
    s_nop 0
    buffer_load_dwordx4 v0, s[40:43], s61 offen lds
    s_add_u32 s61, s61, 0x1c00
    s_add_u32 m0, s58, 0x6400
    s_nop 0
    buffer_load_dwordx4 v0, s[40:43], s61 offen lds
    v_lshrrev_b32 v13, 1, v1
    v_min_u32 v13, 4, v13
    v_and_b32 v12, 1, v1
    v_mul_u32_u24 v12, 0x70, v12
    v_add_u32 v12, v12, v13
    v_lshlrev_b32 v11, 7, v12
    s_and_b32 s59, s52, 6
    s_lshl_b32 s59, s59, 2
    s_lshr_b32 s60, s55, 1
    s_add_u32 s59, s59, s60
    s_mul_i32 s59, s59, 28
    s_mul_i32 s60, s57, 5
    s_add_u32 s59, s59, s60
    s_lshl_b32 s59, s59, 7
    s_add_u32 s63, s59, 0xe80000
    buffer_load_dword v10, v11, s[44:47], s63 offen sc1
    s_add_u32 s61, s67, 16
    s_sub_u32 s59, s61, 20
    s_cmp_ge_u32 s61, 20
    s_cselect_b32 s61, s59, s61
    s_mul_i32 s59, s57, 20
    s_add_u32 s61, s61, s59
    s_mul_i32 s61, s61, 0x3800
    buffer_load_dwordx4 v[96:99], v0, s[40:43], s61 offen
    s_add_u32 s61, s61, 0x1c00
    buffer_load_dwordx4 v[100:103], v0, s[40:43], s61 offen
    s_add_u32 s61, s67, 17
    s_sub_u32 s59, s61, 20
    s_cmp_ge_u32 s61, 20
    s_cselect_b32 s61, s59, s61
    s_mul_i32 s59, s57, 20
    s_add_u32 s61, s61, s59
    s_mul_i32 s61, s61, 0x3800
    buffer_load_dwordx4 v[104:107], v0, s[40:43], s61 offen
    s_add_u32 s61, s61, 0x1c00
    buffer_load_dwordx4 v[108:111], v0, s[40:43], s61 offen
    s_add_u32 s61, s67, 18
    s_sub_u32 s59, s61, 20
    s_cmp_ge_u32 s61, 20
    s_cselect_b32 s61, s59, s61
    s_mul_i32 s59, s57, 20
    s_add_u32 s61, s61, s59
    s_mul_i32 s61, s61, 0x3800
    buffer_load_dwordx4 v[112:115], v0, s[40:43], s61 offen
    s_add_u32 s61, s61, 0x1c00
    buffer_load_dwordx4 v[116:119], v0, s[40:43], s61 offen
    s_add_u32 s61, s67, 19
    s_sub_u32 s59, s61, 20
    s_cmp_ge_u32 s61, 20
    s_cselect_b32 s61, s59, s61
    s_mul_i32 s59, s57, 20
    s_add_u32 s61, s61, s59
    s_mul_i32 s61, s61, 0x3800
    buffer_load_dwordx4 v[120:123], v0, s[40:43], s61 offen
    s_add_u32 s61, s61, 0x1c00
    buffer_load_dwordx4 v[124:127], v0, s[40:43], s61 offen
    v_pk_mul_f32 v[252:253], v[238:239], v[240:241] op_sel_hi:[1,0]
    v_pk_mul_f32 v[254:255], v[246:247], v[248:249] op_sel_hi:[1,0]
    v_pk_fma_f32 v[238:239], v[238:239], v[240:241], v[252:253] op_sel:[1,1,0] op_sel_hi:[0,1,1] neg_hi:[0,1,0]
    v_pk_fma_f32 v[246:247], v[246:247], v[248:249], v[254:255] op_sel:[1,1,0] op_sel_hi:[0,1,1] neg_hi:[0,1,0]
    v_cvt_pk_bf16_f32 v218, v238, v239
    v_cvt_pk_bf16_f32 v222, v246, v247
    v_pk_mul_f32 v[252:253], v[238:239], v[240:241] op_sel_hi:[1,0]
    v_pk_mul_f32 v[254:255], v[246:247], v[248:249] op_sel_hi:[1,0]
    v_pk_fma_f32 v[238:239], v[238:239], v[240:241], v[252:253] op_sel:[1,1,0] op_sel_hi:[0,1,1] neg_hi:[0,1,0]
    v_pk_fma_f32 v[246:247], v[246:247], v[248:249], v[254:255] op_sel:[1,1,0] op_sel_hi:[0,1,1] neg_hi:[0,1,0]
    v_cvt_pk_bf16_f32 v219, v238, v239
    v_cvt_pk_bf16_f32 v223, v246, v247
    v_pk_mul_f32 v[252:253], v[236:237], v[242:243] op_sel_hi:[1,0]
    v_pk_mul_f32 v[254:255], v[244:245], v[250:251] op_sel_hi:[1,0]
    v_pk_fma_f32 v[236:237], v[236:237], v[242:243], v[252:253] op_sel:[1,1,0] op_sel_hi:[0,1,1] neg_hi:[0,1,0]
    v_pk_fma_f32 v[244:245], v[244:245], v[250:251], v[254:255] op_sel:[1,1,0] op_sel_hi:[0,1,1] neg_hi:[0,1,0]
    v_cvt_pk_bf16_f32 v224, v236, v237
    v_cvt_pk_bf16_f32 v228, v244, v245
    v_pk_mul_f32 v[252:253], v[236:237], v[240:241] op_sel_hi:[1,0]
    v_pk_mul_f32 v[254:255], v[244:245], v[248:249] op_sel_hi:[1,0]
    v_pk_fma_f32 v[238:239], v[236:237], v[240:241], v[252:253] op_sel:[1,1,0] op_sel_hi:[0,1,1] neg_hi:[0,1,0]
    v_pk_fma_f32 v[246:247], v[244:245], v[248:249], v[254:255] op_sel:[1,1,0] op_sel_hi:[0,1,1] neg_hi:[0,1,0]
    v_cvt_pk_bf16_f32 v225, v238, v239
    v_cvt_pk_bf16_f32 v229, v246, v247
    v_pk_mul_f32 v[252:253], v[238:239], v[240:241] op_sel_hi:[1,0]
    v_pk_mul_f32 v[254:255], v[246:247], v[248:249] op_sel_hi:[1,0]
    v_pk_fma_f32 v[238:239], v[238:239], v[240:241], v[252:253] op_sel:[1,1,0] op_sel_hi:[0,1,1] neg_hi:[0,1,0]
    v_pk_fma_f32 v[246:247], v[246:247], v[248:249], v[254:255] op_sel:[1,1,0] op_sel_hi:[0,1,1] neg_hi:[0,1,0]
    v_cvt_pk_bf16_f32 v226, v238, v239
    v_cvt_pk_bf16_f32 v230, v246, v247
    v_pk_mul_f32 v[252:253], v[238:239], v[240:241] op_sel_hi:[1,0]
    v_pk_mul_f32 v[254:255], v[246:247], v[248:249] op_sel_hi:[1,0]
    v_pk_fma_f32 v[238:239], v[238:239], v[240:241], v[252:253] op_sel:[1,1,0] op_sel_hi:[0,1,1] neg_hi:[0,1,0]
    v_pk_fma_f32 v[246:247], v[246:247], v[248:249], v[254:255] op_sel:[1,1,0] op_sel_hi:[0,1,1] neg_hi:[0,1,0]
    v_cvt_pk_bf16_f32 v227, v238, v239
    v_cvt_pk_bf16_f32 v231, v246, v247
    s_waitcnt vmcnt(8)
    v_cmp_ne_u32 vcc, 1, v10
    s_nop 4
    s_cbranch_vccz G2Hc_G
G2Hc_P:
    s_add_u32 s66, s66, 1
    buffer_load_dword v10, v11, s[44:47], s63 offen sc1
    s_waitcnt vmcnt(0)
    v_cmp_ne_u32 vcc, 1, v10
    s_nop 4
    s_nop 4
    s_cbranch_vccz G2Hc_G
    s_cmp_ge_u32 s66, 0xfa0
    s_cbranch_scc1 G2Hc_G
    s_sleep 1
    s_branch G2Hc_P
G2Hc_G:
    s_add_u32 s61, s67, 0
    s_sub_u32 s59, s61, 20
    s_cmp_ge_u32 s61, 20
    s_cselect_b32 s61, s59, s61
    s_mul_i32 s59, s57, 20
    s_add_u32 s61, s61, s59
    s_lshl_b32 s61, s61, 10
    s_add_u32 s61, s61, s101
    buffer_load_dwordx4 v[16:19], v3, s[44:47], s61 offen
    s_add_u32 s61, s61, 0xe0000
    buffer_load_dwordx4 v[20:23], v3, s[44:47], s61 offen
    s_add_u32 s61, s67, 1
    s_sub_u32 s59, s61, 20
    s_cmp_ge_u32 s61, 20
    s_cselect_b32 s61, s59, s61
    s_mul_i32 s59, s57, 20
    s_add_u32 s61, s61, s59
    s_lshl_b32 s61, s61, 10
    s_add_u32 s61, s61, s101
    buffer_load_dwordx4 v[24:27], v3, s[44:47], s61 offen
    s_add_u32 s61, s61, 0xe0000
    buffer_load_dwordx4 v[28:31], v3, s[44:47], s61 offen
    s_add_u32 s61, s67, 2
    s_sub_u32 s59, s61, 20
    s_cmp_ge_u32 s61, 20
    s_cselect_b32 s61, s59, s61
    s_mul_i32 s59, s57, 20
    s_add_u32 s61, s61, s59
    s_lshl_b32 s61, s61, 10
    s_add_u32 s61, s61, s101
    buffer_load_dwordx4 v[32:35], v3, s[44:47], s61 offen
    s_add_u32 s61, s61, 0xe0000
    buffer_load_dwordx4 v[36:39], v3, s[44:47], s61 offen
    s_add_u32 s61, s67, 3
    s_sub_u32 s59, s61, 20
    s_cmp_ge_u32 s61, 20
    s_cselect_b32 s61, s59, s61
    s_mul_i32 s59, s57, 20
    s_add_u32 s61, s61, s59
    s_lshl_b32 s61, s61, 10
    s_add_u32 s61, s61, s101
    buffer_load_dwordx4 v[40:43], v3, s[44:47], s61 offen
    s_add_u32 s61, s61, 0xe0000
    buffer_load_dwordx4 v[44:47], v3, s[44:47], s61 offen
    s_add_u32 s61, s67, 4
    s_sub_u32 s59, s61, 20
    s_cmp_ge_u32 s61, 20
    s_cselect_b32 s61, s59, s61
    s_mul_i32 s59, s57, 20
    s_add_u32 s61, s61, s59
    s_lshl_b32 s61, s61, 10
    s_add_u32 s61, s61, s101
    buffer_load_dwordx4 v[48:51], v3, s[44:47], s61 offen
    s_add_u32 s61, s61, 0xe0000
    buffer_load_dwordx4 v[52:55], v3, s[44:47], s61 offen
    s_add_u32 s61, s67, 5
    s_sub_u32 s59, s61, 20
    s_cmp_ge_u32 s61, 20
    s_cselect_b32 s61, s59, s61
    s_mul_i32 s59, s57, 20
    s_add_u32 s61, s61, s59
    s_lshl_b32 s61, s61, 10
    s_add_u32 s61, s61, s101
    buffer_load_dwordx4 v[56:59], v3, s[44:47], s61 offen
    s_add_u32 s61, s61, 0xe0000
    buffer_load_dwordx4 v[60:63], v3, s[44:47], s61 offen
    s_add_u32 s61, s67, 6
    s_sub_u32 s59, s61, 20
    s_cmp_ge_u32 s61, 20
    s_cselect_b32 s61, s59, s61
    s_mul_i32 s59, s57, 20
    s_add_u32 s61, s61, s59
    s_lshl_b32 s61, s61, 10
    s_add_u32 s61, s61, s101
    buffer_load_dwordx4 v[64:67], v3, s[44:47], s61 offen
    s_add_u32 s61, s61, 0xe0000
    buffer_load_dwordx4 v[68:71], v3, s[44:47], s61 offen
    s_add_u32 s61, s67, 7
    s_sub_u32 s59, s61, 20
    s_cmp_ge_u32 s61, 20
    s_cselect_b32 s61, s59, s61
    s_mul_i32 s59, s57, 20
    s_add_u32 s61, s61, s59
    s_lshl_b32 s61, s61, 10
    s_add_u32 s61, s61, s101
    buffer_load_dwordx4 v[72:75], v3, s[44:47], s61 offen
    s_add_u32 s61, s61, 0xe0000
    buffer_load_dwordx4 v[76:79], v3, s[44:47], s61 offen
    s_add_u32 s61, s67, 8
    s_sub_u32 s59, s61, 20
    s_cmp_ge_u32 s61, 20
    s_cselect_b32 s61, s59, s61
    s_mul_i32 s59, s57, 20
    s_add_u32 s61, s61, s59
    s_lshl_b32 s61, s61, 10
    s_add_u32 s61, s61, s101
    buffer_load_dwordx4 v[80:83], v3, s[44:47], s61 offen
    s_add_u32 s61, s61, 0xe0000
    buffer_load_dwordx4 v[84:87], v3, s[44:47], s61 offen
    s_add_u32 s61, s67, 9
    s_sub_u32 s59, s61, 20
    s_cmp_ge_u32 s61, 20
    s_cselect_b32 s61, s59, s61
    s_mul_i32 s59, s57, 20
    s_add_u32 s61, s61, s59
    s_lshl_b32 s61, s61, 10
    s_add_u32 s61, s61, s101
    buffer_load_dwordx4 v[88:91], v3, s[44:47], s61 offen
    s_add_u32 s61, s61, 0xe0000
    buffer_load_dwordx4 v[92:95], v3, s[44:47], s61 offen
    s_lshl_b32 s59, s57, 2
    s_add_u32 s59, s59, 0x27c00
    v_mov_b32 v12, s59
    v_mov_b32 v13, 1
    s_mov_b64 exec, 1
    ds_write_b32 v12, v13 offset:176
    s_mov_b64 exec, -1
    s_mul_i32 s62, s57, 3
    s_lshl_b32 s62, s62, 16
    s_lshl_b32 s59, s52, 10
    s_add_u32 s62, s62, s59
    s_lshl_b32 s59, s53, 8
    s_add_u32 s62, s62, s59
    s_add_u32 s63, s62, 0xc00000
    s_cmp_eq_u32 s57, 0
    s_cselect_b32 vcc_lo, 0xff00, 0
    s_mov_b32 vcc_hi, 0
    v_add_u32 v11, 0x1bff80, v2
    v_cndmask_b32 v11, v2, v11, vcc
    s_waitcnt vmcnt(26)
    ds_write_b128 v7, v[96:99] offset:40960
    ds_write_b128 v7, v[100:103] offset:41984
    ds_read_b64_tr_b16 v[96:97], v4 offset:40960
    ds_read_b64_tr_b16 v[98:99], v4 offset:41472
    ds_read_b64_tr_b16 v[100:101], v5 offset:40960
    ds_read_b64_tr_b16 v[102:103], v5 offset:41472
    s_waitcnt vmcnt(24)
    ds_write_b128 v7, v[104:107] offset:40960
    ds_write_b128 v7, v[108:111] offset:41984
    ds_read_b64_tr_b16 v[104:105], v4 offset:40960
    ds_read_b64_tr_b16 v[106:107], v4 offset:41472
    ds_read_b64_tr_b16 v[108:109], v5 offset:40960
    ds_read_b64_tr_b16 v[110:111], v5 offset:41472
    s_waitcnt vmcnt(22)
    ds_write_b128 v7, v[112:115] offset:40960
    ds_write_b128 v7, v[116:119] offset:41984
    ds_read_b64_tr_b16 v[112:113], v4 offset:40960
    ds_read_b64_tr_b16 v[114:115], v4 offset:41472
    ds_read_b64_tr_b16 v[116:117], v5 offset:40960
    ds_read_b64_tr_b16 v[118:119], v5 offset:41472
    s_waitcnt vmcnt(20)
    ds_write_b128 v7, v[120:123] offset:40960
    ds_write_b128 v7, v[124:127] offset:41984
    ds_read_b64_tr_b16 v[120:121], v4 offset:40960
    ds_read_b64_tr_b16 v[122:123], v4 offset:41472
    ds_read_b64_tr_b16 v[124:125], v5 offset:40960
    ds_read_b64_tr_b16 v[126:127], v5 offset:41472
    v_add_u32 v4, 0xc000, v4
    v_add_u32 v5, 0xc000, v5
    s_lshl_b32 s59, s57, 2
    s_add_u32 s59, s59, 0x27c00
    v_mov_b32 v12, s59
    s_mov_b32 s59, 0
LW_4_P:
    ds_read_b32 v13, v12 offset:32
    s_add_u32 s59, s59, 1
    s_waitcnt lgkmcnt(0)
    v_cmp_gt_u32 vcc, 1, v13
    s_cmp_ge_u32 s59, 0x8000
    s_cbranch_scc1 LW_4_G
    s_nop 2
    s_cbranch_vccnz LW_4_P
LW_4_G:
    ds_read_b64_tr_b16 v[192:193], v4
    ds_read_b64_tr_b16 v[194:195], v4 offset:512
    ds_read_b64_tr_b16 v[196:197], v5
    ds_read_b64_tr_b16 v[198:199], v5 offset:512
    ds_read_b64_tr_b16 v[200:201], v4 offset:8192
    ds_read_b64_tr_b16 v[202:203], v4 offset:8704
    ds_read_b64_tr_b16 v[204:205], v5 offset:8192
    ds_read_b64_tr_b16 v[206:207], v5 offset:8704
    s_waitcnt vmcnt(18) lgkmcnt(4)
    v_mfma_f32_32x32x16_bf16 v[128:143], v[192:195], v[16:19], 0
    v_mfma_f32_32x32x16_bf16 v[144:159], v[192:195], v[20:23], 0
    v_mfma_f32_32x32x16_bf16 v[160:175], v[196:199], v[16:19], 0
    v_mfma_f32_32x32x16_bf16 v[176:191], v[196:199], v[20:23], 0
    s_add_u32 s61, s67, 10
    s_sub_u32 s59, s61, 20
    s_cmp_ge_u32 s61, 20
    s_cselect_b32 s61, s59, s61
    s_mul_i32 s59, s57, 20
    s_add_u32 s61, s61, s59
    s_lshl_b32 s61, s61, 10
    s_add_u32 s61, s61, s101
    buffer_load_dwordx4 v[16:19], v3, s[44:47], s61 offen
    s_add_u32 s61, s61, 0xe0000
    buffer_load_dwordx4 v[20:23], v3, s[44:47], s61 offen
    ds_read_b64_tr_b16 v[192:193], v4 offset:16384
    ds_read_b64_tr_b16 v[194:195], v4 offset:16896
    ds_read_b64_tr_b16 v[196:197], v5 offset:16384
    ds_read_b64_tr_b16 v[198:199], v5 offset:16896
    s_waitcnt vmcnt(18) lgkmcnt(4)
    v_mfma_f32_32x32x16_bf16 v[128:143], v[200:203], v[24:27], v[128:143]
    v_mfma_f32_32x32x16_bf16 v[144:159], v[200:203], v[28:31], v[144:159]
    v_mfma_f32_32x32x16_bf16 v[160:175], v[204:207], v[24:27], v[160:175]
    v_mfma_f32_32x32x16_bf16 v[176:191], v[204:207], v[28:31], v[176:191]
    s_add_u32 s61, s67, 11
    s_sub_u32 s59, s61, 20
    s_cmp_ge_u32 s61, 20
    s_cselect_b32 s61, s59, s61
    s_mul_i32 s59, s57, 20
    s_add_u32 s61, s61, s59
    s_lshl_b32 s61, s61, 10
    s_add_u32 s61, s61, s101
    buffer_load_dwordx4 v[24:27], v3, s[44:47], s61 offen
    s_add_u32 s61, s61, 0xe0000
    buffer_load_dwordx4 v[28:31], v3, s[44:47], s61 offen
    ds_read_b64_tr_b16 v[200:201], v4 offset:24576
    ds_read_b64_tr_b16 v[202:203], v4 offset:25088
    ds_read_b64_tr_b16 v[204:205], v5 offset:24576
    ds_read_b64_tr_b16 v[206:207], v5 offset:25088
    s_waitcnt vmcnt(18) lgkmcnt(4)
    v_mfma_f32_32x32x16_bf16 v[128:143], v[192:195], v[32:35], v[128:143]
    v_mfma_f32_32x32x16_bf16 v[144:159], v[192:195], v[36:39], v[144:159]
    v_mfma_f32_32x32x16_bf16 v[160:175], v[196:199], v[32:35], v[160:175]
    v_mfma_f32_32x32x16_bf16 v[176:191], v[196:199], v[36:39], v[176:191]
    s_add_u32 s61, s67, 12
    s_sub_u32 s59, s61, 20
    s_cmp_ge_u32 s61, 20
    s_cselect_b32 s61, s59, s61
    s_mul_i32 s59, s57, 20
    s_add_u32 s61, s61, s59
    s_lshl_b32 s61, s61, 10
    s_add_u32 s61, s61, s101
    buffer_load_dwordx4 v[32:35], v3, s[44:47], s61 offen
    s_add_u32 s61, s61, 0xe0000
    buffer_load_dwordx4 v[36:39], v3, s[44:47], s61 offen
    ds_read_b64_tr_b16 v[192:193], v4 offset:32768
    ds_read_b64_tr_b16 v[194:195], v4 offset:33280
    ds_read_b64_tr_b16 v[196:197], v5 offset:32768
    ds_read_b64_tr_b16 v[198:199], v5 offset:33280
    s_waitcnt vmcnt(18) lgkmcnt(4)
    v_mfma_f32_32x32x16_bf16 v[128:143], v[200:203], v[40:43], v[128:143]
    v_mfma_f32_32x32x16_bf16 v[144:159], v[200:203], v[44:47], v[144:159]
    v_mfma_f32_32x32x16_bf16 v[160:175], v[204:207], v[40:43], v[160:175]
    v_mfma_f32_32x32x16_bf16 v[176:191], v[204:207], v[44:47], v[176:191]
    s_add_u32 s61, s67, 13
    s_sub_u32 s59, s61, 20
    s_cmp_ge_u32 s61, 20
    s_cselect_b32 s61, s59, s61
    s_mul_i32 s59, s57, 20
    s_add_u32 s61, s61, s59
    s_lshl_b32 s61, s61, 10
    s_add_u32 s61, s61, s101
    buffer_load_dwordx4 v[40:43], v3, s[44:47], s61 offen
    s_add_u32 s61, s61, 0xe0000
    buffer_load_dwordx4 v[44:47], v3, s[44:47], s61 offen
    ds_read_b64_tr_b16 v[200:201], v4 offset:40960
    ds_read_b64_tr_b16 v[202:203], v4 offset:41472
    ds_read_b64_tr_b16 v[204:205], v5 offset:40960
    ds_read_b64_tr_b16 v[206:207], v5 offset:41472
    s_waitcnt vmcnt(18) lgkmcnt(4)
    v_mfma_f32_32x32x16_bf16 v[128:143], v[192:195], v[48:51], v[128:143]
    v_mfma_f32_32x32x16_bf16 v[144:159], v[192:195], v[52:55], v[144:159]
    v_mfma_f32_32x32x16_bf16 v[160:175], v[196:199], v[48:51], v[160:175]
    v_mfma_f32_32x32x16_bf16 v[176:191], v[196:199], v[52:55], v[176:191]
    s_add_u32 s61, s67, 14
    s_sub_u32 s59, s61, 20
    s_cmp_ge_u32 s61, 20
    s_cselect_b32 s61, s59, s61
    s_mul_i32 s59, s57, 20
    s_add_u32 s61, s61, s59
    s_lshl_b32 s61, s61, 10
    s_add_u32 s61, s61, s101
    buffer_load_dwordx4 v[48:51], v3, s[44:47], s61 offen
    s_add_u32 s61, s61, 0xe0000
    buffer_load_dwordx4 v[52:55], v3, s[44:47], s61 offen
    ds_read_b64_tr_b16 v[192:193], v4 offset:49152
    ds_read_b64_tr_b16 v[194:195], v4 offset:49664
    ds_read_b64_tr_b16 v[196:197], v5 offset:49152
    ds_read_b64_tr_b16 v[198:199], v5 offset:49664
    s_waitcnt vmcnt(18) lgkmcnt(4)
    v_mfma_f32_32x32x16_bf16 v[128:143], v[200:203], v[56:59], v[128:143]
    v_mfma_f32_32x32x16_bf16 v[144:159], v[200:203], v[60:63], v[144:159]
    v_mfma_f32_32x32x16_bf16 v[160:175], v[204:207], v[56:59], v[160:175]
    v_mfma_f32_32x32x16_bf16 v[176:191], v[204:207], v[60:63], v[176:191]
    s_add_u32 s61, s67, 15
    s_sub_u32 s59, s61, 20
    s_cmp_ge_u32 s61, 20
    s_cselect_b32 s61, s59, s61
    s_mul_i32 s59, s57, 20
    s_add_u32 s61, s61, s59
    s_lshl_b32 s61, s61, 10
    s_add_u32 s61, s61, s101
    buffer_load_dwordx4 v[56:59], v3, s[44:47], s61 offen
    s_add_u32 s61, s61, 0xe0000
    buffer_load_dwordx4 v[60:63], v3, s[44:47], s61 offen
    ds_read_b64_tr_b16 v[200:201], v4 offset:57344
    ds_read_b64_tr_b16 v[202:203], v4 offset:57856
    ds_read_b64_tr_b16 v[204:205], v5 offset:57344
    ds_read_b64_tr_b16 v[206:207], v5 offset:57856
    s_waitcnt vmcnt(18) lgkmcnt(4)
    v_mfma_f32_32x32x16_bf16 v[128:143], v[192:195], v[64:67], v[128:143]
    v_mfma_f32_32x32x16_bf16 v[144:159], v[192:195], v[68:71], v[144:159]
    v_mfma_f32_32x32x16_bf16 v[160:175], v[196:199], v[64:67], v[160:175]
    v_mfma_f32_32x32x16_bf16 v[176:191], v[196:199], v[68:71], v[176:191]
    s_add_u32 s61, s67, 16
    s_sub_u32 s59, s61, 20
    s_cmp_ge_u32 s61, 20
    s_cselect_b32 s61, s59, s61
    s_mul_i32 s59, s57, 20
    s_add_u32 s61, s61, s59
    s_lshl_b32 s61, s61, 10
    s_add_u32 s61, s61, s101
    buffer_load_dwordx4 v[64:67], v3, s[44:47], s61 offen
    s_add_u32 s61, s61, 0xe0000
    buffer_load_dwordx4 v[68:71], v3, s[44:47], s61 offen
    v_add_u32 v4, 0x10000, v4
    v_add_u32 v5, 0x10000, v5
    ds_read_b64_tr_b16 v[192:193], v4
    ds_read_b64_tr_b16 v[194:195], v4 offset:512
    ds_read_b64_tr_b16 v[196:197], v5
    ds_read_b64_tr_b16 v[198:199], v5 offset:512
    s_waitcnt vmcnt(18) lgkmcnt(4)
    s_lshl_b32 s59, s57, 2
    s_add_u32 s59, s59, 0x27c00
    v_mov_b32 v12, s59
    v_mov_b32 v13, 1
    s_mov_b64 exec, 1
    ds_write_b32 v12, v13 offset:96
    s_mov_b64 exec, -1
    v_mfma_f32_32x32x16_bf16 v[128:143], v[200:203], v[72:75], v[128:143]
    v_mfma_f32_32x32x16_bf16 v[144:159], v[200:203], v[76:79], v[144:159]
    v_mfma_f32_32x32x16_bf16 v[160:175], v[204:207], v[72:75], v[160:175]
    v_mfma_f32_32x32x16_bf16 v[176:191], v[204:207], v[76:79], v[176:191]
    s_add_u32 s61, s67, 17
    s_sub_u32 s59, s61, 20
    s_cmp_ge_u32 s61, 20
    s_cselect_b32 s61, s59, s61
    s_mul_i32 s59, s57, 20
    s_add_u32 s61, s61, s59
    s_lshl_b32 s61, s61, 10
    s_add_u32 s61, s61, s101
    buffer_load_dwordx4 v[72:75], v3, s[44:47], s61 offen
    s_add_u32 s61, s61, 0xe0000
    buffer_load_dwordx4 v[76:79], v3, s[44:47], s61 offen
    ds_read_b64_tr_b16 v[200:201], v4 offset:8192
    ds_read_b64_tr_b16 v[202:203], v4 offset:8704
    ds_read_b64_tr_b16 v[204:205], v5 offset:8192
    ds_read_b64_tr_b16 v[206:207], v5 offset:8704
    s_waitcnt vmcnt(18) lgkmcnt(5)
    v_mfma_f32_32x32x16_bf16 v[128:143], v[192:195], v[80:83], v[128:143]
    v_mfma_f32_32x32x16_bf16 v[144:159], v[192:195], v[84:87], v[144:159]
    v_mfma_f32_32x32x16_bf16 v[160:175], v[196:199], v[80:83], v[160:175]
    v_mfma_f32_32x32x16_bf16 v[176:191], v[196:199], v[84:87], v[176:191]
    s_add_u32 s61, s67, 18
    s_sub_u32 s59, s61, 20
    s_cmp_ge_u32 s61, 20
    s_cselect_b32 s61, s59, s61
    s_mul_i32 s59, s57, 20
    s_add_u32 s61, s61, s59
    s_lshl_b32 s61, s61, 10
    s_add_u32 s61, s61, s101
    buffer_load_dwordx4 v[80:83], v3, s[44:47], s61 offen
    s_add_u32 s61, s61, 0xe0000
    buffer_load_dwordx4 v[84:87], v3, s[44:47], s61 offen
    ds_read_b64_tr_b16 v[192:193], v4 offset:16384
    ds_read_b64_tr_b16 v[194:195], v4 offset:16896
    ds_read_b64_tr_b16 v[196:197], v5 offset:16384
    ds_read_b64_tr_b16 v[198:199], v5 offset:16896
    s_waitcnt vmcnt(18) lgkmcnt(4)
    v_mfma_f32_32x32x16_bf16 v[128:143], v[200:203], v[88:91], v[128:143]
    v_mfma_f32_32x32x16_bf16 v[144:159], v[200:203], v[92:95], v[144:159]
    v_mfma_f32_32x32x16_bf16 v[160:175], v[204:207], v[88:91], v[160:175]
    v_mfma_f32_32x32x16_bf16 v[176:191], v[204:207], v[92:95], v[176:191]
    s_add_u32 s61, s67, 19
    s_sub_u32 s59, s61, 20
    s_cmp_ge_u32 s61, 20
    s_cselect_b32 s61, s59, s61
    s_mul_i32 s59, s57, 20
    s_add_u32 s61, s61, s59
    s_lshl_b32 s61, s61, 10
    s_add_u32 s61, s61, s101
    buffer_load_dwordx4 v[88:91], v3, s[44:47], s61 offen
    s_add_u32 s61, s61, 0xe0000
    buffer_load_dwordx4 v[92:95], v3, s[44:47], s61 offen
    ds_read_b64_tr_b16 v[200:201], v4 offset:24576
    ds_read_b64_tr_b16 v[202:203], v4 offset:25088
    ds_read_b64_tr_b16 v[204:205], v5 offset:24576
    ds_read_b64_tr_b16 v[206:207], v5 offset:25088
    s_waitcnt vmcnt(18) lgkmcnt(4)
    v_mfma_f32_32x32x16_bf16 v[128:143], v[192:195], v[16:19], v[128:143]
    v_mfma_f32_32x32x16_bf16 v[144:159], v[192:195], v[20:23], v[144:159]
    v_mfma_f32_32x32x16_bf16 v[160:175], v[196:199], v[16:19], v[160:175]
    v_mfma_f32_32x32x16_bf16 v[176:191], v[196:199], v[20:23], v[176:191]
    v_and_b32 v12, 7, v1
    v_lshlrev_b32 v12, 2, v12
    v_add_u32 v12, 0x27c00, v12
    s_mov_b32 s59, 0
LW_5_P:
    ds_read_b32 v13, v12 offset:176
    s_add_u32 s59, s59, 1
    s_waitcnt lgkmcnt(0)
    v_cmp_gt_u32 vcc, 1, v13
    s_cmp_ge_u32 s59, 0x8000
    s_cbranch_scc1 LW_5_G
    s_nop 2
    s_cbranch_vccnz LW_5_P
LW_5_G:
    s_mov_b32 s62, s63
    buffer_load_dwordx4 v[232:235], v11, s[44:47], s62 offen sc1
    s_add_u32 s62, s62, 0x8000
    buffer_load_dwordx4 v[236:239], v2, s[44:47], s62 offen sc1
    s_add_u32 s62, s62, 0x8000
    buffer_load_dwordx4 v[240:243], v2, s[44:47], s62 offen sc1
    s_add_u32 s62, s62, 0x8000
    buffer_load_dwordx4 v[244:247], v2, s[44:47], s62 offen sc1
    s_add_u32 s62, s62, 0x8000
    buffer_load_dwordx4 v[248:251], v2, s[44:47], s62 offen sc1
    s_add_u32 s62, s62, 0x8000
    buffer_load_dwordx4 v[252:255], v2, s[44:47], s62 offen sc1
    s_add_u32 s62, s62, 0x8000
    v_add_u32 v4, 0xfffe4000, v4
    v_add_u32 v5, 0xfffe4000, v5
    ds_read_b64_tr_b16 v[192:193], v4
    ds_read_b64_tr_b16 v[194:195], v4 offset:512
    ds_read_b64_tr_b16 v[196:197], v5
    ds_read_b64_tr_b16 v[198:199], v5 offset:512
    s_waitcnt vmcnt(22)
    v_mfma_f32_32x32x16_bf16 v[128:143], v[200:203], v[24:27], v[128:143]
    v_mfma_f32_32x32x16_bf16 v[144:159], v[200:203], v[28:31], v[144:159]
    v_mfma_f32_32x32x16_bf16 v[160:175], v[204:207], v[24:27], v[160:175]
    v_mfma_f32_32x32x16_bf16 v[176:191], v[204:207], v[28:31], v[176:191]
    ds_read_b64_tr_b16 v[200:201], v4 offset:8192
    ds_read_b64_tr_b16 v[202:203], v4 offset:8704
    ds_read_b64_tr_b16 v[204:205], v5 offset:8192
    ds_read_b64_tr_b16 v[206:207], v5 offset:8704
    s_waitcnt vmcnt(20) lgkmcnt(4)
    v_mfma_f32_32x32x16_bf16 v[128:143], v[192:195], v[32:35], v[128:143]
    v_mfma_f32_32x32x16_bf16 v[144:159], v[192:195], v[36:39], v[144:159]
    v_mfma_f32_32x32x16_bf16 v[160:175], v[196:199], v[32:35], v[160:175]
    v_mfma_f32_32x32x16_bf16 v[176:191], v[196:199], v[36:39], v[176:191]
    ds_read_b64_tr_b16 v[192:193], v4 offset:16384
    ds_read_b64_tr_b16 v[194:195], v4 offset:16896
    ds_read_b64_tr_b16 v[196:197], v5 offset:16384
    ds_read_b64_tr_b16 v[198:199], v5 offset:16896
    s_waitcnt vmcnt(18) lgkmcnt(4)
    v_mfma_f32_32x32x16_bf16 v[128:143], v[200:203], v[40:43], v[128:143]
    v_mfma_f32_32x32x16_bf16 v[144:159], v[200:203], v[44:47], v[144:159]
    v_mfma_f32_32x32x16_bf16 v[160:175], v[204:207], v[40:43], v[160:175]
    v_mfma_f32_32x32x16_bf16 v[176:191], v[204:207], v[44:47], v[176:191]
    ds_read_b64_tr_b16 v[200:201], v4 offset:24576
    ds_read_b64_tr_b16 v[202:203], v4 offset:25088
    ds_read_b64_tr_b16 v[204:205], v5 offset:24576
    ds_read_b64_tr_b16 v[206:207], v5 offset:25088
    s_waitcnt vmcnt(16) lgkmcnt(4)
    v_mfma_f32_32x32x16_bf16 v[128:143], v[192:195], v[48:51], v[128:143]
    v_mfma_f32_32x32x16_bf16 v[144:159], v[192:195], v[52:55], v[144:159]
    v_mfma_f32_32x32x16_bf16 v[160:175], v[196:199], v[48:51], v[160:175]
    v_mfma_f32_32x32x16_bf16 v[176:191], v[196:199], v[52:55], v[176:191]
    s_waitcnt vmcnt(14) lgkmcnt(0)
    v_mfma_f32_32x32x16_bf16 v[128:143], v[200:203], v[56:59], v[128:143]
    v_mfma_f32_32x32x16_bf16 v[144:159], v[200:203], v[60:63], v[144:159]
    v_mfma_f32_32x32x16_bf16 v[160:175], v[204:207], v[56:59], v[160:175]
    v_mfma_f32_32x32x16_bf16 v[176:191], v[204:207], v[60:63], v[176:191]
    s_waitcnt vmcnt(12)
    v_mfma_f32_32x32x16_bf16 v[128:143], v[96:99], v[64:67], v[128:143]
    v_mfma_f32_32x32x16_bf16 v[144:159], v[96:99], v[68:71], v[144:159]
    v_mfma_f32_32x32x16_bf16 v[160:175], v[100:103], v[64:67], v[160:175]
    v_mfma_f32_32x32x16_bf16 v[176:191], v[100:103], v[68:71], v[176:191]
    s_waitcnt vmcnt(0)
    s_branch YCcC
YCcP:
    s_sleep 3
    s_add_u32 s66, s66, 1
    s_mov_b32 s62, s63
    buffer_load_dwordx4 v[232:235], v11, s[44:47], s62 offen sc1
    s_add_u32 s62, s62, 0x8000
    buffer_load_dwordx4 v[236:239], v2, s[44:47], s62 offen sc1
    s_add_u32 s62, s62, 0x8000
    buffer_load_dwordx4 v[240:243], v2, s[44:47], s62 offen sc1
    s_add_u32 s62, s62, 0x8000
    buffer_load_dwordx4 v[244:247], v2, s[44:47], s62 offen sc1
    s_add_u32 s62, s62, 0x8000
    buffer_load_dwordx4 v[248:251], v2, s[44:47], s62 offen sc1
    s_add_u32 s62, s62, 0x8000
    buffer_load_dwordx4 v[252:255], v2, s[44:47], s62 offen sc1
    s_add_u32 s62, s62, 0x8000
    s_waitcnt vmcnt(0)
YCcC:
    v_max3_u32 v12, v232, v233, v234
    v_max3_u32 v13, v235, v236, v237
    v_max3_u32 v12, v12, v238, v239
    v_max3_u32 v13, v13, v240, v241
    v_max3_u32 v12, v12, v242, v243
    v_max3_u32 v13, v13, v244, v245
    v_max3_u32 v12, v12, v246, v247
    v_max3_u32 v13, v13, v248, v249
    v_max3_u32 v12, v12, v250, v251
    v_max3_u32 v13, v13, v252, v253
    v_max3_u32 v12, v12, v254, v255
    v_max_u32 v12, v12, v13
    v_cmp_eq_u32 vcc, -1, v12
    s_cmp_ge_u32 s66, 0xfa0
    s_cbranch_scc1 YCcG
    s_nop 2
    s_cbranch_vccnz YCcP
YCcG:
    ds_write_b128 v7, v[232:235] offset:40960
    ds_write_b128 v7, v[236:239] offset:41984
    ds_read_b64_tr_b16 v[232:233], v6
    ds_read_b64_tr_b16 v[234:235], v6 offset:512
    ds_read_b64_tr_b16 v[236:237], v6 offset:8
    ds_read_b64_tr_b16 v[238:239], v6 offset:520
    ds_write_b128 v7, v[240:243] offset:40960
    ds_write_b128 v7, v[244:247] offset:41984
    ds_read_b64_tr_b16 v[240:241], v6
    ds_read_b64_tr_b16 v[242:243], v6 offset:512
    ds_read_b64_tr_b16 v[244:245], v6 offset:8
    ds_read_b64_tr_b16 v[246:247], v6 offset:520
    s_waitcnt lgkmcnt(6)
    v_mfma_f32_32x32x16_bf16 v[128:143], v[208:211], v[232:235], v[128:143]
    v_mfma_f32_32x32x16_bf16 v[144:159], v[208:211], v[236:239], v[144:159]
    v_mfma_f32_32x32x16_bf16 v[160:175], v[212:215], v[232:235], v[160:175]
    v_mfma_f32_32x32x16_bf16 v[176:191], v[212:215], v[236:239], v[176:191]
    ds_write_b128 v7, v[248:251] offset:40960
    ds_write_b128 v7, v[252:255] offset:41984
    ds_read_b64_tr_b16 v[248:249], v6
    ds_read_b64_tr_b16 v[250:251], v6 offset:512
    ds_read_b64_tr_b16 v[252:253], v6 offset:8
    ds_read_b64_tr_b16 v[254:255], v6 offset:520
    s_waitcnt lgkmcnt(6)
    v_mfma_f32_32x32x16_bf16 v[128:143], v[216:219], v[240:243], v[128:143]
    v_mfma_f32_32x32x16_bf16 v[144:159], v[216:219], v[244:247], v[144:159]
    v_mfma_f32_32x32x16_bf16 v[160:175], v[220:223], v[240:243], v[160:175]
    v_mfma_f32_32x32x16_bf16 v[176:191], v[220:223], v[244:247], v[176:191]
    s_waitcnt lgkmcnt(0)
    v_mfma_f32_32x32x16_bf16 v[128:143], v[224:227], v[248:251], v[128:143]
    v_mfma_f32_32x32x16_bf16 v[144:159], v[224:227], v[252:255], v[144:159]
    v_mfma_f32_32x32x16_bf16 v[160:175], v[228:231], v[248:251], v[160:175]
    v_mfma_f32_32x32x16_bf16 v[176:191], v[228:231], v[252:255], v[176:191]
    buffer_load_dwordx4 v[232:235], v8, s[24:27], 0 offen
    v_xor_b32 v208, 0, v3
    s_add_u32 s59, s58, 0
    v_add_u32 v208, s59, v208
    v_xor_b32 v209, 32, v3
    s_add_u32 s59, s58, 0x400
    v_add_u32 v209, s59, v209
    v_xor_b32 v210, 64, v3
    s_add_u32 s59, s58, 0x2000
    v_add_u32 v210, s59, v210
    v_xor_b32 v211, 0x60, v3
    s_add_u32 s59, s58, 0x2400
    v_add_u32 v211, s59, v211
    v_xor_b32 v212, 0x80, v3
    s_add_u32 s59, s58, 0x1c000
    v_add_u32 v212, s59, v212
    v_xor_b32 v213, 0xa0, v3
    s_add_u32 s59, s58, 0x1c400
    v_add_u32 v213, s59, v213
    v_xor_b32 v214, 0xc0, v3
    s_add_u32 s59, s58, 0x1e000
    v_add_u32 v214, s59, v214
    v_xor_b32 v215, 0xe0, v3
    s_add_u32 s59, s58, 0x1e400
    v_add_u32 v215, s59, v215
    v_mfma_f32_32x32x16_bf16 v[128:143], v[104:107], v[72:75], v[128:143]
    v_mfma_f32_32x32x16_bf16 v[144:159], v[104:107], v[76:79], v[144:159]
    v_mfma_f32_32x32x16_bf16 v[160:175], v[108:111], v[72:75], v[160:175]
    v_mfma_f32_32x32x16_bf16 v[176:191], v[108:111], v[76:79], v[176:191]
    v_mfma_f32_32x32x16_bf16 v[128:143], v[112:115], v[80:83], v[128:143]
    v_mfma_f32_32x32x16_bf16 v[144:159], v[112:115], v[84:87], v[144:159]
    v_mfma_f32_32x32x16_bf16 v[160:175], v[116:119], v[80:83], v[160:175]
    v_mfma_f32_32x32x16_bf16 v[176:191], v[116:119], v[84:87], v[176:191]
    v_mfma_f32_32x32x16_bf16 v[128:143], v[120:123], v[88:91], v[128:143]
    v_mfma_f32_32x32x16_bf16 v[144:159], v[120:123], v[92:95], v[144:159]
    v_mfma_f32_32x32x16_bf16 v[160:175], v[124:127], v[88:91], v[160:175]
    v_mfma_f32_32x32x16_bf16 v[176:191], v[124:127], v[92:95], v[176:191]
    s_nop 8
    ds_write_b128 v208, v[128:131]
    ds_write_b128 v209, v[132:135]
    ds_write_b128 v210, v[136:139]
    ds_write_b128 v211, v[140:143]
    ds_write_b128 v208, v[144:147] offset:16384
    ds_write_b128 v209, v[148:151] offset:16384
    ds_write_b128 v210, v[152:155] offset:16384
    ds_write_b128 v211, v[156:159] offset:16384
    ds_write_b128 v212, v[160:163]
    ds_write_b128 v213, v[164:167]
    ds_write_b128 v214, v[168:171]
    ds_write_b128 v215, v[172:175]
    ds_write_b128 v212, v[176:179] offset:16384
    ds_write_b128 v213, v[180:183] offset:16384
    ds_write_b128 v214, v[184:187] offset:16384
    ds_write_b128 v215, v[188:191] offset:16384
    s_waitcnt vmcnt(0)
    v_lshlrev_b32 v216, 16, v232
    v_and_b32 v217, 0xffff0000, v232
    v_lshlrev_b32 v218, 16, v233
    v_and_b32 v219, 0xffff0000, v233
    v_lshlrev_b32 v220, 16, v234
    v_and_b32 v221, 0xffff0000, v234
    v_lshlrev_b32 v222, 16, v235
    v_and_b32 v223, 0xffff0000, v235
    s_branch K_RED
K_HELP:
    s_setprio 2
    s_lshl_b32 s100, s57, 13
    s_mul_i32 s60, s56, 0x3800
    s_lshl_b32 s62, s57, 9
    s_add_u32 s59, s60, s62
    v_add_u32 v251, s59, v3
    s_add_u32 m0, s62, 0x26000
    s_mov_b32 exec_hi, 0
    buffer_load_dwordx4 v251, s[48:51], 0 offen lds
    s_mov_b32 exec_hi, -1
    v_bfe_u32 v12, v1, 3, 2
    v_lshrrev_b32 v13, 5, v1
    v_lshl_add_u32 v12, v12, 6, v13
    v_mul_u32_u24 v12, 0x380, v12
    v_and_b32 v13, 7, v1
    v_lshrrev_b32 v14, 4, v1
    v_xor_b32 v13, v13, v14
    v_lshl_add_u32 v12, v13, 4, v12
    s_lshl_b32 s59, s57, 6
    s_add_u32 s59, s59, s55
    s_mul_i32 s59, s59, 0x1c00
    v_add_u32 v248, s59, v12
    v_xor_b32 v249, 64, v248
    v_add_u32 v249, 0x700, v249
    v_lshrrev_b32 v12, 3, v1
    v_and_b32 v13, 7, v1
    v_lshlrev_b32 v0, 1, v12
    v_and_b32 v0, 4, v0
    v_xor_b32 v13, v13, v0
    v_lshlrev_b32 v13, 4, v13
    v_mul_u32_u24 v0, 0x380, v12
    s_lshl_b32 s59, s54, 7
    v_add3_u32 v0, v0, s59, v13
    v_mul_u32_u24 v12, 0xe00, v12
    s_mul_i32 s59, s57, 0xe000
    s_lshl_b32 s60, s56, 7
    s_add_u32 s59, s59, s60
    v_add3_u32 v250, s59, v12, v13
    s_waitcnt lgkmcnt(0)
    s_mov_b32 s24, s4
    s_mov_b32 s25, s5
    s_mov_b32 s26, 0x1c0000
    s_mov_b32 s27, 0x20000
    s_mov_b32 s28, s12
    s_mov_b32 s29, s13
    s_mov_b32 s30, 0x188000
    s_mov_b32 s31, 0x20000
    s_mov_b32 s32, s14
    s_mov_b32 s33, s15
    s_mov_b32 s34, 0x188000
    s_mov_b32 s35, 0x20000
    s_mov_b32 s59, 0
    s_add_u32 m0, s58, 0x8000
    s_nop 0
    buffer_load_dwordx4 v250, s[28:31], s59 offen lds
    s_mov_b32 s59, 0
    s_add_u32 m0, s58, 0xa000
    s_nop 0
    buffer_load_dwordx4 v250, s[32:35], s59 offen lds
    s_mov_b32 s59, 0x7000
    s_add_u32 m0, s58, 0x8400
    s_nop 0
    buffer_load_dwordx4 v250, s[28:31], s59 offen lds
    s_mov_b32 s59, 0x7000
    s_add_u32 m0, s58, 0xa400
    s_nop 0
    buffer_load_dwordx4 v250, s[32:35], s59 offen lds
    s_mov_b32 s59, 0
    s_add_u32 m0, s100, 0
    s_nop 0
    buffer_load_dwordx4 v248, s[24:27], s59 offen lds
    s_mov_b32 s59, 0
    s_add_u32 m0, s100, 0x400
    s_nop 0
    buffer_load_dwordx4 v249, s[24:27], s59 offen lds
    s_mov_b32 s59, 0xe00
    s_add_u32 m0, s100, 0x800
    s_nop 0
    buffer_load_dwordx4 v248, s[24:27], s59 offen lds
    s_mov_b32 s59, 0xe00
    s_add_u32 m0, s100, 0xc00
    s_nop 0
    buffer_load_dwordx4 v249, s[24:27], s59 offen lds
    s_mov_b32 s59, 0x38000
    s_add_u32 m0, s100, 0x1000
    s_nop 0
    buffer_load_dwordx4 v248, s[24:27], s59 offen lds
    s_mov_b32 s59, 0x38000
    s_add_u32 m0, s100, 0x1400
    s_nop 0
    buffer_load_dwordx4 v249, s[24:27], s59 offen lds
    s_mov_b32 s59, 0x38e00
    s_add_u32 m0, s100, 0x1800
    s_nop 0
    buffer_load_dwordx4 v248, s[24:27], s59 offen lds
    s_mov_b32 s59, 0x38e00
    s_add_u32 m0, s100, 0x1c00
    s_nop 0
    buffer_load_dwordx4 v249, s[24:27], s59 offen lds
    s_barrier
    s_mov_b32 s59, 0x38000
    s_add_u32 m0, s58, 0x14000
    s_nop 0
    buffer_load_dwordx4 v250, s[28:31], s59 offen lds
    s_mov_b32 s59, 0x38000
    s_add_u32 m0, s58, 0x16000
    s_nop 0
    buffer_load_dwordx4 v250, s[32:35], s59 offen lds
    s_mov_b32 s59, 0x3f000
    s_add_u32 m0, s58, 0x14400
    s_nop 0
    buffer_load_dwordx4 v250, s[28:31], s59 offen lds
    s_waitcnt vmcnt(3)
    s_lshl_b32 s59, s57, 2
    s_add_u32 s59, s59, 0x27c00
    v_mov_b32 v12, s59
    v_mov_b32 v13, 1
    s_mov_b64 exec, 1
    ds_write_b32 v12, v13 offset:48
    s_mov_b64 exec, -1
    s_mov_b32 s59, 0x3f000
    s_add_u32 m0, s58, 0x16400
    s_nop 0
    buffer_load_dwordx4 v250, s[32:35], s59 offen lds
    s_mov_b32 s59, 0x80
    s_add_u32 m0, s100, 0xc000
    s_nop 0
    buffer_load_dwordx4 v248, s[24:27], s59 offen lds
    s_mov_b32 s59, 0x80
    s_add_u32 m0, s100, 0xc400
    s_nop 0
    buffer_load_dwordx4 v249, s[24:27], s59 offen lds
    s_mov_b32 s59, 0xe80
    s_add_u32 m0, s100, 0xc800
    s_nop 0
    buffer_load_dwordx4 v248, s[24:27], s59 offen lds
    s_mov_b32 s59, 0xe80
    s_add_u32 m0, s100, 0xcc00
    s_nop 0
    buffer_load_dwordx4 v249, s[24:27], s59 offen lds
    s_mov_b32 s59, 0x38080
    s_add_u32 m0, s100, 0xd000
    s_nop 0
    buffer_load_dwordx4 v248, s[24:27], s59 offen lds
    s_mov_b32 s59, 0x38080
    s_add_u32 m0, s100, 0xd400
    s_nop 0
    buffer_load_dwordx4 v249, s[24:27], s59 offen lds
    s_mov_b32 s59, 0x38e80
    s_add_u32 m0, s100, 0xd800
    s_nop 0
    buffer_load_dwordx4 v248, s[24:27], s59 offen lds
    s_mov_b32 s59, 0x38e80
    s_add_u32 m0, s100, 0xdc00
    s_nop 0
    buffer_load_dwordx4 v249, s[24:27], s59 offen lds
    s_add_u32 m0, s62, 0x26800
    s_movk_i32 s59, 0x800
    s_mov_b32 exec_hi, 0
    buffer_load_dwordx4 v251, s[48:51], s59 offen lds
    s_mov_b32 exec_hi, -1
    s_mov_b32 s36, s20
    s_mov_b32 s37, s21
    s_mov_b32 s38, 0x100
    s_mov_b32 s39, 0x20000
    s_mov_b32 s40, s16
    s_mov_b32 s41, s17
    s_mov_b32 s42, 0x188000
    s_mov_b32 s43, 0x20000
    s_mov_b32 s44, s22
    s_mov_b32 s45, s23
    s_mov_b32 s46, 0x1000000
    s_mov_b32 s47, 0x20000
    v_and_b32 v12, 15, v1
    v_lshlrev_b32 v13, 2, v12
    s_lshl_b32 s59, s56, 6
    s_add_u32 s59, s59, 0xcd000
    buffer_load_dword v255, v13, s[48:51], s59 offen
    v_lshrrev_b32 v13, 4, v1
    v_bfe_u32 v14, v1, 1, 3
    v_xor_b32 v13, v13, v14
    v_lshlrev_b32 v13, 4, v13
    v_lshl_add_u32 v12, v12, 7, v13
    v_add_u32 v252, s100, v12
    v_xor_b32 v253, 64, v252
    v_add_u32 v254, 0x26000, v3
    s_add_u32 s59, s58, 0x24000
    v_add_u32 v7, s59, v3
    v_bfe_u32 v13, v1, 2, 2
    v_bfe_u32 v4, v1, 4, 1
    v_lshlrev_b32 v4, 5, v4
    v_and_b32 v12, 3, v1
    v_lshl_add_u32 v4, v12, 3, v4
    v_lshl_add_u32 v4, v13, 7, v4
    v_lshrrev_b32 v13, 1, v13
    v_lshl_add_u32 v4, v13, 6, v4
    v_lshrrev_b32 v12, 5, v1
    v_lshl_add_u32 v4, v12, 10, v4
    v_add_u32 v4, s59, v4
    v_xor_b32 v5, 64, v4
    v_bfe_u32 v13, v1, 2, 2
    v_bfe_u32 v14, v1, 4, 1
    v_lshlrev_b32 v14, 6, v14
    v_and_b32 v12, 3, v1
    v_lshl_add_u32 v14, v12, 4, v14
    v_lshrrev_b32 v12, 1, v13
    v_lshlrev_b32 v12, 6, v12
    v_xor_b32 v14, v14, v12
    v_lshl_add_u32 v14, v13, 7, v14
    v_lshrrev_b32 v12, 5, v1
    v_lshl_add_u32 v14, v12, 10, v14
    s_add_u32 s59, s58, 0x24000
    v_add_u32 v6, s59, v14
    v_lshrrev_b32 v12, 4, v1
    v_lshlrev_b32 v2, 13, v12
    v_bfe_u32 v13, v1, 3, 1
    v_lshl_add_u32 v2, v13, 7, v2
    v_lshlrev_b32 v12, 2, v12
    v_and_b32 v12, 4, v12
    v_and_b32 v13, 7, v1
    v_xor_b32 v13, v13, v12
    v_lshl_add_u32 v2, v13, 4, v2
    v_bfe_u32 v12, v1, 3, 2
    v_lshrrev_b32 v13, 5, v1
    v_lshl_add_u32 v12, v12, 6, v13
    v_mul_u32_u24 v12, 0x380, v12
    v_and_b32 v13, 7, v1
    v_lshl_add_u32 v12, v13, 4, v12
    s_lshl_b32 s59, s55, 8
    s_lshr_b32 s60, s52, 1
    s_lshl_b32 s60, s60, 4
    s_add_u32 s59, s59, s60
    s_lshl_b32 s60, s3, 1
    s_add_u32 s59, s59, s60
    s_mul_i32 s59, s59, 0x380
    s_lshl_b32 s60, s54, 7
    s_add_u32 s59, s59, s60
    v_add_u32 v8, s59, v12
    v_lshrrev_b32 v12, 3, v1
    s_lshl_b32 s59, s57, 3
    v_add_u32 v12, s59, v12
    v_lshlrev_b32 v14, 1, v13
    v_xor_b32 v12, v12, v14
    v_lshlrev_b32 v9, 4, v12
    v_and_b32 v12, 1, v1
    v_lshl_add_u32 v9, v12, 10, v9
    v_bfe_u32 v12, v1, 1, 1
    v_lshl_add_u32 v9, v12, 13, v9
    v_bfe_u32 v12, v1, 2, 1
    v_lshl_add_u32 v9, v12, 15, v9
    v_add_u32 v9, 0x10000, v9
    s_lshr_b32 s59, s52, 1
    s_lshl_b32 s59, s59, 4
    s_add_u32 s59, s59, s55
    s_mul_i32 s101, s59, 0x1c000
    s_mul_i32 s65, s52, 28
    s_mul_i32 s59, s53, 7
    s_add_u32 s65, s65, s59
    s_add_u32 s65, s65, s54
    s_mov_b32 s59, 0x70000
    buffer_load_dwordx4 v[16:19], v250, s[28:31], s59 offen
    s_mov_b32 s59, 0x70000
    buffer_load_dwordx4 v[20:23], v250, s[32:35], s59 offen
    s_waitcnt vmcnt(3)
    s_lshl_b32 s59, s57, 2
    s_add_u32 s59, s59, 0x27c00
    v_mov_b32 v12, s59
    v_mov_b32 v13, 2
    s_mov_b64 exec, 1
    ds_write_b32 v12, v13 offset:48
    s_mov_b64 exec, -1
    v_and_b32 v12, 3, v1
    v_lshlrev_b32 v12, 2, v12
    v_add_u32 v12, 0x27c00, v12
    s_mov_b32 s59, 0
LW_6_P:
    ds_read_b32 v13, v12 offset:48
    s_add_u32 s59, s59, 1
    s_waitcnt lgkmcnt(0)
    v_cmp_gt_u32 vcc, 1, v13
    s_cmp_ge_u32 s59, 0x8000
    s_cbranch_scc1 LW_6_G
    s_nop 2
    s_cbranch_vccnz LW_6_P
LW_6_G:
    ds_read_b128 v[160:163], v254
    ds_read_b128 v[128:131], v252
    ds_read_b128 v[136:139], v252 offset:2048
    ds_read_b128 v[144:147], v252 offset:4096
    ds_read_b128 v[152:155], v252 offset:6144
    ds_read_b128 v[164:167], v254 offset:1024
    ds_read_b128 v[132:135], v253
    ds_read_b128 v[140:143], v253 offset:2048
    ds_read_b128 v[148:151], v253 offset:4096
    ds_read_b128 v[156:159], v253 offset:6144
    s_mov_b32 s59, 0x77000
    buffer_load_dwordx4 v[24:27], v250, s[28:31], s59 offen
    s_waitcnt lgkmcnt(5)
    v_mfma_f32_16x16x32_bf16 v[168:171], v[128:131], v[160:163], 0
    s_mov_b32 s59, 0x77000
    buffer_load_dwordx4 v[28:31], v250, s[32:35], s59 offen
    v_mfma_f32_16x16x32_bf16 v[172:175], v[136:139], v[160:163], 0
    s_mov_b32 s59, 0x100
    buffer_load_dwordx4 v[32:35], v248, s[24:27], s59 offen
    v_mfma_f32_16x16x32_bf16 v[176:179], v[144:147], v[160:163], 0
    s_mov_b32 s59, 0x100
    buffer_load_dwordx4 v[36:39], v249, s[24:27], s59 offen
    v_mfma_f32_16x16x32_bf16 v[180:183], v[152:155], v[160:163], 0
    s_mov_b32 s59, 0xf00
    buffer_load_dwordx4 v[40:43], v248, s[24:27], s59 offen
    s_waitcnt lgkmcnt(0)
    v_mfma_f32_16x16x32_bf16 v[168:171], v[132:135], v[164:167], v[168:171]
    s_mov_b32 s59, 0xf00
    buffer_load_dwordx4 v[44:47], v249, s[24:27], s59 offen
    v_mfma_f32_16x16x32_bf16 v[172:175], v[140:143], v[164:167], v[172:175]
    s_mov_b32 s59, 0x38100
    buffer_load_dwordx4 v[64:67], v248, s[24:27], s59 offen
    v_mfma_f32_16x16x32_bf16 v[176:179], v[148:151], v[164:167], v[176:179]
    s_mov_b32 s59, 0x38100
    buffer_load_dwordx4 v[68:71], v249, s[24:27], s59 offen
    v_mfma_f32_16x16x32_bf16 v[180:183], v[156:159], v[164:167], v[180:183]
    s_mov_b32 s59, 0x38f00
    buffer_load_dwordx4 v[72:75], v248, s[24:27], s59 offen
    s_mov_b32 s59, 0x38f00
    buffer_load_dwordx4 v[76:79], v249, s[24:27], s59 offen
    s_movk_i32 s59, 0x1000
    s_mov_b32 exec_hi, 0
    buffer_load_dwordx4 v[216:219], v251, s[48:51], s59 offen
    s_mov_b32 exec_hi, -1
    s_lshl_b32 s59, s57, 2
    s_add_u32 s59, s59, 0x27c00
    v_mov_b32 v12, s59
    v_mov_b32 v13, 3
    s_mov_b64 exec, 1
    ds_write_b32 v12, v13 offset:80
    s_mov_b64 exec, -1
    s_mov_b32 s59, 0xa8000
    buffer_load_dwordx4 v[80:83], v250, s[28:31], s59 offen
    s_mov_b32 s59, 0xa8000
    buffer_load_dwordx4 v[84:87], v250, s[32:35], s59 offen
    s_mov_b32 s59, 0xaf000
    buffer_load_dwordx4 v[88:91], v250, s[28:31], s59 offen
    s_mov_b32 s59, 0xaf000
    buffer_load_dwordx4 v[92:95], v250, s[32:35], s59 offen
    s_mov_b32 s59, 0x180
    buffer_load_dwordx4 v[96:99], v248, s[24:27], s59 offen
    s_mov_b32 s59, 0x180
    buffer_load_dwordx4 v[100:103], v249, s[24:27], s59 offen
    v_and_b32 v12, 3, v1
    v_lshlrev_b32 v12, 2, v12
    v_add_u32 v12, 0x27c00, v12
    s_mov_b32 s59, 0
LW_7_P:
    ds_read_b32 v13, v12 offset:48
    s_add_u32 s59, s59, 1
    s_waitcnt lgkmcnt(0)
    v_cmp_gt_u32 vcc, 2, v13
    s_cmp_ge_u32 s59, 0x8000
    s_cbranch_scc1 LW_7_G
    s_nop 2
    s_cbranch_vccnz LW_7_P
LW_7_G:
    v_add_u32 v252, 0xc000, v252
    v_add_u32 v253, 0xc000, v253
    ds_read_b128 v[160:163], v254 offset:2048
    ds_read_b128 v[128:131], v252
    ds_read_b128 v[136:139], v252 offset:2048
    ds_read_b128 v[144:147], v252 offset:4096
    ds_read_b128 v[152:155], v252 offset:6144
    ds_read_b128 v[164:167], v254 offset:3072
    ds_read_b128 v[132:135], v253
    ds_read_b128 v[140:143], v253 offset:2048
    ds_read_b128 v[148:151], v253 offset:4096
    ds_read_b128 v[156:159], v253 offset:6144
    s_add_u32 s59, s58, 0x20000
    v_add_u32 v14, s59, v3
    s_add_u32 s59, s100, 0x18000
    v_add_u32 v15, s59, v3
    s_waitcnt vmcnt(18)
    ds_write_b128 v14, v[16:19]
    s_waitcnt vmcnt(17)
    ds_write_b128 v14, v[20:23] offset:8192
    s_waitcnt vmcnt(16)
    ds_write_b128 v14, v[24:27] offset:1024
    s_waitcnt lgkmcnt(8)
    v_mfma_f32_16x16x32_bf16 v[168:171], v[128:131], v[160:163], v[168:171]
    s_waitcnt vmcnt(15)
    ds_write_b128 v14, v[28:31] offset:9216
    v_mfma_f32_16x16x32_bf16 v[172:175], v[136:139], v[160:163], v[172:175]
    s_waitcnt vmcnt(14)
    ds_write_b128 v15, v[32:35]
    v_mfma_f32_16x16x32_bf16 v[176:179], v[144:147], v[160:163], v[176:179]
    s_waitcnt vmcnt(13)
    ds_write_b128 v15, v[36:39] offset:1024
    v_mfma_f32_16x16x32_bf16 v[180:183], v[152:155], v[160:163], v[180:183]
    s_waitcnt vmcnt(12)
    ds_write_b128 v15, v[40:43] offset:2048
    s_mov_b32 s59, 0xf80
    buffer_load_dwordx4 v[104:107], v248, s[24:27], s59 offen
    s_waitcnt lgkmcnt(7)
    v_mfma_f32_16x16x32_bf16 v[168:171], v[132:135], v[164:167], v[168:171]
    s_waitcnt vmcnt(12)
    ds_write_b128 v15, v[44:47] offset:3072
    s_mov_b32 s59, 0xf80
    buffer_load_dwordx4 v[108:111], v249, s[24:27], s59 offen
    v_mfma_f32_16x16x32_bf16 v[172:175], v[140:143], v[164:167], v[172:175]
    s_waitcnt vmcnt(12)
    ds_write_b128 v15, v[64:67] offset:4096
    s_mov_b32 s59, 0x38180
    buffer_load_dwordx4 v[112:115], v248, s[24:27], s59 offen
    v_mfma_f32_16x16x32_bf16 v[176:179], v[148:151], v[164:167], v[176:179]
    s_waitcnt vmcnt(12)
    ds_write_b128 v15, v[68:71] offset:5120
    s_mov_b32 s59, 0x38180
    buffer_load_dwordx4 v[116:119], v249, s[24:27], s59 offen
    v_mfma_f32_16x16x32_bf16 v[180:183], v[156:159], v[164:167], v[180:183]
    s_waitcnt vmcnt(12)
    ds_write_b128 v15, v[72:75] offset:6144
    s_mov_b32 s59, 0x38f80
    buffer_load_dwordx4 v[120:123], v248, s[24:27], s59 offen
    s_waitcnt vmcnt(12)
    ds_write_b128 v15, v[76:79] offset:7168
    s_mov_b32 s59, 0x38f80
    buffer_load_dwordx4 v[124:127], v249, s[24:27], s59 offen
    s_waitcnt vmcnt(12)
    v_add_u32 v14, s62, v254
    s_mov_b32 exec_hi, 0
    ds_write_b128 v14, v[216:219] offset:4096
    s_mov_b32 exec_hi, -1
    s_lshl_b32 s59, s57, 2
    s_add_u32 s59, s59, 0x27c00
    v_mov_b32 v12, s59
    v_mov_b32 v13, 3
    s_mov_b64 exec, 1
    ds_write_b32 v12, v13 offset:48
    s_mov_b64 exec, -1
    s_movk_i32 s59, 0x1800
    s_mov_b32 exec_hi, 0
    buffer_load_dwordx4 v[220:223], v251, s[48:51], s59 offen
    s_mov_b32 exec_hi, -1
    s_waitcnt lgkmcnt(6)
    s_mov_b32 s59, 0xe0000
    buffer_load_dwordx4 v[16:19], v250, s[28:31], s59 offen
    s_waitcnt lgkmcnt(5)
    s_mov_b32 s59, 0xe0000
    buffer_load_dwordx4 v[20:23], v250, s[32:35], s59 offen
    s_waitcnt lgkmcnt(4)
    s_mov_b32 s59, 0xe7000
    buffer_load_dwordx4 v[24:27], v250, s[28:31], s59 offen
    s_waitcnt lgkmcnt(3)
    s_mov_b32 s59, 0xe7000
    buffer_load_dwordx4 v[28:31], v250, s[32:35], s59 offen
    s_waitcnt lgkmcnt(2)
    s_mov_b32 s59, 0x200
    buffer_load_dwordx4 v[32:35], v248, s[24:27], s59 offen
    s_waitcnt lgkmcnt(1)
    s_mov_b32 s59, 0x200
    buffer_load_dwordx4 v[36:39], v249, s[24:27], s59 offen
    s_mov_b32 s59, 0x1000
    buffer_load_dwordx4 v[40:43], v248, s[24:27], s59 offen
    s_mov_b32 s59, 0x1000
    buffer_load_dwordx4 v[44:47], v249, s[24:27], s59 offen
    s_mov_b32 s59, 0x38200
    buffer_load_dwordx4 v[64:67], v248, s[24:27], s59 offen
    s_mov_b32 s59, 0x38200
    buffer_load_dwordx4 v[68:71], v249, s[24:27], s59 offen
    s_mov_b32 s59, 0x39000
    buffer_load_dwordx4 v[72:75], v248, s[24:27], s59 offen
    s_mov_b32 s59, 0x39000
    buffer_load_dwordx4 v[76:79], v249, s[24:27], s59 offen
    s_movk_i32 s59, 0x2000
    s_mov_b32 exec_hi, 0
    buffer_load_dwordx4 v[216:219], v251, s[48:51], s59 offen
    s_mov_b32 exec_hi, -1
    s_lshl_b32 s59, s57, 2
    s_add_u32 s59, s59, 0x27c00
    v_mov_b32 v12, s59
    v_mov_b32 v13, 4
    s_mov_b64 exec, 1
    ds_write_b32 v12, v13 offset:80
    s_mov_b64 exec, -1
    v_min_u32 v12, 11, v1
    v_lshlrev_b32 v12, 2, v12
    v_add_u32 v12, 0x27c00, v12
    s_mov_b32 s59, 0
    s_branch LW_8_P0
LW_8_P:
    s_sleep 1
LW_8_P0:
    ds_read_b32 v13, v12 offset:48
    s_add_u32 s59, s59, 1
    s_waitcnt lgkmcnt(0)
    v_cmp_gt_u32 vcc, 3, v13
    s_cmp_ge_u32 s59, 0x8000
    s_cbranch_scc1 LW_8_G
    s_nop 2
    s_cbranch_vccnz LW_8_P
LW_8_G:
    v_add_u32 v252, 0xc000, v252
    v_add_u32 v253, 0xc000, v253
    ds_read_b128 v[160:163], v254 offset:4096
    ds_read_b128 v[128:131], v252
    ds_read_b128 v[136:139], v252 offset:2048
    ds_read_b128 v[144:147], v252 offset:4096
    ds_read_b128 v[152:155], v252 offset:6144
    ds_read_b128 v[164:167], v254 offset:5120
    ds_read_b128 v[132:135], v253
    ds_read_b128 v[140:143], v253 offset:2048
    ds_read_b128 v[148:151], v253 offset:4096
    ds_read_b128 v[156:159], v253 offset:6144
    s_add_u32 s59, s58, 0x8000
    v_add_u32 v14, s59, v3
    s_add_u32 s59, s100, 0
    v_add_u32 v15, s59, v3
    s_waitcnt vmcnt(25)
    ds_write_b128 v14, v[80:83]
    s_waitcnt vmcnt(24)
    ds_write_b128 v14, v[84:87] offset:8192
    s_waitcnt vmcnt(23)
    ds_write_b128 v14, v[88:91] offset:1024
    s_waitcnt lgkmcnt(2)
    s_mov_b32 s59, 0x118000
    buffer_load_dwordx4 v[80:83], v250, s[28:31], s59 offen
    v_mfma_f32_16x16x32_bf16 v[168:171], v[128:131], v[160:163], v[168:171]
    s_waitcnt vmcnt(23)
    ds_write_b128 v14, v[92:95] offset:9216
    s_waitcnt lgkmcnt(2)
    s_mov_b32 s59, 0x118000
    buffer_load_dwordx4 v[84:87], v250, s[32:35], s59 offen
    v_mfma_f32_16x16x32_bf16 v[172:175], v[136:139], v[160:163], v[172:175]
    s_waitcnt vmcnt(23)
    ds_write_b128 v15, v[96:99]
    s_waitcnt lgkmcnt(2)
    s_mov_b32 s59, 0x11f000
    buffer_load_dwordx4 v[88:91], v250, s[28:31], s59 offen
    v_mfma_f32_16x16x32_bf16 v[176:179], v[144:147], v[160:163], v[176:179]
    s_waitcnt vmcnt(23)
    ds_write_b128 v15, v[100:103] offset:1024
    s_waitcnt lgkmcnt(2)
    s_mov_b32 s59, 0x11f000
    buffer_load_dwordx4 v[92:95], v250, s[32:35], s59 offen
    v_mfma_f32_16x16x32_bf16 v[180:183], v[152:155], v[160:163], v[180:183]
    s_waitcnt vmcnt(23)
    ds_write_b128 v15, v[104:107] offset:2048
    s_waitcnt lgkmcnt(2)
    s_mov_b32 s59, 0x280
    buffer_load_dwordx4 v[96:99], v248, s[24:27], s59 offen
    v_mfma_f32_16x16x32_bf16 v[168:171], v[132:135], v[164:167], v[168:171]
    s_waitcnt vmcnt(23)
    ds_write_b128 v15, v[108:111] offset:3072
    s_waitcnt lgkmcnt(2)
    s_mov_b32 s59, 0x280
    buffer_load_dwordx4 v[100:103], v249, s[24:27], s59 offen
    v_mfma_f32_16x16x32_bf16 v[172:175], v[140:143], v[164:167], v[172:175]
    s_waitcnt vmcnt(23)
    ds_write_b128 v15, v[112:115] offset:4096
    s_waitcnt lgkmcnt(2)
    s_mov_b32 s59, 0x1080
    buffer_load_dwordx4 v[104:107], v248, s[24:27], s59 offen
    v_mfma_f32_16x16x32_bf16 v[176:179], v[148:151], v[164:167], v[176:179]
    s_waitcnt vmcnt(23)
    ds_write_b128 v15, v[116:119] offset:5120
    s_waitcnt lgkmcnt(2)
    s_mov_b32 s59, 0x1080
    buffer_load_dwordx4 v[108:111], v249, s[24:27], s59 offen
    v_mfma_f32_16x16x32_bf16 v[180:183], v[156:159], v[164:167], v[180:183]
    s_waitcnt vmcnt(23)
    ds_write_b128 v15, v[120:123] offset:6144
    s_waitcnt lgkmcnt(2)
    s_mov_b32 s59, 0x38280
    buffer_load_dwordx4 v[112:115], v248, s[24:27], s59 offen
    s_waitcnt vmcnt(23)
    ds_write_b128 v15, v[124:127] offset:7168
    s_waitcnt lgkmcnt(2)
    s_mov_b32 s59, 0x38280
    buffer_load_dwordx4 v[116:119], v249, s[24:27], s59 offen
    s_waitcnt vmcnt(23)
    v_add_u32 v14, s62, v254
    s_mov_b32 exec_hi, 0
    ds_write_b128 v14, v[220:223]
    s_mov_b32 exec_hi, -1
    s_lshl_b32 s59, s57, 2
    s_add_u32 s59, s59, 0x27c00
    v_mov_b32 v12, s59
    v_mov_b32 v13, 4
    s_mov_b64 exec, 1
    ds_write_b32 v12, v13 offset:48
    s_mov_b64 exec, -1
    s_waitcnt lgkmcnt(3)
    s_mov_b32 s59, 0x39080
    buffer_load_dwordx4 v[120:123], v248, s[24:27], s59 offen
    s_waitcnt lgkmcnt(2)
    s_mov_b32 s59, 0x39080
    buffer_load_dwordx4 v[124:127], v249, s[24:27], s59 offen
    s_waitcnt lgkmcnt(1)
    s_movk_i32 s59, 0x2800
    s_mov_b32 exec_hi, 0
    buffer_load_dwordx4 v[220:223], v251, s[48:51], s59 offen
    s_mov_b32 exec_hi, -1
    s_lshl_b32 s59, s57, 2
    s_add_u32 s59, s59, 0x27c00
    v_mov_b32 v12, s59
    v_mov_b32 v13, 5
    s_mov_b64 exec, 1
    ds_write_b32 v12, v13 offset:80
    s_mov_b64 exec, -1
    v_min_u32 v12, 11, v1
    v_lshlrev_b32 v12, 2, v12
    v_add_u32 v12, 0x27c00, v12
    s_mov_b32 s59, 0
    s_branch LW_9_P0
LW_9_P:
    s_sleep 1
LW_9_P0:
    ds_read_b32 v13, v12 offset:48
    s_add_u32 s59, s59, 1
    s_waitcnt lgkmcnt(0)
    v_cmp_gt_u32 vcc, 4, v13
    s_cmp_ge_u32 s59, 0x8000
    s_cbranch_scc1 LW_9_G
    s_nop 2
    s_cbranch_vccnz LW_9_P
LW_9_G:
    s_cmp_lt_u32 s57, 2
    s_cselect_b32 s59, 0x80, 0x40000000
    v_mov_b32 v11, s59
    buffer_load_dword v10, v11, s[36:39], 0 offen sc1
    v_add_u32 v252, 0xfffe8000, v252
    v_add_u32 v253, 0xfffe8000, v253
    ds_read_b128 v[160:163], v254
    ds_read_b128 v[128:131], v252
    ds_read_b128 v[136:139], v252 offset:2048
    ds_read_b128 v[144:147], v252 offset:4096
    ds_read_b128 v[152:155], v252 offset:6144
    ds_read_b128 v[164:167], v254 offset:1024
    ds_read_b128 v[132:135], v253
    ds_read_b128 v[140:143], v253 offset:2048
    ds_read_b128 v[148:151], v253 offset:4096
    ds_read_b128 v[156:159], v253 offset:6144
    s_add_u32 s59, s58, 0x14000
    v_add_u32 v14, s59, v3
    s_add_u32 s59, s100, 0xc000
    v_add_u32 v15, s59, v3
    s_waitcnt vmcnt(26)
    ds_write_b128 v14, v[16:19]
    s_waitcnt vmcnt(25)
    ds_write_b128 v14, v[20:23] offset:8192
    s_waitcnt vmcnt(24)
    ds_write_b128 v14, v[24:27] offset:1024
    s_waitcnt lgkmcnt(2)
    s_mov_b32 s59, 0x150000
    buffer_load_dwordx4 v[16:19], v250, s[28:31], s59 offen
    v_mfma_f32_16x16x32_bf16 v[168:171], v[128:131], v[160:163], v[168:171]
    s_waitcnt vmcnt(24)
    ds_write_b128 v14, v[28:31] offset:9216
    s_waitcnt lgkmcnt(2)
    s_mov_b32 s59, 0x150000
    buffer_load_dwordx4 v[20:23], v250, s[32:35], s59 offen
    v_mfma_f32_16x16x32_bf16 v[172:175], v[136:139], v[160:163], v[172:175]
    s_waitcnt vmcnt(24)
    ds_write_b128 v15, v[32:35]
    s_waitcnt lgkmcnt(2)
    s_mov_b32 s59, 0x157000
    buffer_load_dwordx4 v[24:27], v250, s[28:31], s59 offen
    v_mfma_f32_16x16x32_bf16 v[176:179], v[144:147], v[160:163], v[176:179]
    s_waitcnt vmcnt(24)
    ds_write_b128 v15, v[36:39] offset:1024
    s_waitcnt lgkmcnt(2)
    s_mov_b32 s59, 0x157000
    buffer_load_dwordx4 v[28:31], v250, s[32:35], s59 offen
    v_mfma_f32_16x16x32_bf16 v[180:183], v[152:155], v[160:163], v[180:183]
    s_waitcnt vmcnt(24)
    ds_write_b128 v15, v[40:43] offset:2048
    s_waitcnt lgkmcnt(2)
    s_mov_b32 s59, 0x300
    buffer_load_dwordx4 v[32:35], v248, s[24:27], s59 offen
    v_mfma_f32_16x16x32_bf16 v[168:171], v[132:135], v[164:167], v[168:171]
    s_waitcnt vmcnt(24)
    ds_write_b128 v15, v[44:47] offset:3072
    s_waitcnt lgkmcnt(2)
    s_mov_b32 s59, 0x300
    buffer_load_dwordx4 v[36:39], v249, s[24:27], s59 offen
    v_mfma_f32_16x16x32_bf16 v[172:175], v[140:143], v[164:167], v[172:175]
    s_waitcnt vmcnt(24)
    ds_write_b128 v15, v[64:67] offset:4096
    s_waitcnt lgkmcnt(2)
    s_mov_b32 s59, 0x1100
    buffer_load_dwordx4 v[40:43], v248, s[24:27], s59 offen
    v_mfma_f32_16x16x32_bf16 v[176:179], v[148:151], v[164:167], v[176:179]
    s_waitcnt vmcnt(24)
    ds_write_b128 v15, v[68:71] offset:5120
    s_waitcnt lgkmcnt(2)
    s_mov_b32 s59, 0x1100
    buffer_load_dwordx4 v[44:47], v249, s[24:27], s59 offen
    v_mfma_f32_16x16x32_bf16 v[180:183], v[156:159], v[164:167], v[180:183]
    s_waitcnt vmcnt(24)
    ds_write_b128 v15, v[72:75] offset:6144
    s_waitcnt lgkmcnt(2)
    s_mov_b32 s59, 0x38300
    buffer_load_dwordx4 v[64:67], v248, s[24:27], s59 offen
    s_waitcnt vmcnt(24)
    ds_write_b128 v15, v[76:79] offset:7168
    s_waitcnt lgkmcnt(2)
    s_mov_b32 s59, 0x38300
    buffer_load_dwordx4 v[68:71], v249, s[24:27], s59 offen
    s_waitcnt vmcnt(24)
    v_add_u32 v14, s62, v254
    s_mov_b32 exec_hi, 0
    ds_write_b128 v14, v[216:219] offset:2048
    s_mov_b32 exec_hi, -1
    s_lshl_b32 s59, s57, 2
    s_add_u32 s59, s59, 0x27c00
    v_mov_b32 v12, s59
    v_mov_b32 v13, 5
    s_mov_b64 exec, 1
    ds_write_b32 v12, v13 offset:48
    s_mov_b64 exec, -1
    s_waitcnt lgkmcnt(3)
    s_mov_b32 s59, 0x39100
    buffer_load_dwordx4 v[72:75], v248, s[24:27], s59 offen
    s_waitcnt lgkmcnt(2)
    s_mov_b32 s59, 0x39100
    buffer_load_dwordx4 v[76:79], v249, s[24:27], s59 offen
    s_waitcnt lgkmcnt(1)
    s_movk_i32 s59, 0x3000
    s_mov_b32 exec_hi, 0
    buffer_load_dwordx4 v[216:219], v251, s[48:51], s59 offen
    s_mov_b32 exec_hi, -1
    s_lshl_b32 s59, s57, 2
    s_add_u32 s59, s59, 0x27c00
    v_mov_b32 v12, s59
    v_mov_b32 v13, 6
    s_mov_b64 exec, 1
    ds_write_b32 v12, v13 offset:80
    s_mov_b64 exec, -1
    v_min_u32 v12, 11, v1
    v_lshlrev_b32 v12, 2, v12
    v_add_u32 v12, 0x27c00, v12
    s_mov_b32 s59, 0
    s_branch LW_10_P0
LW_10_P:
    s_sleep 1
LW_10_P0:
    ds_read_b32 v13, v12 offset:48
    s_add_u32 s59, s59, 1
    s_waitcnt lgkmcnt(0)
    v_cmp_gt_u32 vcc, 5, v13
    s_cmp_ge_u32 s59, 0x8000
    s_cbranch_scc1 LW_10_G
    s_nop 2
    s_cbranch_vccnz LW_10_P
LW_10_G:
    s_cmp_ge_u32 s57, 2
    s_cbranch_scc1 GC_11
    s_waitcnt vmcnt(13)
    v_cmp_ne_u32 vcc, 1, v10
    s_nop 4
    s_cbranch_vccz GO0_G
GO0_P:
    s_add_u32 s66, s66, 1
    buffer_load_dword v10, v11, s[36:39], 0 offen sc1
    s_waitcnt vmcnt(0)
    v_cmp_ne_u32 vcc, 1, v10
    s_nop 4
    s_nop 4
    s_cbranch_vccz GO0_G
    s_cmp_ge_u32 s66, 0xfa0
    s_cbranch_scc1 GO0_G
    s_sleep 2
    s_branch GO0_P
GO0_G:
GC_11:
    v_mov_b32 v11, 0
    s_lshl_b32 s59, s55, 11
    s_add_u32 s59, s59, 0xe00000
    s_cmp_eq_u32 s57, 0
    s_cselect_b32 s59, s59, 0x40000000
    v_add3_u32 v11, v11, v3, s59
    buffer_load_dwordx4 v[184:187], v11, s[44:47], 0 offen sc1
    buffer_load_dwordx4 v[188:191], v11, s[44:47], 0 offen offset:1024 sc1
    v_add_u32 v252, 0xc000, v252
    v_add_u32 v253, 0xc000, v253
    ds_read_b128 v[160:163], v254 offset:2048
    ds_read_b128 v[128:131], v252
    ds_read_b128 v[136:139], v252 offset:2048
    ds_read_b128 v[144:147], v252 offset:4096
    ds_read_b128 v[152:155], v252 offset:6144
    ds_read_b128 v[164:167], v254 offset:3072
    ds_read_b128 v[132:135], v253
    ds_read_b128 v[140:143], v253 offset:2048
    ds_read_b128 v[148:151], v253 offset:4096
    ds_read_b128 v[156:159], v253 offset:6144
    s_add_u32 s59, s58, 0x20000
    v_add_u32 v14, s59, v3
    s_add_u32 s59, s100, 0x18000
    v_add_u32 v15, s59, v3
    s_waitcnt vmcnt(28)
    ds_write_b128 v14, v[80:83]
    s_waitcnt vmcnt(27)
    ds_write_b128 v14, v[84:87] offset:8192
    s_waitcnt vmcnt(26)
    ds_write_b128 v14, v[88:91] offset:1024
    s_waitcnt lgkmcnt(2)
    s_add_u32 s61, s10, 2
    s_sub_u32 s59, s61, 8
    s_cmp_ge_u32 s61, 8
    s_cselect_b32 s61, s59, s61
    s_mul_i32 s59, s57, 8
    s_add_u32 s61, s61, s59
    s_add_u32 s61, s61, 0x50
    s_mul_i32 s61, s61, 0x3800
    buffer_load_dwordx4 v[80:83], v0, s[40:43], s61 offen
    v_mfma_f32_16x16x32_bf16 v[168:171], v[128:131], v[160:163], v[168:171]
    s_waitcnt vmcnt(26)
    ds_write_b128 v14, v[92:95] offset:9216
    s_waitcnt lgkmcnt(2)
    s_add_u32 s61, s10, 2
    s_sub_u32 s59, s61, 8
    s_cmp_ge_u32 s61, 8
    s_cselect_b32 s61, s59, s61
    s_mul_i32 s59, s57, 8
    s_add_u32 s61, s61, s59
    s_add_u32 s61, s61, 0x50
    s_mul_i32 s61, s61, 0x3800
    s_add_u32 s61, s61, 0x1c00
    buffer_load_dwordx4 v[84:87], v0, s[40:43], s61 offen
    v_mfma_f32_16x16x32_bf16 v[172:175], v[136:139], v[160:163], v[172:175]
    s_waitcnt vmcnt(26)
    ds_write_b128 v15, v[96:99]
    s_waitcnt lgkmcnt(2)
    s_add_u32 s61, s10, 3
    s_sub_u32 s59, s61, 8
    s_cmp_ge_u32 s61, 8
    s_cselect_b32 s61, s59, s61
    s_mul_i32 s59, s57, 8
    s_add_u32 s61, s61, s59
    s_add_u32 s61, s61, 0x50
    s_mul_i32 s61, s61, 0x3800
    buffer_load_dwordx4 v[88:91], v0, s[40:43], s61 offen
    v_mfma_f32_16x16x32_bf16 v[176:179], v[144:147], v[160:163], v[176:179]
    s_waitcnt vmcnt(26)
    ds_write_b128 v15, v[100:103] offset:1024
    s_waitcnt lgkmcnt(2)
    s_add_u32 s61, s10, 3
    s_sub_u32 s59, s61, 8
    s_cmp_ge_u32 s61, 8
    s_cselect_b32 s61, s59, s61
    s_mul_i32 s59, s57, 8
    s_add_u32 s61, s61, s59
    s_add_u32 s61, s61, 0x50
    s_mul_i32 s61, s61, 0x3800
    s_add_u32 s61, s61, 0x1c00
    buffer_load_dwordx4 v[92:95], v0, s[40:43], s61 offen
    v_mfma_f32_16x16x32_bf16 v[180:183], v[152:155], v[160:163], v[180:183]
    s_waitcnt vmcnt(26)
    ds_write_b128 v15, v[104:107] offset:2048
    s_waitcnt lgkmcnt(2)
    s_add_u32 s61, s10, 4
    s_sub_u32 s59, s61, 8
    s_cmp_ge_u32 s61, 8
    s_cselect_b32 s61, s59, s61
    s_mul_i32 s59, s57, 8
    s_add_u32 s61, s61, s59
    s_add_u32 s61, s61, 0x50
    s_mul_i32 s61, s61, 0x3800
    buffer_load_dwordx4 v[96:99], v0, s[40:43], s61 offen
    v_mfma_f32_16x16x32_bf16 v[168:171], v[132:135], v[164:167], v[168:171]
    s_waitcnt vmcnt(26)
    ds_write_b128 v15, v[108:111] offset:3072
    s_waitcnt lgkmcnt(2)
    s_add_u32 s61, s10, 4
    s_sub_u32 s59, s61, 8
    s_cmp_ge_u32 s61, 8
    s_cselect_b32 s61, s59, s61
    s_mul_i32 s59, s57, 8
    s_add_u32 s61, s61, s59
    s_add_u32 s61, s61, 0x50
    s_mul_i32 s61, s61, 0x3800
    s_add_u32 s61, s61, 0x1c00
    buffer_load_dwordx4 v[100:103], v0, s[40:43], s61 offen
    v_mfma_f32_16x16x32_bf16 v[172:175], v[140:143], v[164:167], v[172:175]
    s_waitcnt vmcnt(26)
    ds_write_b128 v15, v[112:115] offset:4096
    s_waitcnt lgkmcnt(2)
    s_add_u32 s61, s10, 5
    s_sub_u32 s59, s61, 8
    s_cmp_ge_u32 s61, 8
    s_cselect_b32 s61, s59, s61
    s_mul_i32 s59, s57, 8
    s_add_u32 s61, s61, s59
    s_add_u32 s61, s61, 0x50
    s_mul_i32 s61, s61, 0x3800
    buffer_load_dwordx4 v[104:107], v0, s[40:43], s61 offen
    v_mfma_f32_16x16x32_bf16 v[176:179], v[148:151], v[164:167], v[176:179]
    s_waitcnt vmcnt(26)
    ds_write_b128 v15, v[116:119] offset:5120
    s_waitcnt lgkmcnt(2)
    s_add_u32 s61, s10, 5
    s_sub_u32 s59, s61, 8
    s_cmp_ge_u32 s61, 8
    s_cselect_b32 s61, s59, s61
    s_mul_i32 s59, s57, 8
    s_add_u32 s61, s61, s59
    s_add_u32 s61, s61, 0x50
    s_mul_i32 s61, s61, 0x3800
    s_add_u32 s61, s61, 0x1c00
    buffer_load_dwordx4 v[108:111], v0, s[40:43], s61 offen
    v_mfma_f32_16x16x32_bf16 v[180:183], v[156:159], v[164:167], v[180:183]
    s_waitcnt vmcnt(26)
    ds_write_b128 v15, v[120:123] offset:6144
    s_waitcnt lgkmcnt(2)
    s_add_u32 s61, s10, 6
    s_sub_u32 s59, s61, 8
    s_cmp_ge_u32 s61, 8
    s_cselect_b32 s61, s59, s61
    s_mul_i32 s59, s57, 8
    s_add_u32 s61, s61, s59
    s_add_u32 s61, s61, 0x50
    s_mul_i32 s61, s61, 0x3800
    buffer_load_dwordx4 v[112:115], v0, s[40:43], s61 offen
    s_waitcnt vmcnt(26)
    ds_write_b128 v15, v[124:127] offset:7168
    s_waitcnt lgkmcnt(2)
    s_add_u32 s61, s10, 6
    s_sub_u32 s59, s61, 8
    s_cmp_ge_u32 s61, 8
    s_cselect_b32 s61, s59, s61
    s_mul_i32 s59, s57, 8
    s_add_u32 s61, s61, s59
    s_add_u32 s61, s61, 0x50
    s_mul_i32 s61, s61, 0x3800
    s_add_u32 s61, s61, 0x1c00
    buffer_load_dwordx4 v[116:119], v0, s[40:43], s61 offen
    s_waitcnt vmcnt(26)
    v_add_u32 v14, s62, v254
    s_mov_b32 exec_hi, 0
    ds_write_b128 v14, v[220:223] offset:4096
    s_mov_b32 exec_hi, -1
    s_lshl_b32 s59, s57, 2
    s_add_u32 s59, s59, 0x27c00
    v_mov_b32 v12, s59
    v_mov_b32 v13, 6
    s_mov_b64 exec, 1
    ds_write_b32 v12, v13 offset:48
    s_mov_b64 exec, -1
    s_waitcnt lgkmcnt(3)
    s_add_u32 s61, s10, 7
    s_sub_u32 s59, s61, 8
    s_cmp_ge_u32 s61, 8
    s_cselect_b32 s61, s59, s61
    s_mul_i32 s59, s57, 8
    s_add_u32 s61, s61, s59
    s_add_u32 s61, s61, 0x50
    s_mul_i32 s61, s61, 0x3800
    buffer_load_dwordx4 v[120:123], v0, s[40:43], s61 offen
    s_waitcnt lgkmcnt(2)
    s_add_u32 s61, s10, 7
    s_sub_u32 s59, s61, 8
    s_cmp_ge_u32 s61, 8
    s_cselect_b32 s61, s59, s61
    s_mul_i32 s59, s57, 8
    s_add_u32 s61, s61, s59
    s_add_u32 s61, s61, 0x50
    s_mul_i32 s61, s61, 0x3800
    s_add_u32 s61, s61, 0x1c00
    buffer_load_dwordx4 v[124:127], v0, s[40:43], s61 offen
    s_lshl_b32 s59, s57, 2
    s_add_u32 s59, s59, 0x27c00
    v_mov_b32 v12, s59
    v_mov_b32 v13, 7
    s_mov_b64 exec, 1
    ds_write_b32 v12, v13 offset:80
    s_mov_b64 exec, -1
    v_min_u32 v12, 11, v1
    v_lshlrev_b32 v12, 2, v12
    v_add_u32 v12, 0x27c00, v12
    s_mov_b32 s59, 0
    s_branch LW_12_P0
LW_12_P:
    s_sleep 1
LW_12_P0:
    ds_read_b32 v13, v12 offset:48
    s_add_u32 s59, s59, 1
    s_waitcnt lgkmcnt(0)
    v_cmp_gt_u32 vcc, 6, v13
    s_cmp_ge_u32 s59, 0x8000
    s_cbranch_scc1 LW_12_G
    s_nop 2
    s_cbranch_vccnz LW_12_P
LW_12_G:
    v_and_b32 v12, 3, v1
    v_lshlrev_b32 v12, 2, v12
    v_add_u32 v12, 0x27c00, v12
    s_mov_b32 s59, 0
LW_13_P:
    ds_read_b32 v13, v12 offset:80
    s_add_u32 s59, s59, 1
    s_waitcnt lgkmcnt(0)
    v_cmp_gt_u32 vcc, 7, v13
    s_cmp_ge_u32 s59, 0x8000
    s_cbranch_scc1 LW_13_G
    s_nop 2
    s_cbranch_vccnz LW_13_P
LW_13_G:
    s_cmp_lg_u32 s57, 0
    s_cbranch_scc1 CS_14
    s_waitcnt vmcnt(12)
    s_branch CS_14C
CS_14P:
    s_sleep 2
    s_add_u32 s66, s66, 1
    buffer_load_dwordx4 v[184:187], v11, s[44:47], 0 offen sc1
    buffer_load_dwordx4 v[188:191], v11, s[44:47], 0 offen offset:1024 sc1
    s_waitcnt vmcnt(0)
CS_14C:
    v_min_u32 v12, v185, v187
    v_min3_u32 v12, v12, v189, v191
    v_cmp_eq_u32 vcc, 0, v12
    s_cmp_ge_u32 s66, 0xfa0
    s_cbranch_scc1 CS_14G
    s_nop 4
    s_nop 4
    s_cbranch_vccnz CS_14P
CS_14G:
    v_add_u32 v12, 0x26800, v3
    ds_write_b128 v12, v[184:187]
    ds_write_b128 v12, v[188:191] offset:1024
    s_lshl_b32 s59, s57, 2
    s_add_u32 s59, s59, 0x27c00
    v_mov_b32 v12, s59
    v_mov_b32 v13, 1
    s_mov_b64 exec, 1
    ds_write_b32 v12, v13 offset:112
    s_mov_b64 exec, -1
CS_14:
    v_add_u32 v252, 0xc000, v252
    v_add_u32 v253, 0xc000, v253
    ds_read_b128 v[160:163], v254 offset:4096
    ds_read_b128 v[128:131], v252
    ds_read_b128 v[136:139], v252 offset:2048
    ds_read_b128 v[144:147], v252 offset:4096
    ds_read_b128 v[152:155], v252 offset:6144
    ds_read_b128 v[164:167], v254 offset:5120
    ds_read_b128 v[132:135], v253
    ds_read_b128 v[140:143], v253 offset:2048
    ds_read_b128 v[148:151], v253 offset:4096
    ds_read_b128 v[156:159], v253 offset:6144
    s_add_u32 s59, s58, 0x8000
    v_add_u32 v14, s59, v3
    s_add_u32 s59, s100, 0
    v_add_u32 v15, s59, v3
    s_waitcnt vmcnt(26)
    ds_write_b128 v14, v[16:19]
    s_waitcnt vmcnt(25)
    ds_write_b128 v14, v[20:23] offset:8192
    s_waitcnt vmcnt(24)
    ds_write_b128 v14, v[24:27] offset:1024
    s_mov_b32 s59, 0xc4000
    buffer_load_dwordx4 v[226:229], v3, s[48:51], s59 offen
    s_waitcnt lgkmcnt(8)
    v_mfma_f32_16x16x32_bf16 v[168:171], v[128:131], v[160:163], v[168:171]
    s_waitcnt vmcnt(24)
    ds_write_b128 v14, v[28:31] offset:9216
    s_mov_b32 s59, 0xc4400
    buffer_load_dwordx4 v[232:235], v3, s[48:51], s59 offen
    v_mfma_f32_16x16x32_bf16 v[172:175], v[136:139], v[160:163], v[172:175]
    s_waitcnt vmcnt(24)
    ds_write_b128 v15, v[32:35]
    s_mov_b32 s59, 0xc4800
    buffer_load_dwordx4 v[238:241], v3, s[48:51], s59 offen
    v_mfma_f32_16x16x32_bf16 v[176:179], v[144:147], v[160:163], v[176:179]
    s_waitcnt vmcnt(24)
    ds_write_b128 v15, v[36:39] offset:1024
    s_mov_b32 s59, 0xc4c00
    buffer_load_dwordx4 v[244:247], v3, s[48:51], s59 offen
    v_mfma_f32_16x16x32_bf16 v[180:183], v[152:155], v[160:163], v[180:183]
    s_waitcnt vmcnt(24)
    ds_write_b128 v15, v[40:43] offset:2048
    s_mul_i32 s59, s57, 0x800
    s_add_u32 s59, s59, 0xc9000
    buffer_load_dwordx4 v[48:51], v3, s[48:51], s59 offen
    s_waitcnt lgkmcnt(7)
    v_mfma_f32_16x16x32_bf16 v[168:171], v[132:135], v[164:167], v[168:171]
    s_waitcnt vmcnt(24)
    ds_write_b128 v15, v[44:47] offset:3072
    s_mul_i32 s59, s57, 0x800
    s_add_u32 s59, s59, 0xc9400
    buffer_load_dwordx4 v[52:55], v3, s[48:51], s59 offen
    v_mfma_f32_16x16x32_bf16 v[172:175], v[140:143], v[164:167], v[172:175]
    s_waitcnt vmcnt(24)
    ds_write_b128 v15, v[64:67] offset:4096
    s_mul_i32 s59, s57, 0x1000
    s_add_u32 s59, s59, 0xc5000
    buffer_load_dwordx4 v[194:197], v3, s[48:51], s59 offen
    v_mfma_f32_16x16x32_bf16 v[176:179], v[148:151], v[164:167], v[176:179]
    s_waitcnt vmcnt(24)
    ds_write_b128 v15, v[68:71] offset:5120
    s_mul_i32 s59, s57, 0x1000
    s_add_u32 s59, s59, 0xc5400
    buffer_load_dwordx4 v[200:203], v3, s[48:51], s59 offen
    v_mfma_f32_16x16x32_bf16 v[180:183], v[156:159], v[164:167], v[180:183]
    s_waitcnt vmcnt(24)
    ds_write_b128 v15, v[72:75] offset:6144
    s_mul_i32 s59, s57, 0x1000
    s_add_u32 s59, s59, 0xc5800
    buffer_load_dwordx4 v[206:209], v3, s[48:51], s59 offen
    s_waitcnt vmcnt(24)
    ds_write_b128 v15, v[76:79] offset:7168
    s_mul_i32 s59, s57, 0x1000
    s_add_u32 s59, s59, 0xc5c00
    buffer_load_dwordx4 v[212:215], v3, s[48:51], s59 offen
    s_waitcnt vmcnt(24)
    v_add_u32 v14, s62, v254
    s_mov_b32 exec_hi, 0
    ds_write_b128 v14, v[216:219]
    s_mov_b32 exec_hi, -1
    s_lshl_b32 s59, s57, 2
    s_add_u32 s59, s59, 0x27c00
    v_mov_b32 v12, s59
    v_mov_b32 v13, 7
    s_mov_b64 exec, 1
    ds_write_b32 v12, v13 offset:48
    s_mov_b64 exec, -1
    s_mul_i32 s59, s57, 0x800
    s_add_u32 s59, s59, 0xcb000
    buffer_load_dwordx4 v[56:59], v3, s[48:51], s59 offen
    s_mul_i32 s59, s57, 0x800
    s_add_u32 s59, s59, 0xcb400
    buffer_load_dwordx4 v[60:63], v3, s[48:51], s59 offen
    s_lshl_b32 s59, s57, 2
    s_add_u32 s59, s59, 0x27c00
    v_mov_b32 v12, s59
    v_mov_b32 v13, 8
    s_mov_b64 exec, 1
    ds_write_b32 v12, v13 offset:80
    s_mov_b64 exec, -1
    v_lshrrev_b32 v10, 5, v1
    v_mul_u32_u24 v10, 0x3600, v10
    s_lshl_b32 s59, s56, 9
    s_add_u32 s59, s59, 0xe04000
    s_cmp_eq_u32 s57, 1
    s_cselect_b32 s59, s59, 0x40000000
    v_add3_u32 v10, v10, v3, s59
    buffer_load_dwordx4 v[220:223], v10, s[44:47], 0 offen sc1
    v_and_b32 v12, 3, v1
    v_lshlrev_b32 v12, 2, v12
    v_add_u32 v12, 0x27c00, v12
    s_mov_b32 s59, 0
LW_15_P:
    ds_read_b32 v13, v12 offset:48
    s_add_u32 s59, s59, 1
    s_waitcnt lgkmcnt(0)
    v_cmp_gt_u32 vcc, 7, v13
    s_cmp_ge_u32 s59, 0x8000
    s_cbranch_scc1 LW_15_G
    s_nop 2
    s_cbranch_vccnz LW_15_P
LW_15_G:
    v_add_u32 v252, 0xfffe8000, v252
    v_add_u32 v253, 0xfffe8000, v253
    ds_read_b128 v[160:163], v254
    ds_read_b128 v[128:131], v252
    ds_read_b128 v[136:139], v252 offset:2048
    ds_read_b128 v[144:147], v252 offset:4096
    ds_read_b128 v[152:155], v252 offset:6144
    ds_read_b128 v[164:167], v254 offset:1024
    ds_read_b128 v[132:135], v253
    ds_read_b128 v[140:143], v253 offset:2048
    ds_read_b128 v[148:151], v253 offset:4096
    ds_read_b128 v[156:159], v253 offset:6144
    s_lshl_b32 s59, s57, 2
    s_add_u32 s59, s59, 0x27c00
    v_mov_b32 v12, s59
    v_mov_b32 v13, 9
    s_mov_b64 exec, 1
    ds_write_b32 v12, v13 offset:80
    s_mov_b64 exec, -1
    v_mov_b32 v12, 0x27c00
    s_mov_b32 s59, 0
LW_16_P:
    ds_read_b32 v13, v12 offset:112
    s_add_u32 s59, s59, 1
    s_waitcnt lgkmcnt(0)
    v_cmp_gt_u32 vcc, 1, v13
    s_cmp_ge_u32 s59, 0x8000
    s_cbranch_scc1 LW_16_G
    s_nop 2
    s_cbranch_vccnz LW_16_P
LW_16_G:
    v_lshrrev_b32 v12, 4, v1
    v_lshlrev_b32 v12, 5, v12
    s_lshl_b32 s59, s57, 9
    s_add_u32 s59, s59, 0x26800
    v_add_u32 v12, s59, v12
    ds_read_b128 v[16:19], v12
    ds_read_b128 v[20:23], v12 offset:16
    ds_read_b128 v[24:27], v12 offset:128
    ds_read_b128 v[28:31], v12 offset:144
    ds_read_b128 v[32:35], v12 offset:256
    ds_read_b128 v[36:39], v12 offset:272
    ds_read_b128 v[40:43], v12 offset:384
    ds_read_b128 v[44:47], v12 offset:400
    v_mfma_f32_16x16x32_bf16 v[168:171], v[128:131], v[160:163], v[168:171]
    v_mfma_f32_16x16x32_bf16 v[172:175], v[136:139], v[160:163], v[172:175]
    v_mfma_f32_16x16x32_bf16 v[176:179], v[144:147], v[160:163], v[176:179]
    v_mfma_f32_16x16x32_bf16 v[180:183], v[152:155], v[160:163], v[180:183]
    v_mfma_f32_16x16x32_bf16 v[168:171], v[132:135], v[164:167], v[168:171]
    v_mfma_f32_16x16x32_bf16 v[172:175], v[140:143], v[164:167], v[172:175]
    v_mfma_f32_16x16x32_bf16 v[176:179], v[148:151], v[164:167], v[176:179]
    v_mfma_f32_16x16x32_bf16 v[180:183], v[156:159], v[164:167], v[180:183]
    v_and_b32 v13, 7, v1
    v_lshrrev_b32 v14, 3, v1
    v_lshlrev_b32 v14, 3, v14
    v_lshl_add_u32 v13, v13, 7, v14
    s_add_u32 s59, s58, 0x24000
    v_add_u32 v13, s59, v13
    v_lshrrev_b32 v14, 3, v1
    v_and_b32 v15, 7, v1
    v_lshlrev_b32 v15, 4, v15
    v_lshl_add_u32 v14, v14, 13, v15
    s_lshr_b32 s60, s55, 1
    s_lshl_b32 s60, s60, 11
    s_and_b32 s61, s55, 1
    s_lshl_b32 s61, s61, 7
    s_add_u32 s60, s60, s61
    s_lshl_b32 s61, s57, 9
    s_add_u32 s60, s60, s61
    s_add_u32 s60, s60, 0x800000
    s_lshl_b32 s61, s56, 16
    s_add_u32 s61, s61, s60
    s_waitcnt lgkmcnt(6)
    v_fma_f32 v168, -v16, v255, v168
    v_fma_f32 v169, -v18, v255, v169
    v_fma_f32 v170, -v20, v255, v170
    v_fma_f32 v171, -v22, v255, v171
    v_mul_f32 v168, v168, v17
    v_mul_f32 v169, v169, v19
    v_mul_f32 v170, v170, v21
    v_mul_f32 v171, v171, v23
    v_cvt_pk_bf16_f32 v168, v168, v169
    v_cvt_pk_bf16_f32 v169, v170, v171
    ds_write_b64 v13, v[168:169]
    s_waitcnt lgkmcnt(5)
    v_fma_f32 v172, -v24, v255, v172
    v_fma_f32 v173, -v26, v255, v173
    v_fma_f32 v174, -v28, v255, v174
    v_fma_f32 v175, -v30, v255, v175
    v_mul_f32 v172, v172, v25
    v_mul_f32 v173, v173, v27
    v_mul_f32 v174, v174, v29
    v_mul_f32 v175, v175, v31
    v_cvt_pk_bf16_f32 v172, v172, v173
    v_cvt_pk_bf16_f32 v173, v174, v175
    ds_write_b64 v13, v[172:173] offset:64
    s_waitcnt lgkmcnt(4)
    v_fma_f32 v176, -v32, v255, v176
    v_fma_f32 v177, -v34, v255, v177
    v_fma_f32 v178, -v36, v255, v178
    v_fma_f32 v179, -v38, v255, v179
    v_mul_f32 v176, v176, v33
    v_mul_f32 v177, v177, v35
    v_mul_f32 v178, v178, v37
    v_mul_f32 v179, v179, v39
    v_cvt_pk_bf16_f32 v176, v176, v177
    v_cvt_pk_bf16_f32 v177, v178, v179
    ds_write_b64 v13, v[176:177] offset:1024
    s_waitcnt lgkmcnt(3)
    v_fma_f32 v180, -v40, v255, v180
    v_fma_f32 v181, -v42, v255, v181
    v_fma_f32 v182, -v44, v255, v182
    v_fma_f32 v183, -v46, v255, v183
    v_mul_f32 v180, v180, v41
    v_mul_f32 v181, v181, v43
    v_mul_f32 v182, v182, v45
    v_mul_f32 v183, v183, v47
    v_cvt_pk_bf16_f32 v180, v180, v181
    v_cvt_pk_bf16_f32 v181, v182, v183
    ds_write_b64 v13, v[180:181] offset:1088
    ds_read_b128 v[160:163], v7
    ds_read_b128 v[164:167], v7 offset:1024
    s_waitcnt lgkmcnt(0)
    s_cmp_lg_u32 s56, 0
    s_cbranch_scc1 SP_17
    s_mov_b64 exec, 0xff
    s_add_u32 s60, s60, 0x1c0000
    v_mov_b32 v128, v162
    v_mov_b32 v129, v163
    v_mov_b32 v130, 0
    v_mov_b32 v131, 0
    v_mov_b32 v162, 0
    v_mov_b32 v163, 0
    buffer_store_dwordx4 v[128:131], v14, s[44:47], s60 offen sc1
    v_mov_b32 v132, v166
    v_mov_b32 v133, v167
    v_mov_b32 v134, 0
    v_mov_b32 v135, 0
    v_mov_b32 v166, 0
    v_mov_b32 v167, 0
    buffer_store_dwordx4 v[132:135], v14, s[44:47], s60 offen offset:256 sc1
    s_mov_b64 exec, -1
SP_17:
    buffer_store_dwordx4 v[160:163], v14, s[44:47], s61 offen sc1
    buffer_store_dwordx4 v[164:167], v14, s[44:47], s61 offen offset:256 sc1
    s_cmp_lg_u32 s57, 1
    s_cbranch_scc1 CS_18
    s_waitcnt vmcnt(2)
    s_branch CS_18C
CS_18P:
    s_sleep 2
    s_add_u32 s66, s66, 1
    buffer_load_dwordx4 v[220:223], v10, s[44:47], 0 offen sc1
    s_waitcnt vmcnt(0)
CS_18C:
    v_and_b32 v12, v221, v223
    v_lshrrev_b32 v12, 16, v12
    v_cmp_ne_u32 vcc, 0x3f80, v12
    s_cmp_ge_u32 s66, 0xfa0
    s_cbranch_scc1 CS_18G
    s_nop 4
    s_nop 4
    s_cbranch_vccnz CS_18P
CS_18G:
    v_add_u32 v12, 0x27800, v3
    ds_write_b128 v12, v[220:223]
    s_lshl_b32 s59, s57, 2
    s_add_u32 s59, s59, 0x27c00
    v_mov_b32 v12, s59
    v_mov_b32 v13, 1
    s_mov_b64 exec, 1
    ds_write_b32 v12, v13 offset:112
    s_mov_b64 exec, -1
CS_18:
    s_add_u32 s61, s10, 0
    s_sub_u32 s59, s61, 8
    s_cmp_ge_u32 s61, 8
    s_cselect_b32 s61, s59, s61
    s_mul_i32 s59, s57, 8
    s_add_u32 s61, s61, s59
    s_add_u32 s61, s61, 0x50
    s_mul_i32 s61, s61, 0x3800
    buffer_load_dwordx4 v[64:67], v0, s[40:43], s61 offen
    s_add_u32 s61, s10, 0
    s_sub_u32 s59, s61, 8
    s_cmp_ge_u32 s61, 8
    s_cselect_b32 s61, s59, s61
    s_mul_i32 s59, s57, 8
    s_add_u32 s61, s61, s59
    s_add_u32 s61, s61, 0x50
    s_mul_i32 s61, s61, 0x3800
    s_add_u32 s61, s61, 0x1c00
    buffer_load_dwordx4 v[68:71], v0, s[40:43], s61 offen
    s_add_u32 s61, s10, 1
    s_sub_u32 s59, s61, 8
    s_cmp_ge_u32 s61, 8
    s_cselect_b32 s61, s59, s61
    s_mul_i32 s59, s57, 8
    s_add_u32 s61, s61, s59
    s_add_u32 s61, s61, 0x50
    s_mul_i32 s61, s61, 0x3800
    buffer_load_dwordx4 v[72:75], v0, s[40:43], s61 offen
    s_add_u32 s61, s10, 1
    s_sub_u32 s59, s61, 8
    s_cmp_ge_u32 s61, 8
    s_cselect_b32 s61, s59, s61
    s_mul_i32 s59, s57, 8
    s_add_u32 s61, s61, s59
    s_add_u32 s61, s61, 0x50
    s_mul_i32 s61, s61, 0x3800
    s_add_u32 s61, s61, 0x1c00
    buffer_load_dwordx4 v[76:79], v0, s[40:43], s61 offen
    v_and_b32 v12, 7, v1
    v_lshlrev_b32 v12, 2, v12
    v_add_u32 v12, 0x27c00, v12
    s_mov_b32 s59, 0
    s_branch LW_19_P0
LW_19_P:
    s_sleep 1
LW_19_P0:
    ds_read_b32 v13, v12 offset:64
    s_add_u32 s59, s59, 1
    s_waitcnt lgkmcnt(0)
    v_cmp_gt_u32 vcc, 7, v13
    s_cmp_ge_u32 s59, 0x8000
    s_cbranch_scc1 LW_19_G
    s_nop 2
    s_cbranch_vccnz LW_19_P
LW_19_G:
    s_add_u32 s61, s67, 0
    s_sub_u32 s59, s61, 20
    s_cmp_ge_u32 s61, 20
    s_cselect_b32 s61, s59, s61
    s_mul_i32 s59, s57, 20
    s_add_u32 s61, s61, s59
    s_mul_i32 s61, s61, 0x3800
    s_add_u32 m0, s58, 0xc000
    s_nop 0
    buffer_load_dwordx4 v0, s[40:43], s61 offen lds
    s_add_u32 s61, s61, 0x1c00
    s_add_u32 m0, s58, 0xc400
    s_nop 0
    buffer_load_dwordx4 v0, s[40:43], s61 offen lds
    s_add_u32 s61, s67, 1
    s_sub_u32 s59, s61, 20
    s_cmp_ge_u32 s61, 20
    s_cselect_b32 s61, s59, s61
    s_mul_i32 s59, s57, 20
    s_add_u32 s61, s61, s59
    s_mul_i32 s61, s61, 0x3800
    s_add_u32 m0, s58, 0xe000
    s_nop 0
    buffer_load_dwordx4 v0, s[40:43], s61 offen lds
    s_add_u32 s61, s61, 0x1c00
    s_add_u32 m0, s58, 0xe400
    s_nop 0
    buffer_load_dwordx4 v0, s[40:43], s61 offen lds
    s_add_u32 s61, s67, 2
    s_sub_u32 s59, s61, 20
    s_cmp_ge_u32 s61, 20
    s_cselect_b32 s61, s59, s61
    s_mul_i32 s59, s57, 20
    s_add_u32 s61, s61, s59
    s_mul_i32 s61, s61, 0x3800
    s_add_u32 m0, s58, 0x10000
    s_nop 0
    buffer_load_dwordx4 v0, s[40:43], s61 offen lds
    s_add_u32 s61, s61, 0x1c00
    s_add_u32 m0, s58, 0x10400
    s_nop 0
    buffer_load_dwordx4 v0, s[40:43], s61 offen lds
    s_add_u32 s61, s67, 3
    s_sub_u32 s59, s61, 20
    s_cmp_ge_u32 s61, 20
    s_cselect_b32 s61, s59, s61
    s_mul_i32 s59, s57, 20
    s_add_u32 s61, s61, s59
    s_mul_i32 s61, s61, 0x3800
    s_add_u32 m0, s58, 0x12000
    s_nop 0
    buffer_load_dwordx4 v0, s[40:43], s61 offen lds
    s_add_u32 s61, s61, 0x1c00
    s_add_u32 m0, s58, 0x12400
    s_nop 0
    buffer_load_dwordx4 v0, s[40:43], s61 offen lds
    s_add_u32 s61, s67, 4
    s_sub_u32 s59, s61, 20
    s_cmp_ge_u32 s61, 20
    s_cselect_b32 s61, s59, s61
    s_mul_i32 s59, s57, 20
    s_add_u32 s61, s61, s59
    s_mul_i32 s61, s61, 0x3800
    s_add_u32 m0, s58, 0x14000
    s_nop 0
    buffer_load_dwordx4 v0, s[40:43], s61 offen lds
    s_add_u32 s61, s61, 0x1c00
    s_add_u32 m0, s58, 0x14400
    s_nop 0
    buffer_load_dwordx4 v0, s[40:43], s61 offen lds
    s_add_u32 s61, s67, 5
    s_sub_u32 s59, s61, 20
    s_cmp_ge_u32 s61, 20
    s_cselect_b32 s61, s59, s61
    s_mul_i32 s59, s57, 20
    s_add_u32 s61, s61, s59
    s_mul_i32 s61, s61, 0x3800
    s_add_u32 m0, s58, 0x16000
    s_nop 0
    buffer_load_dwordx4 v0, s[40:43], s61 offen lds
    s_add_u32 s61, s61, 0x1c00
    s_add_u32 m0, s58, 0x16400
    s_nop 0
    buffer_load_dwordx4 v0, s[40:43], s61 offen lds
    s_lshl_b32 s59, s56, 3
    s_add_u32 s59, s59, s55
    s_lshl_b32 s59, s59, 2
    s_add_u32 s59, s59, s57
    s_lshl_b32 s59, s59, 7
    s_add_u32 s59, s59, 0xe9c000
    v_mov_b32 v12, 0
    v_mov_b32 v13, 1
    s_waitcnt vmcnt(16)
    s_mov_b64 exec, 1
    buffer_store_dword v13, v12, s[44:47], s59 offen sc1
    s_mov_b64 exec, -1
    v_xor_b32 v224, 0x80008000, v228
    v_xor_b32 v225, 0x80008000, v229
    v_xor_b32 v230, 0x80008000, v234
    v_xor_b32 v231, 0x80008000, v235
    v_xor_b32 v236, 0x80008000, v240
    v_xor_b32 v237, 0x80008000, v241
    v_xor_b32 v242, 0x80008000, v246
    v_xor_b32 v243, 0x80008000, v247
    v_xor_b32 v192, 0x80008000, v196
    v_xor_b32 v193, 0x80008000, v197
    v_xor_b32 v198, 0x80008000, v202
    v_xor_b32 v199, 0x80008000, v203
    v_xor_b32 v204, 0x80008000, v208
    v_xor_b32 v205, 0x80008000, v209
    v_xor_b32 v210, 0x80008000, v214
    v_xor_b32 v211, 0x80008000, v215
    s_waitcnt vmcnt(13)
    s_setprio 3
    s_mov_b32 s28, s18
    s_mov_b32 s29, s19
    s_mov_b32 s30, 0x1c0000
    s_mov_b32 s31, 0x20000
    s_mov_b32 s64, 1
K_FFT:
    s_lshr_b32 s59, s65, 3
    s_cmp_eq_u32 s59, 28
    s_cselect_b32 s59, 0, s59
    s_lshl_b32 s59, s59, 12
    s_lshl_b32 s60, s57, 10
    s_add_u32 s59, s59, s60
    s_add_u32 s59, s59, 0xe9c000
    s_and_b32 s60, s2, 63
    s_lshl_b32 s60, s60, 7
    s_add_u32 s60, s60, 0xed8000
    v_and_b32 v248, 7, v1
    v_lshlrev_b32 v248, 7, v248
    v_add_u32 v248, s59, v248
    v_mov_b32 v249, s60
    s_mov_b32 vcc_lo, 0xff00ff00
    s_mov_b32 vcc_hi, 0xff00ff00
    v_cndmask_b32 v248, v248, v249, vcc
    s_cmp_eq_u32 s64, 0
    s_cbranch_scc1 FO_20
    ds_write_b128 v7, v[64:67]
    ds_write_b128 v7, v[68:71] offset:1024
    ds_read_b64_tr_b16 v[64:65], v4
    ds_read_b64_tr_b16 v[66:67], v4 offset:512
    ds_read_b64_tr_b16 v[68:69], v5
    ds_read_b64_tr_b16 v[70:71], v5 offset:512
    ds_write_b128 v7, v[72:75]
    ds_write_b128 v7, v[76:79] offset:1024
    ds_read_b64_tr_b16 v[72:73], v4
    ds_read_b64_tr_b16 v[74:75], v4 offset:512
    ds_read_b64_tr_b16 v[76:77], v5
    ds_read_b64_tr_b16 v[78:79], v5 offset:512
    ds_write_b128 v7, v[80:83]
    ds_write_b128 v7, v[84:87] offset:1024
    ds_read_b64_tr_b16 v[80:81], v4
    ds_read_b64_tr_b16 v[82:83], v4 offset:512
    ds_read_b64_tr_b16 v[84:85], v5
    ds_read_b64_tr_b16 v[86:87], v5 offset:512
    ds_write_b128 v7, v[88:91]
    ds_write_b128 v7, v[92:95] offset:1024
    ds_read_b64_tr_b16 v[88:89], v4
    ds_read_b64_tr_b16 v[90:91], v4 offset:512
    ds_read_b64_tr_b16 v[92:93], v5
    ds_read_b64_tr_b16 v[94:95], v5 offset:512
    ds_write_b128 v7, v[96:99]
    ds_write_b128 v7, v[100:103] offset:1024
    ds_read_b64_tr_b16 v[96:97], v4
    ds_read_b64_tr_b16 v[98:99], v4 offset:512
    ds_read_b64_tr_b16 v[100:101], v5
    ds_read_b64_tr_b16 v[102:103], v5 offset:512
    ds_write_b128 v7, v[104:107]
    ds_write_b128 v7, v[108:111] offset:1024
    ds_read_b64_tr_b16 v[104:105], v4
    ds_read_b64_tr_b16 v[106:107], v4 offset:512
    ds_read_b64_tr_b16 v[108:109], v5
    ds_read_b64_tr_b16 v[110:111], v5 offset:512
    ds_write_b128 v7, v[112:115]
    ds_write_b128 v7, v[116:119] offset:1024
    ds_read_b64_tr_b16 v[112:113], v4
    ds_read_b64_tr_b16 v[114:115], v4 offset:512
    ds_read_b64_tr_b16 v[116:117], v5
    ds_read_b64_tr_b16 v[118:119], v5 offset:512
    ds_write_b128 v7, v[120:123]
    ds_write_b128 v7, v[124:127] offset:1024
    ds_read_b64_tr_b16 v[120:121], v4
    ds_read_b64_tr_b16 v[122:123], v4 offset:512
    ds_read_b64_tr_b16 v[124:125], v5
    ds_read_b64_tr_b16 v[126:127], v5 offset:512
FO_20:
    buffer_load_dword v249, v248, s[44:47], 0 offen sc1
    s_waitcnt vmcnt(0)
    v_cmp_ne_u32 vcc, 1, v249
    s_nop 4
    s_cbranch_vccz FX_G
FX_P:
    s_add_u32 s66, s66, 1
    buffer_load_dword v249, v248, s[44:47], 0 offen sc1
    s_waitcnt vmcnt(0)
    v_cmp_ne_u32 vcc, 1, v249
    s_nop 4
    s_nop 4
    s_cbranch_vccz FX_G
    s_cmp_ge_u32 s66, 0xfa0
    s_cbranch_scc1 FX_G
    s_sleep 6
    s_branch FX_P
FX_G:
    s_lshl_b32 s59, s65, 13
    s_add_u32 s59, s59, s58
    s_add_u32 s60, s59, 0x800000
    s_add_u32 s59, s59, 0xa00000
    buffer_load_dwordx4 v[128:131], v3, s[44:47], s60 offen sc1
    buffer_load_dwordx4 v[132:135], v3, s[44:47], s60 offen offset:1024 sc1
    buffer_load_dwordx4 v[136:139], v3, s[44:47], s59 offen sc1
    buffer_load_dwordx4 v[140:143], v3, s[44:47], s59 offen offset:1024 sc1
    s_lshl_b32 s59, s57, 2
    s_add_u32 s59, s59, 0x27c00
    v_mov_b32 v248, s59
    v_mov_b32 v249, 1
    s_mov_b64 exec, 1
    ds_write_b32 v248, v249 offset:160
    s_mov_b64 exec, -1
    s_cmp_eq_u32 s64, 0
    s_cbranch_scc1 FO_21
    s_lshl_b32 s59, s57, 2
    s_add_u32 s59, s59, 0x27c00
    v_mov_b32 v248, s59
    v_mov_b32 v249, 1
    s_mov_b64 exec, 1
    ds_write_b32 v248, v249 offset:32
    s_mov_b64 exec, -1
FO_21:
    s_waitcnt vmcnt(0)
    s_waitcnt lgkmcnt(0)
    v_mfma_f32_16x16x32_bf16 v[144:147], v[128:131], v[226:229], 0
    v_mfma_f32_16x16x32_bf16 v[152:155], v[128:131], v[224:227], 0
    v_mfma_f32_16x16x32_bf16 v[144:147], v[132:135], v[232:235], v[144:147]
    v_mfma_f32_16x16x32_bf16 v[152:155], v[132:135], v[230:233], v[152:155]
    v_mfma_f32_16x16x32_bf16 v[148:151], v[128:131], v[238:241], 0
    v_mfma_f32_16x16x32_bf16 v[156:159], v[128:131], v[236:239], 0
    v_mfma_f32_16x16x32_bf16 v[148:151], v[132:135], v[244:247], v[148:151]
    v_mfma_f32_16x16x32_bf16 v[156:159], v[132:135], v[242:245], v[156:159]
    s_nop 2
    v_fma_mix_f32 v248, v144, v48, 0 op_sel:[0,1,0] op_sel_hi:[0,1,0]
    v_fma_mix_f32 v144, v144, v48, 0 op_sel:[0,0,0] op_sel_hi:[0,1,0]
    v_fma_mix_f32 v144, -v152, v48, v144 op_sel:[0,1,0] op_sel_hi:[0,1,0]
    v_fma_mix_f32 v152, v152, v48, v248 op_sel:[0,0,0] op_sel_hi:[0,1,0]
    v_fma_mix_f32 v249, v145, v49, 0 op_sel:[0,1,0] op_sel_hi:[0,1,0]
    v_fma_mix_f32 v145, v145, v49, 0 op_sel:[0,0,0] op_sel_hi:[0,1,0]
    v_fma_mix_f32 v145, -v153, v49, v145 op_sel:[0,1,0] op_sel_hi:[0,1,0]
    v_fma_mix_f32 v153, v153, v49, v249 op_sel:[0,0,0] op_sel_hi:[0,1,0]
    v_fma_mix_f32 v248, v146, v50, 0 op_sel:[0,1,0] op_sel_hi:[0,1,0]
    v_fma_mix_f32 v146, v146, v50, 0 op_sel:[0,0,0] op_sel_hi:[0,1,0]
    v_fma_mix_f32 v146, -v154, v50, v146 op_sel:[0,1,0] op_sel_hi:[0,1,0]
    v_fma_mix_f32 v154, v154, v50, v248 op_sel:[0,0,0] op_sel_hi:[0,1,0]
    v_fma_mix_f32 v249, v147, v51, 0 op_sel:[0,1,0] op_sel_hi:[0,1,0]
    v_fma_mix_f32 v147, v147, v51, 0 op_sel:[0,0,0] op_sel_hi:[0,1,0]
    v_fma_mix_f32 v147, -v155, v51, v147 op_sel:[0,1,0] op_sel_hi:[0,1,0]
    v_fma_mix_f32 v155, v155, v51, v249 op_sel:[0,0,0] op_sel_hi:[0,1,0]
    v_cvt_pk_bf16_f32 v216, v144, v145
    v_cvt_pk_bf16_f32 v217, v146, v147
    v_cvt_pk_bf16_f32 v218, v152, v153
    v_cvt_pk_bf16_f32 v219, v154, v155
    ds_write_b128 v7, v[216:219]
    v_fma_mix_f32 v248, v148, v52, 0 op_sel:[0,1,0] op_sel_hi:[0,1,0]
    v_fma_mix_f32 v148, v148, v52, 0 op_sel:[0,0,0] op_sel_hi:[0,1,0]
    v_fma_mix_f32 v148, -v156, v52, v148 op_sel:[0,1,0] op_sel_hi:[0,1,0]
    v_fma_mix_f32 v156, v156, v52, v248 op_sel:[0,0,0] op_sel_hi:[0,1,0]
    v_fma_mix_f32 v249, v149, v53, 0 op_sel:[0,1,0] op_sel_hi:[0,1,0]
    v_fma_mix_f32 v149, v149, v53, 0 op_sel:[0,0,0] op_sel_hi:[0,1,0]
    v_fma_mix_f32 v149, -v157, v53, v149 op_sel:[0,1,0] op_sel_hi:[0,1,0]
    v_fma_mix_f32 v157, v157, v53, v249 op_sel:[0,0,0] op_sel_hi:[0,1,0]
    v_fma_mix_f32 v248, v150, v54, 0 op_sel:[0,1,0] op_sel_hi:[0,1,0]
    v_fma_mix_f32 v150, v150, v54, 0 op_sel:[0,0,0] op_sel_hi:[0,1,0]
    v_fma_mix_f32 v150, -v158, v54, v150 op_sel:[0,1,0] op_sel_hi:[0,1,0]
    v_fma_mix_f32 v158, v158, v54, v248 op_sel:[0,0,0] op_sel_hi:[0,1,0]
    v_fma_mix_f32 v249, v151, v55, 0 op_sel:[0,1,0] op_sel_hi:[0,1,0]
    v_fma_mix_f32 v151, v151, v55, 0 op_sel:[0,0,0] op_sel_hi:[0,1,0]
    v_fma_mix_f32 v151, -v159, v55, v151 op_sel:[0,1,0] op_sel_hi:[0,1,0]
    v_fma_mix_f32 v159, v159, v55, v249 op_sel:[0,0,0] op_sel_hi:[0,1,0]
    v_cvt_pk_bf16_f32 v220, v148, v149
    v_cvt_pk_bf16_f32 v221, v150, v151
    v_cvt_pk_bf16_f32 v222, v156, v157
    v_cvt_pk_bf16_f32 v223, v158, v159
    ds_write_b128 v7, v[220:223] offset:1024
    s_lshl_b32 s59, s57, 2
    s_add_u32 s59, s59, 0x27c00
    v_mov_b32 v248, s59
    v_mov_b32 v249, 1
    s_mov_b64 exec, 1
    ds_write_b32 v248, v249
    s_mov_b64 exec, -1
    v_add_u32 v250, 0x24000, v3
    v_and_b32 v248, 3, v1
    v_lshlrev_b32 v248, 2, v248
    v_add_u32 v248, 0x27c00, v248
    s_mov_b32 s59, 0
LW_22_P:
    ds_read_b32 v249, v248
    s_add_u32 s59, s59, 1
    s_waitcnt lgkmcnt(0)
    v_cmp_gt_u32 vcc, 1, v249
    s_cmp_ge_u32 s59, 0x8000
    s_cbranch_scc1 LW_22_G
    s_nop 2
    s_cbranch_vccnz LW_22_P
LW_22_G:
    ds_read_b128 v[160:163], v250
    ds_read_b128 v[164:167], v250 offset:1024
    ds_read_b128 v[168:171], v250 offset:2048
    ds_read_b128 v[172:175], v250 offset:3072
    ds_read_b128 v[176:179], v250 offset:4096
    ds_read_b128 v[180:183], v250 offset:5120
    ds_read_b128 v[184:187], v250 offset:6144
    ds_read_b128 v[188:191], v250 offset:7168
    s_lshl_b32 s59, s57, 2
    s_add_u32 s59, s59, 0x27c00
    v_mov_b32 v248, s59
    v_mov_b32 v249, 1
    s_mov_b64 exec, 1
    ds_write_b32 v248, v249 offset:128
    s_mov_b64 exec, -1
    s_waitcnt lgkmcnt(7)
    v_mfma_f32_16x16x32_bf16 v[144:147], v[194:197], v[160:163], 0
    v_mfma_f32_16x16x32_bf16 v[152:155], v[192:195], v[160:163], 0
    v_mfma_f32_16x16x32_bf16 v[148:151], v[194:197], v[164:167], 0
    v_mfma_f32_16x16x32_bf16 v[156:159], v[192:195], v[164:167], 0
    s_waitcnt lgkmcnt(5)
    v_mfma_f32_16x16x32_bf16 v[144:147], v[200:203], v[168:171], v[144:147]
    v_mfma_f32_16x16x32_bf16 v[152:155], v[198:201], v[168:171], v[152:155]
    v_mfma_f32_16x16x32_bf16 v[148:151], v[200:203], v[172:175], v[148:151]
    v_mfma_f32_16x16x32_bf16 v[156:159], v[198:201], v[172:175], v[156:159]
    s_waitcnt lgkmcnt(3)
    v_mfma_f32_16x16x32_bf16 v[144:147], v[206:209], v[176:179], v[144:147]
    v_mfma_f32_16x16x32_bf16 v[152:155], v[204:207], v[176:179], v[152:155]
    v_mfma_f32_16x16x32_bf16 v[148:151], v[206:209], v[180:183], v[148:151]
    v_mfma_f32_16x16x32_bf16 v[156:159], v[204:207], v[180:183], v[156:159]
    s_waitcnt lgkmcnt(1)
    v_mfma_f32_16x16x32_bf16 v[144:147], v[212:215], v[184:187], v[144:147]
    v_mfma_f32_16x16x32_bf16 v[152:155], v[210:213], v[184:187], v[152:155]
    v_mfma_f32_16x16x32_bf16 v[148:151], v[212:215], v[188:191], v[148:151]
    v_mfma_f32_16x16x32_bf16 v[156:159], v[210:213], v[188:191], v[156:159]
    v_lshlrev_b32 v249, 16, v136
    v_lshlrev_b32 v250, 16, v138
    s_nop 2
    v_mul_f32 v248, v144, v250
    v_mul_f32 v144, v144, v249
    v_fma_f32 v144, -v152, v250, v144
    v_fma_f32 v152, v152, v249, v248
    v_and_b32 v249, 0xffff0000, v136
    v_and_b32 v250, 0xffff0000, v138
    v_mul_f32 v248, v145, v250
    v_mul_f32 v145, v145, v249
    v_fma_f32 v145, -v153, v250, v145
    v_fma_f32 v153, v153, v249, v248
    v_lshlrev_b32 v249, 16, v137
    v_lshlrev_b32 v250, 16, v139
    v_mul_f32 v248, v146, v250
    v_mul_f32 v146, v146, v249
    v_fma_f32 v146, -v154, v250, v146
    v_fma_f32 v154, v154, v249, v248
    v_and_b32 v249, 0xffff0000, v137
    v_and_b32 v250, 0xffff0000, v139
    v_mul_f32 v248, v147, v250
    v_mul_f32 v147, v147, v249
    v_fma_f32 v147, -v155, v250, v147
    v_fma_f32 v155, v155, v249, v248
    v_cvt_pk_bf16_f32 v216, v144, v145
    v_cvt_pk_bf16_f32 v217, v146, v147
    v_cvt_pk_bf16_f32 v218, -v152, -v153
    v_cvt_pk_bf16_f32 v219, -v154, -v155
    v_and_b32 v248, 3, v1
    v_lshlrev_b32 v248, 2, v248
    v_add_u32 v248, 0x27c00, v248
    s_mov_b32 s59, 0
LW_23_P:
    ds_read_b32 v249, v248 offset:128
    s_add_u32 s59, s59, 1
    s_waitcnt lgkmcnt(0)
    v_cmp_gt_u32 vcc, 1, v249
    s_cmp_ge_u32 s59, 0x8000
    s_cbranch_scc1 LW_23_G
    s_nop 2
    s_cbranch_vccnz LW_23_P
LW_23_G:
    ds_write_b128 v7, v[216:219]
    v_lshlrev_b32 v249, 16, v140
    v_lshlrev_b32 v250, 16, v142
    v_mul_f32 v248, v148, v250
    v_mul_f32 v148, v148, v249
    v_fma_f32 v148, -v156, v250, v148
    v_fma_f32 v156, v156, v249, v248
    v_and_b32 v249, 0xffff0000, v140
    v_and_b32 v250, 0xffff0000, v142
    v_mul_f32 v248, v149, v250
    v_mul_f32 v149, v149, v249
    v_fma_f32 v149, -v157, v250, v149
    v_fma_f32 v157, v157, v249, v248
    v_lshlrev_b32 v249, 16, v141
    v_lshlrev_b32 v250, 16, v143
    v_mul_f32 v248, v150, v250
    v_mul_f32 v150, v150, v249
    v_fma_f32 v150, -v158, v250, v150
    v_fma_f32 v158, v158, v249, v248
    v_and_b32 v249, 0xffff0000, v141
    v_and_b32 v250, 0xffff0000, v143
    v_mul_f32 v248, v151, v250
    v_mul_f32 v151, v151, v249
    v_fma_f32 v151, -v159, v250, v151
    v_fma_f32 v159, v159, v249, v248
    v_cvt_pk_bf16_f32 v220, v148, v149
    v_cvt_pk_bf16_f32 v221, v150, v151
    v_cvt_pk_bf16_f32 v222, -v156, -v157
    v_cvt_pk_bf16_f32 v223, -v158, -v159
    ds_write_b128 v7, v[220:223] offset:1024
    s_lshl_b32 s59, s57, 2
    s_add_u32 s59, s59, 0x27c00
    v_mov_b32 v248, s59
    v_mov_b32 v249, 1
    s_mov_b64 exec, 1
    ds_write_b32 v248, v249 offset:16
    s_mov_b64 exec, -1
    v_add_u32 v250, 0x24000, v3
    v_and_b32 v248, 3, v1
    v_lshlrev_b32 v248, 2, v248
    v_add_u32 v248, 0x27c00, v248
    s_mov_b32 s59, 0
LW_24_P:
    ds_read_b32 v249, v248 offset:16
    s_add_u32 s59, s59, 1
    s_waitcnt lgkmcnt(0)
    v_cmp_gt_u32 vcc, 1, v249
    s_cmp_ge_u32 s59, 0x8000
    s_cbranch_scc1 LW_24_G
    s_nop 2
    s_cbranch_vccnz LW_24_P
LW_24_G:
    ds_read_b128 v[160:163], v250
    ds_read_b128 v[164:167], v250 offset:1024
    ds_read_b128 v[168:171], v250 offset:2048
    ds_read_b128 v[172:175], v250 offset:3072
    ds_read_b128 v[176:179], v250 offset:4096
    ds_read_b128 v[180:183], v250 offset:5120
    ds_read_b128 v[184:187], v250 offset:6144
    ds_read_b128 v[188:191], v250 offset:7168
    s_lshl_b32 s59, s57, 2
    s_add_u32 s59, s59, 0x27c00
    v_mov_b32 v248, s59
    v_mov_b32 v249, 1
    s_mov_b64 exec, 1
    ds_write_b32 v248, v249 offset:144
    s_mov_b64 exec, -1
    s_waitcnt lgkmcnt(7)
    v_mfma_f32_16x16x32_bf16 v[144:147], v[160:163], v[194:197], 0
    v_mfma_f32_16x16x32_bf16 v[152:155], v[160:163], v[192:195], 0
    v_mfma_f32_16x16x32_bf16 v[148:151], v[164:167], v[194:197], 0
    v_mfma_f32_16x16x32_bf16 v[156:159], v[164:167], v[192:195], 0
    s_waitcnt lgkmcnt(5)
    v_mfma_f32_16x16x32_bf16 v[144:147], v[168:171], v[200:203], v[144:147]
    v_mfma_f32_16x16x32_bf16 v[152:155], v[168:171], v[198:201], v[152:155]
    v_mfma_f32_16x16x32_bf16 v[148:151], v[172:175], v[200:203], v[148:151]
    v_mfma_f32_16x16x32_bf16 v[156:159], v[172:175], v[198:201], v[156:159]
    s_waitcnt lgkmcnt(3)
    v_mfma_f32_16x16x32_bf16 v[144:147], v[176:179], v[206:209], v[144:147]
    v_mfma_f32_16x16x32_bf16 v[152:155], v[176:179], v[204:207], v[152:155]
    v_mfma_f32_16x16x32_bf16 v[148:151], v[180:183], v[206:209], v[148:151]
    v_mfma_f32_16x16x32_bf16 v[156:159], v[180:183], v[204:207], v[156:159]
    s_waitcnt lgkmcnt(1)
    v_mfma_f32_16x16x32_bf16 v[144:147], v[184:187], v[212:215], v[144:147]
    v_mfma_f32_16x16x32_bf16 v[152:155], v[184:187], v[210:213], v[152:155]
    v_mfma_f32_16x16x32_bf16 v[148:151], v[188:191], v[212:215], v[148:151]
    v_mfma_f32_16x16x32_bf16 v[156:159], v[188:191], v[210:213], v[156:159]
    s_nop 4
    v_fma_mix_f32 v248, v144, v56, 0 op_sel:[0,1,0] op_sel_hi:[0,1,0]
    v_fma_mix_f32 v144, v144, v56, 0 op_sel:[0,0,0] op_sel_hi:[0,1,0]
    v_fma_mix_f32 v144, -v152, v56, v144 op_sel:[0,1,0] op_sel_hi:[0,1,0]
    v_fma_mix_f32 v152, v152, v56, v248 op_sel:[0,0,0] op_sel_hi:[0,1,0]
    v_fma_mix_f32 v249, v145, v57, 0 op_sel:[0,1,0] op_sel_hi:[0,1,0]
    v_fma_mix_f32 v145, v145, v57, 0 op_sel:[0,0,0] op_sel_hi:[0,1,0]
    v_fma_mix_f32 v145, -v153, v57, v145 op_sel:[0,1,0] op_sel_hi:[0,1,0]
    v_fma_mix_f32 v153, v153, v57, v249 op_sel:[0,0,0] op_sel_hi:[0,1,0]
    v_fma_mix_f32 v248, v146, v58, 0 op_sel:[0,1,0] op_sel_hi:[0,1,0]
    v_fma_mix_f32 v146, v146, v58, 0 op_sel:[0,0,0] op_sel_hi:[0,1,0]
    v_fma_mix_f32 v146, -v154, v58, v146 op_sel:[0,1,0] op_sel_hi:[0,1,0]
    v_fma_mix_f32 v154, v154, v58, v248 op_sel:[0,0,0] op_sel_hi:[0,1,0]
    v_fma_mix_f32 v249, v147, v59, 0 op_sel:[0,1,0] op_sel_hi:[0,1,0]
    v_fma_mix_f32 v147, v147, v59, 0 op_sel:[0,0,0] op_sel_hi:[0,1,0]
    v_fma_mix_f32 v147, -v155, v59, v147 op_sel:[0,1,0] op_sel_hi:[0,1,0]
    v_fma_mix_f32 v155, v155, v59, v249 op_sel:[0,0,0] op_sel_hi:[0,1,0]
    v_cvt_pk_bf16_f32 v216, v144, v145
    v_cvt_pk_bf16_f32 v217, v146, v147
    v_cvt_pk_bf16_f32 v218, v152, v153
    v_cvt_pk_bf16_f32 v219, v154, v155
    v_fma_mix_f32 v248, v148, v60, 0 op_sel:[0,1,0] op_sel_hi:[0,1,0]
    v_fma_mix_f32 v148, v148, v60, 0 op_sel:[0,0,0] op_sel_hi:[0,1,0]
    v_fma_mix_f32 v148, -v156, v60, v148 op_sel:[0,1,0] op_sel_hi:[0,1,0]
    v_fma_mix_f32 v156, v156, v60, v248 op_sel:[0,0,0] op_sel_hi:[0,1,0]
    v_fma_mix_f32 v249, v149, v61, 0 op_sel:[0,1,0] op_sel_hi:[0,1,0]
    v_fma_mix_f32 v149, v149, v61, 0 op_sel:[0,0,0] op_sel_hi:[0,1,0]
    v_fma_mix_f32 v149, -v157, v61, v149 op_sel:[0,1,0] op_sel_hi:[0,1,0]
    v_fma_mix_f32 v157, v157, v61, v249 op_sel:[0,0,0] op_sel_hi:[0,1,0]
    v_fma_mix_f32 v248, v150, v62, 0 op_sel:[0,1,0] op_sel_hi:[0,1,0]
    v_fma_mix_f32 v150, v150, v62, 0 op_sel:[0,0,0] op_sel_hi:[0,1,0]
    v_fma_mix_f32 v150, -v158, v62, v150 op_sel:[0,1,0] op_sel_hi:[0,1,0]
    v_fma_mix_f32 v158, v158, v62, v248 op_sel:[0,0,0] op_sel_hi:[0,1,0]
    v_fma_mix_f32 v249, v151, v63, 0 op_sel:[0,1,0] op_sel_hi:[0,1,0]
    v_fma_mix_f32 v151, v151, v63, 0 op_sel:[0,0,0] op_sel_hi:[0,1,0]
    v_fma_mix_f32 v151, -v159, v63, v151 op_sel:[0,1,0] op_sel_hi:[0,1,0]
    v_fma_mix_f32 v159, v159, v63, v249 op_sel:[0,0,0] op_sel_hi:[0,1,0]
    v_cvt_pk_bf16_f32 v220, v148, v149
    v_cvt_pk_bf16_f32 v221, v150, v151
    v_cvt_pk_bf16_f32 v222, v156, v157
    v_cvt_pk_bf16_f32 v223, v158, v159
    v_mfma_f32_16x16x32_bf16 v[160:163], v[226:229], v[216:219], 0
    v_mfma_f32_16x16x32_bf16 v[168:171], v[224:227], v[216:219], 0
    v_mfma_f32_16x16x32_bf16 v[160:163], v[232:235], v[220:223], v[160:163]
    v_mfma_f32_16x16x32_bf16 v[168:171], v[230:233], v[220:223], v[168:171]
    v_mfma_f32_16x16x32_bf16 v[164:167], v[238:241], v[216:219], 0
    v_mfma_f32_16x16x32_bf16 v[172:175], v[236:239], v[216:219], 0
    v_mfma_f32_16x16x32_bf16 v[164:167], v[244:247], v[220:223], v[164:167]
    v_mfma_f32_16x16x32_bf16 v[172:175], v[242:245], v[220:223], v[172:175]
    s_lshl_b32 s59, s65, 13
    s_add_u32 s59, s59, s58
    s_add_u32 s59, s59, 0xc00000
    v_cvt_pk_bf16_f32 v176, v160, v161
    v_cvt_pk_bf16_f32 v178, -v168, -v169
    v_cvt_pk_bf16_f32 v177, v162, v163
    v_cvt_pk_bf16_f32 v179, -v170, -v171
    s_mov_b32 vcc_lo, 0xff00ff
    s_mov_b32 vcc_hi, 0xff00ff
    v_cndmask_b32_dpp v180, v178, v176, vcc row_ror:8 row_mask:0xf bank_mask:0xf
    v_cndmask_b32_dpp v181, v179, v177, vcc row_ror:8 row_mask:0xf bank_mask:0xf
    s_mov_b32 vcc_lo, 0xff00ff00
    s_mov_b32 vcc_hi, 0xff00ff00
    v_cndmask_b32_dpp v182, v176, v178, vcc row_ror:8 row_mask:0xf bank_mask:0xf
    v_cndmask_b32_dpp v183, v177, v179, vcc row_ror:8 row_mask:0xf bank_mask:0xf
    buffer_store_dwordx4 v[180:183], v3, s[44:47], s59 offen sc1
    v_cvt_pk_bf16_f32 v184, v164, v165
    v_cvt_pk_bf16_f32 v186, -v172, -v173
    v_cvt_pk_bf16_f32 v185, v166, v167
    v_cvt_pk_bf16_f32 v187, -v174, -v175
    s_mov_b32 vcc_lo, 0xff00ff
    s_mov_b32 vcc_hi, 0xff00ff
    v_cndmask_b32_dpp v188, v186, v184, vcc row_ror:8 row_mask:0xf bank_mask:0xf
    v_cndmask_b32_dpp v189, v187, v185, vcc row_ror:8 row_mask:0xf bank_mask:0xf
    s_mov_b32 vcc_lo, 0xff00ff00
    s_mov_b32 vcc_hi, 0xff00ff00
    v_cndmask_b32_dpp v190, v184, v186, vcc row_ror:8 row_mask:0xf bank_mask:0xf
    v_cndmask_b32_dpp v191, v185, v187, vcc row_ror:8 row_mask:0xf bank_mask:0xf
    buffer_store_dwordx4 v[188:191], v3, s[44:47], s59 offen offset:1024 sc1
    s_cmp_lg_u32 s64, 0
    s_cbranch_scc1 K_G2H
    s_waitcnt vmcnt(0)
    s_endpgm
K_G2H:
    s_nop 1
    v_lshrrev_b32 v13, 1, v1
    v_min_u32 v13, 1, v13
    v_and_b32 v12, 1, v1
    v_mul_u32_u24 v12, 0x70, v12
    v_add_u32 v12, v12, v13
    v_lshlrev_b32 v11, 7, v12
    s_and_b32 s59, s52, 6
    s_lshl_b32 s59, s59, 2
    s_lshr_b32 s60, s55, 1
    s_add_u32 s59, s59, s60
    s_mul_i32 s59, s59, 28
    s_mul_i32 s60, s57, 2
    s_add_u32 s59, s59, s60
    s_lshl_b32 s59, s59, 7
    s_add_u32 s63, s59, 0xe80a00
    buffer_load_dword v10, v11, s[44:47], s63 offen sc1
    v_and_b32 v12, 3, v1
    v_lshlrev_b32 v12, 2, v12
    v_add_u32 v12, 0x27c00, v12
    s_mov_b32 s59, 0
LW_25_P:
    ds_read_b32 v13, v12 offset:144
    s_add_u32 s59, s59, 1
    s_waitcnt lgkmcnt(0)
    v_cmp_gt_u32 vcc, 1, v13
    s_cmp_ge_u32 s59, 0x8000
    s_cbranch_scc1 LW_25_G
    s_nop 2
    s_cbranch_vccnz LW_25_P
LW_25_G:
    s_mov_b32 s12, 0x36124925
    s_mov_b32 s13, 0xb6124925
    s_mul_i32 s59, s57, 32
    s_add_u32 s59, s59, 0x60
    v_lshrrev_b32 v146, 5, v1
    v_lshl_add_u32 v146, v146, 2, s59
    v_cvt_f32_u32 v146, v146
    s_lshl_b32 s59, s54, 6
    v_and_b32 v144, 31, v1
    v_add_u32 v144, s59, v144
    v_cvt_f32_u32 v144, v144
    v_add_f32 v145, 0x42000000, v144
    v_mul_f32 v130, v144, v146
    v_mul_f32 v147, 0x3b124925, v130
    v_floor_f32 v147, v147
    v_fmamk_f32 v130, v147, 0xc3e00000, v130
    v_mul_f32 v130, 0x3b124925, v130
    v_cos_f32 v128, v130
    v_sin_f32 v129, v130
    v_mul_f32 v130, 0x3b124925, v144
    v_cos_f32 v132, v130
    v_sin_f32 v133, v130
    v_mul_f32 v130, 0x3c924925, v144
    v_cos_f32 v134, v130
    v_sin_f32 v135, v130
    v_pk_mul_f32 v[128:129], v[128:129], s[12:13]
    v_mul_f32 v138, v145, v146
    v_mul_f32 v147, 0x3b124925, v138
    v_floor_f32 v147, v147
    v_fmamk_f32 v138, v147, 0xc3e00000, v138
    v_mul_f32 v138, 0x3b124925, v138
    v_cos_f32 v136, v138
    v_sin_f32 v137, v138
    v_mul_f32 v138, 0x3b124925, v145
    v_cos_f32 v140, v138
    v_sin_f32 v141, v138
    v_mul_f32 v138, 0x3c924925, v145
    v_cos_f32 v142, v138
    v_sin_f32 v143, v138
    v_pk_mul_f32 v[136:137], v[136:137], s[12:13]
    v_cvt_pk_bf16_f32 v16, v128, v129
    v_cvt_pk_bf16_f32 v20, v136, v137
    v_pk_mul_f32 v[144:145], v[128:129], v[132:133] op_sel_hi:[1,0]
    v_pk_mul_f32 v[146:147], v[136:137], v[140:141] op_sel_hi:[1,0]
    v_pk_fma_f32 v[130:131], v[128:129], v[132:133], v[144:145] op_sel:[1,1,0] op_sel_hi:[0,1,1] neg_hi:[0,1,0]
    v_pk_fma_f32 v[138:139], v[136:137], v[140:141], v[146:147] op_sel:[1,1,0] op_sel_hi:[0,1,1] neg_hi:[0,1,0]
    v_cvt_pk_bf16_f32 v17, v130, v131
    v_cvt_pk_bf16_f32 v21, v138, v139
    v_pk_mul_f32 v[144:145], v[130:131], v[132:133] op_sel_hi:[1,0]
    v_pk_mul_f32 v[146:147], v[138:139], v[140:141] op_sel_hi:[1,0]
    v_pk_fma_f32 v[130:131], v[130:131], v[132:133], v[144:145] op_sel:[1,1,0] op_sel_hi:[0,1,1] neg_hi:[0,1,0]
    v_pk_fma_f32 v[138:139], v[138:139], v[140:141], v[146:147] op_sel:[1,1,0] op_sel_hi:[0,1,1] neg_hi:[0,1,0]
    v_cvt_pk_bf16_f32 v18, v130, v131
    v_cvt_pk_bf16_f32 v22, v138, v139
    v_pk_mul_f32 v[144:145], v[130:131], v[132:133] op_sel_hi:[1,0]
    v_pk_mul_f32 v[146:147], v[138:139], v[140:141] op_sel_hi:[1,0]
    v_pk_fma_f32 v[130:131], v[130:131], v[132:133], v[144:145] op_sel:[1,1,0] op_sel_hi:[0,1,1] neg_hi:[0,1,0]
    v_pk_fma_f32 v[138:139], v[138:139], v[140:141], v[146:147] op_sel:[1,1,0] op_sel_hi:[0,1,1] neg_hi:[0,1,0]
    v_cvt_pk_bf16_f32 v19, v130, v131
    v_cvt_pk_bf16_f32 v23, v138, v139
    v_pk_mul_f32 v[144:145], v[128:129], v[134:135] op_sel_hi:[1,0]
    v_pk_mul_f32 v[146:147], v[136:137], v[142:143] op_sel_hi:[1,0]
    v_pk_fma_f32 v[128:129], v[128:129], v[134:135], v[144:145] op_sel:[1,1,0] op_sel_hi:[0,1,1] neg_hi:[0,1,0]
    v_pk_fma_f32 v[136:137], v[136:137], v[142:143], v[146:147] op_sel:[1,1,0] op_sel_hi:[0,1,1] neg_hi:[0,1,0]
    v_cvt_pk_bf16_f32 v24, v128, v129
    v_cvt_pk_bf16_f32 v28, v136, v137
    s_waitcnt vmcnt(0)
    v_cmp_ne_u32 vcc, 1, v10
    s_nop 4
    s_cbranch_vccz G2Hh_G
G2Hh_P:
    s_add_u32 s66, s66, 1
    buffer_load_dword v10, v11, s[44:47], s63 offen sc1
    s_waitcnt vmcnt(0)
    v_cmp_ne_u32 vcc, 1, v10
    s_nop 4
    s_nop 4
    s_cbranch_vccz G2Hh_G
    s_cmp_ge_u32 s66, 0xfa0
    s_cbranch_scc1 G2Hh_G
    s_sleep 1
    s_branch G2Hh_P
G2Hh_G:
    s_add_u32 s61, s10, 0
    s_sub_u32 s59, s61, 8
    s_cmp_ge_u32 s61, 8
    s_cselect_b32 s61, s59, s61
    s_mul_i32 s59, s57, 8
    s_add_u32 s61, s61, s59
    s_add_u32 s61, s61, 0x50
    s_lshl_b32 s61, s61, 10
    s_add_u32 s61, s61, s101
    buffer_load_dwordx4 v[192:195], v3, s[44:47], s61 offen
    s_add_u32 s61, s61, 0xe0000
    buffer_load_dwordx4 v[196:199], v3, s[44:47], s61 offen
    s_add_u32 s61, s10, 1
    s_sub_u32 s59, s61, 8
    s_cmp_ge_u32 s61, 8
    s_cselect_b32 s61, s59, s61
    s_mul_i32 s59, s57, 8
    s_add_u32 s61, s61, s59
    s_add_u32 s61, s61, 0x50
    s_lshl_b32 s61, s61, 10
    s_add_u32 s61, s61, s101
    buffer_load_dwordx4 v[200:203], v3, s[44:47], s61 offen
    s_add_u32 s61, s61, 0xe0000
    buffer_load_dwordx4 v[204:207], v3, s[44:47], s61 offen
    s_add_u32 s61, s10, 2
    s_sub_u32 s59, s61, 8
    s_cmp_ge_u32 s61, 8
    s_cselect_b32 s61, s59, s61
    s_mul_i32 s59, s57, 8
    s_add_u32 s61, s61, s59
    s_add_u32 s61, s61, 0x50
    s_lshl_b32 s61, s61, 10
    s_add_u32 s61, s61, s101
    buffer_load_dwordx4 v[208:211], v3, s[44:47], s61 offen
    s_add_u32 s61, s61, 0xe0000
    buffer_load_dwordx4 v[212:215], v3, s[44:47], s61 offen
    s_add_u32 s61, s10, 3
    s_sub_u32 s59, s61, 8
    s_cmp_ge_u32 s61, 8
    s_cselect_b32 s61, s59, s61
    s_mul_i32 s59, s57, 8
    s_add_u32 s61, s61, s59
    s_add_u32 s61, s61, 0x50
    s_lshl_b32 s61, s61, 10
    s_add_u32 s61, s61, s101
    buffer_load_dwordx4 v[48:51], v3, s[44:47], s61 offen
    s_add_u32 s61, s61, 0xe0000
    buffer_load_dwordx4 v[52:55], v3, s[44:47], s61 offen
    s_add_u32 s61, s10, 4
    s_sub_u32 s59, s61, 8
    s_cmp_ge_u32 s61, 8
    s_cselect_b32 s61, s59, s61
    s_mul_i32 s59, s57, 8
    s_add_u32 s61, s61, s59
    s_add_u32 s61, s61, 0x50
    s_lshl_b32 s61, s61, 10
    s_add_u32 s61, s61, s101
    buffer_load_dwordx4 v[216:219], v3, s[44:47], s61 offen
    s_add_u32 s61, s61, 0xe0000
    buffer_load_dwordx4 v[220:223], v3, s[44:47], s61 offen
    s_lshl_b32 s59, s57, 2
    s_add_u32 s59, s59, 0x27c00
    v_mov_b32 v12, s59
    v_mov_b32 v13, 1
    s_mov_b64 exec, 1
    ds_write_b32 v12, v13 offset:192
    s_mov_b64 exec, -1
    s_mul_i32 s62, s57, 4
    s_add_u32 s62, s62, 12
    s_lshl_b32 s62, s62, 16
    s_lshl_b32 s59, s52, 10
    s_add_u32 s62, s62, s59
    s_lshl_b32 s59, s53, 8
    s_add_u32 s62, s62, s59
    s_add_u32 s63, s62, 0xc00000
    v_pk_mul_f32 v[144:145], v[128:129], v[132:133] op_sel_hi:[1,0]
    v_pk_mul_f32 v[146:147], v[136:137], v[140:141] op_sel_hi:[1,0]
    v_pk_fma_f32 v[130:131], v[128:129], v[132:133], v[144:145] op_sel:[1,1,0] op_sel_hi:[0,1,1] neg_hi:[0,1,0]
    v_pk_fma_f32 v[138:139], v[136:137], v[140:141], v[146:147] op_sel:[1,1,0] op_sel_hi:[0,1,1] neg_hi:[0,1,0]
    v_cvt_pk_bf16_f32 v25, v130, v131
    v_cvt_pk_bf16_f32 v29, v138, v139
    v_pk_mul_f32 v[144:145], v[130:131], v[132:133] op_sel_hi:[1,0]
    v_pk_mul_f32 v[146:147], v[138:139], v[140:141] op_sel_hi:[1,0]
    v_pk_fma_f32 v[130:131], v[130:131], v[132:133], v[144:145] op_sel:[1,1,0] op_sel_hi:[0,1,1] neg_hi:[0,1,0]
    v_pk_fma_f32 v[138:139], v[138:139], v[140:141], v[146:147] op_sel:[1,1,0] op_sel_hi:[0,1,1] neg_hi:[0,1,0]
    v_cvt_pk_bf16_f32 v26, v130, v131
    v_cvt_pk_bf16_f32 v30, v138, v139
    v_pk_mul_f32 v[144:145], v[130:131], v[132:133] op_sel_hi:[1,0]
    v_pk_mul_f32 v[146:147], v[138:139], v[140:141] op_sel_hi:[1,0]
    v_pk_fma_f32 v[130:131], v[130:131], v[132:133], v[144:145] op_sel:[1,1,0] op_sel_hi:[0,1,1] neg_hi:[0,1,0]
    v_pk_fma_f32 v[138:139], v[138:139], v[140:141], v[146:147] op_sel:[1,1,0] op_sel_hi:[0,1,1] neg_hi:[0,1,0]
    v_cvt_pk_bf16_f32 v27, v130, v131
    v_cvt_pk_bf16_f32 v31, v138, v139
    v_pk_mul_f32 v[144:145], v[128:129], v[134:135] op_sel_hi:[1,0]
    v_pk_mul_f32 v[146:147], v[136:137], v[142:143] op_sel_hi:[1,0]
    v_pk_fma_f32 v[128:129], v[128:129], v[134:135], v[144:145] op_sel:[1,1,0] op_sel_hi:[0,1,1] neg_hi:[0,1,0]
    v_pk_fma_f32 v[136:137], v[136:137], v[142:143], v[146:147] op_sel:[1,1,0] op_sel_hi:[0,1,1] neg_hi:[0,1,0]
    v_cvt_pk_bf16_f32 v32, v128, v129
    v_cvt_pk_bf16_f32 v36, v136, v137
    v_pk_mul_f32 v[144:145], v[128:129], v[132:133] op_sel_hi:[1,0]
    v_pk_mul_f32 v[146:147], v[136:137], v[140:141] op_sel_hi:[1,0]
    v_pk_fma_f32 v[130:131], v[128:129], v[132:133], v[144:145] op_sel:[1,1,0] op_sel_hi:[0,1,1] neg_hi:[0,1,0]
    v_pk_fma_f32 v[138:139], v[136:137], v[140:141], v[146:147] op_sel:[1,1,0] op_sel_hi:[0,1,1] neg_hi:[0,1,0]
    v_cvt_pk_bf16_f32 v33, v130, v131
    v_cvt_pk_bf16_f32 v37, v138, v139
    v_pk_mul_f32 v[144:145], v[130:131], v[132:133] op_sel_hi:[1,0]
    v_pk_mul_f32 v[146:147], v[138:139], v[140:141] op_sel_hi:[1,0]
    v_pk_fma_f32 v[130:131], v[130:131], v[132:133], v[144:145] op_sel:[1,1,0] op_sel_hi:[0,1,1] neg_hi:[0,1,0]
    v_pk_fma_f32 v[138:139], v[138:139], v[140:141], v[146:147] op_sel:[1,1,0] op_sel_hi:[0,1,1] neg_hi:[0,1,0]
    v_cvt_pk_bf16_f32 v34, v130, v131
    v_cvt_pk_bf16_f32 v38, v138, v139
    v_pk_mul_f32 v[144:145], v[130:131], v[132:133] op_sel_hi:[1,0]
    v_pk_mul_f32 v[146:147], v[138:139], v[140:141] op_sel_hi:[1,0]
    v_pk_fma_f32 v[130:131], v[130:131], v[132:133], v[144:145] op_sel:[1,1,0] op_sel_hi:[0,1,1] neg_hi:[0,1,0]
    v_pk_fma_f32 v[138:139], v[138:139], v[140:141], v[146:147] op_sel:[1,1,0] op_sel_hi:[0,1,1] neg_hi:[0,1,0]
    v_cvt_pk_bf16_f32 v35, v130, v131
    v_cvt_pk_bf16_f32 v39, v138, v139
    v_pk_mul_f32 v[144:145], v[128:129], v[134:135] op_sel_hi:[1,0]
    v_pk_mul_f32 v[146:147], v[136:137], v[142:143] op_sel_hi:[1,0]
    v_pk_fma_f32 v[128:129], v[128:129], v[134:135], v[144:145] op_sel:[1,1,0] op_sel_hi:[0,1,1] neg_hi:[0,1,0]
    v_pk_fma_f32 v[136:137], v[136:137], v[142:143], v[146:147] op_sel:[1,1,0] op_sel_hi:[0,1,1] neg_hi:[0,1,0]
    v_cvt_pk_bf16_f32 v40, v128, v129
    v_cvt_pk_bf16_f32 v44, v136, v137
    v_pk_mul_f32 v[144:145], v[128:129], v[132:133] op_sel_hi:[1,0]
    v_pk_mul_f32 v[146:147], v[136:137], v[140:141] op_sel_hi:[1,0]
    v_pk_fma_f32 v[130:131], v[128:129], v[132:133], v[144:145] op_sel:[1,1,0] op_sel_hi:[0,1,1] neg_hi:[0,1,0]
    v_pk_fma_f32 v[138:139], v[136:137], v[140:141], v[146:147] op_sel:[1,1,0] op_sel_hi:[0,1,1] neg_hi:[0,1,0]
    v_cvt_pk_bf16_f32 v41, v130, v131
    v_cvt_pk_bf16_f32 v45, v138, v139
    v_pk_mul_f32 v[144:145], v[130:131], v[132:133] op_sel_hi:[1,0]
    v_pk_mul_f32 v[146:147], v[138:139], v[140:141] op_sel_hi:[1,0]
    v_pk_fma_f32 v[130:131], v[130:131], v[132:133], v[144:145] op_sel:[1,1,0] op_sel_hi:[0,1,1] neg_hi:[0,1,0]
    v_pk_fma_f32 v[138:139], v[138:139], v[140:141], v[146:147] op_sel:[1,1,0] op_sel_hi:[0,1,1] neg_hi:[0,1,0]
    v_cvt_pk_bf16_f32 v42, v130, v131
    v_cvt_pk_bf16_f32 v46, v138, v139
    v_pk_mul_f32 v[144:145], v[130:131], v[132:133] op_sel_hi:[1,0]
    v_pk_mul_f32 v[146:147], v[138:139], v[140:141] op_sel_hi:[1,0]
    v_pk_fma_f32 v[130:131], v[130:131], v[132:133], v[144:145] op_sel:[1,1,0] op_sel_hi:[0,1,1] neg_hi:[0,1,0]
    v_pk_fma_f32 v[138:139], v[138:139], v[140:141], v[146:147] op_sel:[1,1,0] op_sel_hi:[0,1,1] neg_hi:[0,1,0]
    v_cvt_pk_bf16_f32 v43, v130, v131
    v_cvt_pk_bf16_f32 v47, v138, v139
    s_setprio 0
    s_waitcnt vmcnt(8)
    v_mfma_f32_32x32x16_bf16 v[128:143], v[64:67], v[192:195], 0
    v_mfma_f32_32x32x16_bf16 v[144:159], v[64:67], v[196:199], 0
    v_mfma_f32_32x32x16_bf16 v[160:175], v[68:71], v[192:195], 0
    v_mfma_f32_32x32x16_bf16 v[176:191], v[68:71], v[196:199], 0
    s_add_u32 s61, s10, 5
    s_sub_u32 s59, s61, 8
    s_cmp_ge_u32 s61, 8
    s_cselect_b32 s61, s59, s61
    s_mul_i32 s59, s57, 8
    s_add_u32 s61, s61, s59
    s_add_u32 s61, s61, 0x50
    s_lshl_b32 s61, s61, 10
    s_add_u32 s61, s61, s101
    buffer_load_dwordx4 v[192:195], v3, s[44:47], s61 offen
    s_add_u32 s61, s61, 0xe0000
    buffer_load_dwordx4 v[196:199], v3, s[44:47], s61 offen
    s_waitcnt vmcnt(8)
    v_mfma_f32_32x32x16_bf16 v[128:143], v[72:75], v[200:203], v[128:143]
    v_mfma_f32_32x32x16_bf16 v[144:159], v[72:75], v[204:207], v[144:159]
    v_mfma_f32_32x32x16_bf16 v[160:175], v[76:79], v[200:203], v[160:175]
    v_mfma_f32_32x32x16_bf16 v[176:191], v[76:79], v[204:207], v[176:191]
    s_add_u32 s61, s10, 6
    s_sub_u32 s59, s61, 8
    s_cmp_ge_u32 s61, 8
    s_cselect_b32 s61, s59, s61
    s_mul_i32 s59, s57, 8
    s_add_u32 s61, s61, s59
    s_add_u32 s61, s61, 0x50
    s_lshl_b32 s61, s61, 10
    s_add_u32 s61, s61, s101
    buffer_load_dwordx4 v[200:203], v3, s[44:47], s61 offen
    s_add_u32 s61, s61, 0xe0000
    buffer_load_dwordx4 v[204:207], v3, s[44:47], s61 offen
    s_waitcnt vmcnt(8)
    v_mfma_f32_32x32x16_bf16 v[128:143], v[80:83], v[208:211], v[128:143]
    v_mfma_f32_32x32x16_bf16 v[144:159], v[80:83], v[212:215], v[144:159]
    v_mfma_f32_32x32x16_bf16 v[160:175], v[84:87], v[208:211], v[160:175]
    v_mfma_f32_32x32x16_bf16 v[176:191], v[84:87], v[212:215], v[176:191]
    s_add_u32 s61, s10, 7
    s_sub_u32 s59, s61, 8
    s_cmp_ge_u32 s61, 8
    s_cselect_b32 s61, s59, s61
    s_mul_i32 s59, s57, 8
    s_add_u32 s61, s61, s59
    s_add_u32 s61, s61, 0x50
    s_lshl_b32 s61, s61, 10
    s_add_u32 s61, s61, s101
    buffer_load_dwordx4 v[208:211], v3, s[44:47], s61 offen
    s_add_u32 s61, s61, 0xe0000
    buffer_load_dwordx4 v[212:215], v3, s[44:47], s61 offen
    v_and_b32 v12, 7, v1
    v_lshlrev_b32 v12, 2, v12
    v_add_u32 v12, 0x27c00, v12
    s_mov_b32 s59, 0
LW_26_P:
    ds_read_b32 v13, v12 offset:176
    s_add_u32 s59, s59, 1
    s_waitcnt lgkmcnt(0)
    v_cmp_gt_u32 vcc, 1, v13
    s_cmp_ge_u32 s59, 0x8000
    s_cbranch_scc1 LW_26_G
    s_nop 2
    s_cbranch_vccnz LW_26_P
LW_26_G:
    s_mov_b32 s62, s63
    buffer_load_dwordx4 v[56:59], v2, s[44:47], s62 offen sc1
    s_add_u32 s62, s62, 0x8000
    buffer_load_dwordx4 v[60:63], v2, s[44:47], s62 offen sc1
    s_add_u32 s62, s62, 0x8000
    buffer_load_dwordx4 v[224:227], v2, s[44:47], s62 offen sc1
    s_add_u32 s62, s62, 0x8000
    buffer_load_dwordx4 v[228:231], v2, s[44:47], s62 offen sc1
    s_add_u32 s62, s62, 0x8000
    buffer_load_dwordx4 v[232:235], v2, s[44:47], s62 offen sc1
    s_add_u32 s62, s62, 0x8000
    buffer_load_dwordx4 v[236:239], v2, s[44:47], s62 offen sc1
    s_add_u32 s62, s62, 0x8000
    buffer_load_dwordx4 v[240:243], v2, s[44:47], s62 offen sc1
    s_add_u32 s62, s62, 0x8000
    buffer_load_dwordx4 v[244:247], v2, s[44:47], s62 offen sc1
    s_add_u32 s62, s62, 0x8000
    buffer_load_dwordx4 v[248:251], v8, s[24:27], 0 offen
    s_waitcnt vmcnt(17)
    v_mfma_f32_32x32x16_bf16 v[128:143], v[88:91], v[48:51], v[128:143]
    v_mfma_f32_32x32x16_bf16 v[144:159], v[88:91], v[52:55], v[144:159]
    v_mfma_f32_32x32x16_bf16 v[160:175], v[92:95], v[48:51], v[160:175]
    v_mfma_f32_32x32x16_bf16 v[176:191], v[92:95], v[52:55], v[176:191]
    s_waitcnt vmcnt(15)
    v_mfma_f32_32x32x16_bf16 v[128:143], v[96:99], v[216:219], v[128:143]
    v_mfma_f32_32x32x16_bf16 v[144:159], v[96:99], v[220:223], v[144:159]
    v_mfma_f32_32x32x16_bf16 v[160:175], v[100:103], v[216:219], v[160:175]
    v_mfma_f32_32x32x16_bf16 v[176:191], v[100:103], v[220:223], v[176:191]
    s_waitcnt vmcnt(13)
    v_mfma_f32_32x32x16_bf16 v[128:143], v[104:107], v[192:195], v[128:143]
    v_mfma_f32_32x32x16_bf16 v[144:159], v[104:107], v[196:199], v[144:159]
    v_mfma_f32_32x32x16_bf16 v[160:175], v[108:111], v[192:195], v[160:175]
    v_mfma_f32_32x32x16_bf16 v[176:191], v[108:111], v[196:199], v[176:191]
    s_waitcnt vmcnt(11)
    v_mfma_f32_32x32x16_bf16 v[128:143], v[112:115], v[200:203], v[128:143]
    v_mfma_f32_32x32x16_bf16 v[144:159], v[112:115], v[204:207], v[144:159]
    v_mfma_f32_32x32x16_bf16 v[160:175], v[116:119], v[200:203], v[160:175]
    v_mfma_f32_32x32x16_bf16 v[176:191], v[116:119], v[204:207], v[176:191]
    s_lshl_b32 s59, s57, 2
    s_add_u32 s59, s59, 0x27c00
    v_mov_b32 v12, s59
    s_mov_b32 s59, 0
LW_27_P:
    ds_read_b32 v13, v12 offset:96
    s_add_u32 s59, s59, 1
    s_waitcnt lgkmcnt(0)
    v_cmp_gt_u32 vcc, 1, v13
    s_cmp_ge_u32 s59, 0x8000
    s_cbranch_scc1 LW_27_G
    s_nop 2
    s_cbranch_vccnz LW_27_P
LW_27_G:
    s_waitcnt vmcnt(9)
    v_mfma_f32_32x32x16_bf16 v[128:143], v[120:123], v[208:211], v[128:143]
    v_mfma_f32_32x32x16_bf16 v[144:159], v[120:123], v[212:215], v[144:159]
    v_mfma_f32_32x32x16_bf16 v[160:175], v[124:127], v[208:211], v[160:175]
    v_mfma_f32_32x32x16_bf16 v[176:191], v[124:127], v[212:215], v[176:191]
    s_waitcnt vmcnt(1)
    s_branch YChC
YChP:
    s_sleep 3
    s_add_u32 s66, s66, 1
    s_mov_b32 s62, s63
    buffer_load_dwordx4 v[56:59], v2, s[44:47], s62 offen sc1
    s_add_u32 s62, s62, 0x8000
    buffer_load_dwordx4 v[60:63], v2, s[44:47], s62 offen sc1
    s_add_u32 s62, s62, 0x8000
    buffer_load_dwordx4 v[224:227], v2, s[44:47], s62 offen sc1
    s_add_u32 s62, s62, 0x8000
    buffer_load_dwordx4 v[228:231], v2, s[44:47], s62 offen sc1
    s_add_u32 s62, s62, 0x8000
    buffer_load_dwordx4 v[232:235], v2, s[44:47], s62 offen sc1
    s_add_u32 s62, s62, 0x8000
    buffer_load_dwordx4 v[236:239], v2, s[44:47], s62 offen sc1
    s_add_u32 s62, s62, 0x8000
    buffer_load_dwordx4 v[240:243], v2, s[44:47], s62 offen sc1
    s_add_u32 s62, s62, 0x8000
    buffer_load_dwordx4 v[244:247], v2, s[44:47], s62 offen sc1
    s_add_u32 s62, s62, 0x8000
    s_waitcnt vmcnt(0)
YChC:
    v_max3_u32 v12, v56, v57, v58
    v_max3_u32 v13, v59, v60, v61
    v_max3_u32 v12, v12, v62, v63
    v_max3_u32 v13, v13, v224, v225
    v_max3_u32 v12, v12, v226, v227
    v_max3_u32 v13, v13, v228, v229
    v_max3_u32 v12, v12, v230, v231
    v_max3_u32 v13, v13, v232, v233
    v_max3_u32 v12, v12, v234, v235
    v_max3_u32 v13, v13, v236, v237
    v_max3_u32 v12, v12, v238, v239
    v_max3_u32 v13, v13, v240, v241
    v_max3_u32 v12, v12, v242, v243
    v_max3_u32 v13, v13, v244, v245
    v_max3_u32 v12, v12, v246, v247
    v_max_u32 v12, v12, v13
    v_cmp_eq_u32 vcc, -1, v12
    s_cmp_ge_u32 s66, 0xfa0
    s_cbranch_scc1 YChG
    s_nop 2
    s_cbranch_vccnz YChP
YChG:
    ds_write_b128 v7, v[56:59]
    ds_write_b128 v7, v[60:63] offset:1024
    ds_read_b64_tr_b16 v[56:57], v6
    ds_read_b64_tr_b16 v[58:59], v6 offset:512
    ds_read_b64_tr_b16 v[60:61], v6 offset:8
    ds_read_b64_tr_b16 v[62:63], v6 offset:520
    ds_write_b128 v7, v[224:227]
    ds_write_b128 v7, v[228:231] offset:1024
    ds_read_b64_tr_b16 v[224:225], v6
    ds_read_b64_tr_b16 v[226:227], v6 offset:512
    ds_read_b64_tr_b16 v[228:229], v6 offset:8
    ds_read_b64_tr_b16 v[230:231], v6 offset:520
    s_waitcnt lgkmcnt(6)
    v_mfma_f32_32x32x16_bf16 v[128:143], v[16:19], v[56:59], v[128:143]
    v_mfma_f32_32x32x16_bf16 v[144:159], v[16:19], v[60:63], v[144:159]
    v_mfma_f32_32x32x16_bf16 v[160:175], v[20:23], v[56:59], v[160:175]
    v_mfma_f32_32x32x16_bf16 v[176:191], v[20:23], v[60:63], v[176:191]
    ds_write_b128 v7, v[232:235]
    ds_write_b128 v7, v[236:239] offset:1024
    ds_read_b64_tr_b16 v[232:233], v6
    ds_read_b64_tr_b16 v[234:235], v6 offset:512
    ds_read_b64_tr_b16 v[236:237], v6 offset:8
    ds_read_b64_tr_b16 v[238:239], v6 offset:520
    s_waitcnt lgkmcnt(6)
    v_mfma_f32_32x32x16_bf16 v[128:143], v[24:27], v[224:227], v[128:143]
    v_mfma_f32_32x32x16_bf16 v[144:159], v[24:27], v[228:231], v[144:159]
    v_mfma_f32_32x32x16_bf16 v[160:175], v[28:31], v[224:227], v[160:175]
    v_mfma_f32_32x32x16_bf16 v[176:191], v[28:31], v[228:231], v[176:191]
    ds_write_b128 v7, v[240:243]
    ds_write_b128 v7, v[244:247] offset:1024
    ds_read_b64_tr_b16 v[240:241], v6
    ds_read_b64_tr_b16 v[242:243], v6 offset:512
    ds_read_b64_tr_b16 v[244:245], v6 offset:8
    ds_read_b64_tr_b16 v[246:247], v6 offset:520
    s_waitcnt lgkmcnt(6)
    v_mfma_f32_32x32x16_bf16 v[128:143], v[32:35], v[232:235], v[128:143]
    v_mfma_f32_32x32x16_bf16 v[144:159], v[32:35], v[236:239], v[144:159]
    v_mfma_f32_32x32x16_bf16 v[160:175], v[36:39], v[232:235], v[160:175]
    v_mfma_f32_32x32x16_bf16 v[176:191], v[36:39], v[236:239], v[176:191]
    s_waitcnt lgkmcnt(0)
    v_mfma_f32_32x32x16_bf16 v[128:143], v[40:43], v[240:243], v[128:143]
    v_mfma_f32_32x32x16_bf16 v[144:159], v[40:43], v[244:247], v[144:159]
    v_mfma_f32_32x32x16_bf16 v[160:175], v[44:47], v[240:243], v[160:175]
    v_mfma_f32_32x32x16_bf16 v[176:191], v[44:47], v[244:247], v[176:191]
    v_xor_b32 v16, 0, v3
    s_add_u32 s59, s58, 0xc000
    v_add_u32 v16, s59, v16
    v_xor_b32 v17, 32, v3
    s_add_u32 s59, s58, 0xc400
    v_add_u32 v17, s59, v17
    v_xor_b32 v18, 64, v3
    s_add_u32 s59, s58, 0xe000
    v_add_u32 v18, s59, v18
    v_xor_b32 v19, 0x60, v3
    s_add_u32 s59, s58, 0xe400
    v_add_u32 v19, s59, v19
    v_xor_b32 v20, 0x80, v3
    s_add_u32 s59, s58, 0x14000
    v_add_u32 v20, s59, v20
    v_xor_b32 v21, 0xa0, v3
    s_add_u32 s59, s58, 0x14400
    v_add_u32 v21, s59, v21
    v_xor_b32 v22, 0xc0, v3
    s_add_u32 s59, s58, 0x16000
    v_add_u32 v22, s59, v22
    v_xor_b32 v23, 0xe0, v3
    s_add_u32 s59, s58, 0x16400
    v_add_u32 v23, s59, v23
    ds_write_b128 v16, v[128:131]
    ds_write_b128 v17, v[132:135]
    ds_write_b128 v18, v[136:139]
    ds_write_b128 v19, v[140:143]
    ds_write_b128 v16, v[144:147] offset:16384
    ds_write_b128 v17, v[148:151] offset:16384
    ds_write_b128 v18, v[152:155] offset:16384
    ds_write_b128 v19, v[156:159] offset:16384
    ds_write_b128 v20, v[160:163]
    ds_write_b128 v21, v[164:167]
    ds_write_b128 v22, v[168:171]
    ds_write_b128 v23, v[172:175]
    ds_write_b128 v20, v[176:179] offset:16384
    ds_write_b128 v21, v[180:183] offset:16384
    ds_write_b128 v22, v[184:187] offset:16384
    ds_write_b128 v23, v[188:191] offset:16384
    s_waitcnt vmcnt(0)
    v_lshlrev_b32 v216, 16, v248
    v_and_b32 v217, 0xffff0000, v248
    v_lshlrev_b32 v218, 16, v249
    v_and_b32 v219, 0xffff0000, v249
    v_lshlrev_b32 v220, 16, v250
    v_and_b32 v221, 0xffff0000, v250
    v_lshlrev_b32 v222, 16, v251
    v_and_b32 v223, 0xffff0000, v251
K_RED:
    v_bfe_u32 v12, v1, 2, 1
    v_mul_u32_u24 v12, 0x14000, v12
    v_add_u32 v12, v12, v9
    v_subrev_u32 v12, 0xc000, v12
    s_waitcnt lgkmcnt(0)
    s_barrier
    ds_read_b128 v[16:19], v9
    ds_read_b128 v[20:23], v9 offset:512
    ds_read_b128 v[24:27], v9 offset:2048
    ds_read_b128 v[28:31], v9 offset:2560
    ds_read_b128 v[32:35], v9 offset:4096
    ds_read_b128 v[36:39], v9 offset:4608
    ds_read_b128 v[40:43], v9 offset:6144
    ds_read_b128 v[44:47], v9 offset:6656
    ds_read_b128 v[48:51], v12
    ds_read_b128 v[52:55], v12 offset:512
    ds_read_b128 v[56:59], v12 offset:2048
    ds_read_b128 v[60:63], v12 offset:2560
    ds_read_b128 v[64:67], v12 offset:4096
    ds_read_b128 v[68:71], v12 offset:4608
    s_waitcnt lgkmcnt(12)
    ds_read_b128 v[72:75], v12 offset:6144
    ds_read_b128 v[76:79], v12 offset:6656
    v_pk_add_f32 v[216:217], v[216:217], v[16:17]
    v_pk_add_f32 v[218:219], v[218:219], v[18:19]
    v_pk_add_f32 v[220:221], v[220:221], v[20:21]
    v_pk_add_f32 v[222:223], v[222:223], v[22:23]
    s_waitcnt lgkmcnt(12)
    v_pk_add_f32 v[216:217], v[216:217], v[24:25]
    v_pk_add_f32 v[218:219], v[218:219], v[26:27]
    v_pk_add_f32 v[220:221], v[220:221], v[28:29]
    v_pk_add_f32 v[222:223], v[222:223], v[30:31]
    s_waitcnt lgkmcnt(10)
    v_pk_add_f32 v[216:217], v[216:217], v[32:33]
    v_pk_add_f32 v[218:219], v[218:219], v[34:35]
    v_pk_add_f32 v[220:221], v[220:221], v[36:37]
    v_pk_add_f32 v[222:223], v[222:223], v[38:39]
    s_waitcnt lgkmcnt(8)
    v_pk_add_f32 v[216:217], v[216:217], v[40:41]
    v_pk_add_f32 v[218:219], v[218:219], v[42:43]
    v_pk_add_f32 v[220:221], v[220:221], v[44:45]
    v_pk_add_f32 v[222:223], v[222:223], v[46:47]
    s_waitcnt lgkmcnt(6)
    v_pk_add_f32 v[216:217], v[216:217], v[48:49]
    v_pk_add_f32 v[218:219], v[218:219], v[50:51]
    v_pk_add_f32 v[220:221], v[220:221], v[52:53]
    v_pk_add_f32 v[222:223], v[222:223], v[54:55]
    s_waitcnt lgkmcnt(4)
    v_pk_add_f32 v[216:217], v[216:217], v[56:57]
    v_pk_add_f32 v[218:219], v[218:219], v[58:59]
    v_pk_add_f32 v[220:221], v[220:221], v[60:61]
    v_pk_add_f32 v[222:223], v[222:223], v[62:63]
    s_waitcnt lgkmcnt(2)
    v_pk_add_f32 v[216:217], v[216:217], v[64:65]
    v_pk_add_f32 v[218:219], v[218:219], v[66:67]
    v_pk_add_f32 v[220:221], v[220:221], v[68:69]
    v_pk_add_f32 v[222:223], v[222:223], v[70:71]
    s_waitcnt lgkmcnt(0)
    v_pk_add_f32 v[216:217], v[216:217], v[72:73]
    v_pk_add_f32 v[218:219], v[218:219], v[74:75]
    v_pk_add_f32 v[220:221], v[220:221], v[76:77]
    v_pk_add_f32 v[222:223], v[222:223], v[78:79]
    v_cvt_pk_bf16_f32 v112, v216, v217
    v_cvt_pk_bf16_f32 v113, v218, v219
    v_cvt_pk_bf16_f32 v114, v220, v221
    v_cvt_pk_bf16_f32 v115, v222, v223
    buffer_store_dwordx4 v[112:115], v8, s[28:31], 0 offen
    s_endpgm
K_AUX:
    s_lshl_b32 s56, s52, 2
    s_add_u32 s56, s56, s53
    s_and_b32 s59, s52, 6
    s_lshr_b32 s60, s3, 2
    s_add_u32 s59, s59, s60
    s_lshl_b32 s65, s55, 3
    s_add_u32 s65, s65, s59
    s_lshl_b32 s59, s59, 8
    s_lshl_b32 s60, s55, 3
    s_add_u32 s59, s59, s60
    s_and_b32 s61, s3, 3
    s_lshl_b32 s60, s61, 1
    s_add_u32 s59, s59, s60
    s_mul_i32 s59, s59, 0x380
    v_bfe_u32 v12, v1, 3, 2
    v_lshrrev_b32 v13, 5, v1
    v_lshl_add_u32 v12, v12, 6, v13
    v_mul_u32_u24 v12, 0x380, v12
    v_and_b32 v14, 7, v1
    v_lshl_add_u32 v12, v14, 4, v12
    v_add_u32 v15, s59, v12
    s_lshl_b32 s60, s65, 8
    s_lshl_b32 s61, s61, 6
    s_add_u32 s60, s60, s61
    s_add_u32 s60, s60, 0xe00000
    v_add_u32 v6, s60, v1
    s_lshr_b32 s63, s52, 1
    s_mul_i32 s63, s63, 0x1c0
    s_mul_i32 s61, s53, 0x70
    s_add_u32 s63, s63, s61
    v_mul_u32_u24 v12, 37, v1
    v_lshrrev_b32 v12, 9, v12
    v_mul_u32_u24 v13, 14, v12
    v_sub_u32 v13, v1, v13
    v_mul_u32_u24 v14, 0xe00, v12
    v_lshl_add_u32 v14, v13, 4, v14
    v_mov_b32 v7, 0x40000000
    v_cmp_gt_u32 vcc, 56, v1
    s_nop 1
    v_cndmask_b32 v14, v7, v14, vcc
    s_lshl_b32 s61, s3, 2
    v_add_u32 v12, s61, v12
    v_mul_u32_u24 v12, 0x1c0, v12
    v_lshl_add_u32 v12, v13, 5, v12
    v_mov_b32 v7, 0x8000
    v_cndmask_b32 v8, v7, v12, vcc
    s_mul_i32 s61, s3, 0x31000
    s_lshl_b32 s62, s63, 1
    s_add_u32 s61, s61, s62
    v_mov_b32 v116, 0
    v_mov_b32 v117, 0
    v_mov_b32 v118, 0
    v_mov_b32 v119, 0
    s_and_b32 s59, s52, 1
    s_mul_i32 s64, s59, 0x3800
    s_lshl_b32 s60, s63, 3
    s_add_u32 s64, s64, s60
    s_add_u32 s64, s64, 0xe04000
    s_cmp_eq_u32 s3, 0
    s_cselect_b32 s59, 0, 0x40000000
    v_add_u32 v9, s59, v3
    s_lshl_b32 s59, s56, 3
    s_add_u32 s59, s59, s3
    s_lshl_b32 s59, s59, 11
    s_add_u32 s59, s59, 0xe80000
    s_waitcnt lgkmcnt(0)
    s_mov_b32 s44, s22
    s_mov_b32 s45, s23
    s_mov_b32 s46, 0x1000000
    s_mov_b32 s47, 0x20000
    s_mov_b32 s24, s4
    s_mov_b32 s25, s5
    s_mov_b32 s26, 0x1c0000
    s_mov_b32 s27, 0x20000
    buffer_store_dwordx4 v[116:119], v3, s[44:47], s59 offen sc1
    buffer_store_dwordx4 v[116:119], v3, s[44:47], s59 offen offset:1024 sc1
    s_mov_b32 exec_hi, 0x00ffffff
    buffer_store_dwordx4 v[116:119], v9, s[44:47], s64 offen sc1
    s_mov_b32 exec_lo, 0x01010101
    s_mov_b32 exec_hi, 0x01010101
    buffer_store_dwordx2 v[116:117], v6, s[44:47], 0 offen sc1
    s_mov_b64 exec, -1
    buffer_load_dwordx4 v[16:19], v15, s[24:27], 0 offen
    buffer_load_dwordx4 v[20:23], v15, s[24:27], 0 offen offset:128
    buffer_load_dwordx4 v[24:27], v15, s[24:27], 0 offen offset:256
    buffer_load_dwordx4 v[28:31], v15, s[24:27], 0 offen offset:384
    buffer_load_dwordx4 v[32:35], v15, s[24:27], 0 offen offset:512
    buffer_load_dwordx4 v[36:39], v15, s[24:27], 0 offen offset:640
    buffer_load_dwordx4 v[40:43], v15, s[24:27], 0 offen offset:768
    s_bitcmp0_b32 s52, 0
    s_cselect_b32 s28, s12, s14
    s_cselect_b32 s29, s13, s15
    s_mov_b32 s30, 0x188000
    s_mov_b32 s31, 0x20000
    s_mov_b32 s32, s20
    s_mov_b32 s33, s21
    s_mov_b32 s34, 0x100
    s_mov_b32 s35, 0x20000
    s_mov_b32 s36, s6
    s_mov_b32 s37, s7
    s_mov_b32 s38, 0xe1000
    s_mov_b32 s39, 0x20000
    s_mov_b32 s40, s8
    s_mov_b32 s41, s9
    s_mov_b32 s42, 0xe1000
    s_mov_b32 s43, 0x20000
    s_barrier
    s_bfe_u32 s59, s56, 0x10002
    s_lshl_b32 s59, s59, 4
    s_lshr_b32 s60, s56, 3
    s_lshl_b32 s60, s60, 9
    s_add_u32 s59, s59, s60
    s_and_b32 s60, s56, 3
    s_lshl_b32 s60, s60, 7
    s_add_u32 s59, s59, s60
    s_lshl_b32 s60, s57, 5
    s_add_u32 s59, s59, s60
    s_mul_i32 s59, s59, 0x1c2
    s_cmp_ge_u32 s3, 4
    s_cselect_b32 s36, s40, s36
    s_cselect_b32 s37, s41, s37
    s_lshl_b32 s60, s3, 13
    s_add_u32 m0, s60, 0x10000
    s_nop 0
    buffer_load_dwordx4 v3, s[36:39], s59 offen lds
    s_add_u32 s59, s59, 0x400
    s_add_u32 m0, s60, 0x10400
    s_nop 0
    buffer_load_dwordx4 v3, s[36:39], s59 offen lds
    s_add_u32 s59, s59, 0x400
    s_add_u32 m0, s60, 0x10800
    s_nop 0
    buffer_load_dwordx4 v3, s[36:39], s59 offen lds
    s_add_u32 s59, s59, 0x400
    s_add_u32 m0, s60, 0x10c00
    s_nop 0
    buffer_load_dwordx4 v3, s[36:39], s59 offen lds
    s_add_u32 s59, s59, 0x400
    s_add_u32 m0, s60, 0x11000
    s_nop 0
    buffer_load_dwordx4 v3, s[36:39], s59 offen lds
    s_add_u32 s59, s59, 0x400
    s_add_u32 m0, s60, 0x11400
    s_nop 0
    buffer_load_dwordx4 v3, s[36:39], s59 offen lds
    s_add_u32 s59, s59, 0x400
    s_add_u32 m0, s60, 0x11800
    s_nop 0
    buffer_load_dwordx4 v3, s[36:39], s59 offen lds
    s_add_u32 s59, s59, 0x400
    s_add_u32 m0, s60, 0x11c00
    s_mov_b64 exec, 3
    buffer_load_dwordx4 v3, s[36:39], s59 offen lds
    s_mov_b64 exec, -1
    buffer_load_dwordx4 v[44:47], v14, s[28:31], s61 offen
    s_add_u32 s61, s61, 0x3800
    buffer_load_dwordx4 v[48:51], v14, s[28:31], s61 offen
    s_add_u32 s61, s61, 0x3800
    s_waitcnt vmcnt(17)
    s_barrier
    s_cmp_lg_u32 s3, 7
    s_cbranch_scc1 AO_28
    v_mov_b32 v122, 0
    v_mov_b32 v123, 1
    s_mov_b64 exec, 1
    buffer_atomic_add v123, v122, s[32:35], 0 offen sc0
    s_mov_b64 exec, -1
AO_28:
    v_mov_b32 v4, 0
    v_mov_b32 v5, 0
    v_mov_b32 v9, 0
    v_mov_b32 v10, 0
    v_mov_b32 v125, 0x3f803f80
    v_mov_b32 v126, 0x3f80
    v_mov_b32 v127, 0x3f800000
    s_waitcnt vmcnt(16)
    v_dot2c_f32_bf16 v4, v16, v125
    v_dot2c_f32_bf16 v5, v16, v16
    v_dot2c_f32_bf16 v9, v17, v125
    v_dot2c_f32_bf16 v10, v17, v17
    v_dot2c_f32_bf16 v4, v18, v125
    v_dot2c_f32_bf16 v5, v18, v18
    v_dot2c_f32_bf16 v9, v19, v125
    v_dot2c_f32_bf16 v10, v19, v19
    s_waitcnt vmcnt(15)
    v_dot2c_f32_bf16 v4, v20, v125
    v_dot2c_f32_bf16 v5, v20, v20
    v_dot2c_f32_bf16 v9, v21, v125
    v_dot2c_f32_bf16 v10, v21, v21
    v_dot2c_f32_bf16 v4, v22, v125
    v_dot2c_f32_bf16 v5, v22, v22
    v_dot2c_f32_bf16 v9, v23, v125
    v_dot2c_f32_bf16 v10, v23, v23
    s_waitcnt vmcnt(14)
    v_dot2c_f32_bf16 v4, v24, v125
    v_dot2c_f32_bf16 v5, v24, v24
    v_dot2c_f32_bf16 v9, v25, v125
    v_dot2c_f32_bf16 v10, v25, v25
    v_dot2c_f32_bf16 v4, v26, v125
    v_dot2c_f32_bf16 v5, v26, v26
    v_dot2c_f32_bf16 v9, v27, v125
    v_dot2c_f32_bf16 v10, v27, v27
    s_waitcnt vmcnt(13)
    v_dot2c_f32_bf16 v4, v28, v125
    v_dot2c_f32_bf16 v5, v28, v28
    v_dot2c_f32_bf16 v9, v29, v125
    v_dot2c_f32_bf16 v10, v29, v29
    v_dot2c_f32_bf16 v4, v30, v125
    v_dot2c_f32_bf16 v5, v30, v30
    v_dot2c_f32_bf16 v9, v31, v125
    v_dot2c_f32_bf16 v10, v31, v31
    s_waitcnt vmcnt(12)
    v_dot2c_f32_bf16 v4, v32, v125
    v_dot2c_f32_bf16 v5, v32, v32
    v_dot2c_f32_bf16 v9, v33, v125
    v_dot2c_f32_bf16 v10, v33, v33
    v_dot2c_f32_bf16 v4, v34, v125
    v_dot2c_f32_bf16 v5, v34, v34
    v_dot2c_f32_bf16 v9, v35, v125
    v_dot2c_f32_bf16 v10, v35, v35
    s_waitcnt vmcnt(11)
    v_dot2c_f32_bf16 v4, v36, v125
    v_dot2c_f32_bf16 v5, v36, v36
    v_dot2c_f32_bf16 v9, v37, v125
    v_dot2c_f32_bf16 v10, v37, v37
    v_dot2c_f32_bf16 v4, v38, v125
    v_dot2c_f32_bf16 v5, v38, v38
    v_dot2c_f32_bf16 v9, v39, v125
    v_dot2c_f32_bf16 v10, v39, v39
    s_waitcnt vmcnt(10)
    v_dot2c_f32_bf16 v4, v40, v125
    v_dot2c_f32_bf16 v5, v40, v40
    v_dot2c_f32_bf16 v9, v41, v125
    v_dot2c_f32_bf16 v10, v41, v41
    v_dot2c_f32_bf16 v4, v42, v125
    v_dot2c_f32_bf16 v5, v42, v42
    v_dot2c_f32_bf16 v9, v43, v125
    v_dot2c_f32_bf16 v10, v43, v43
    s_nop 1
    v_add_f32 v4, v4, v9
    v_add_f32 v5, v5, v10
    s_nop 0
    v_add_f32_dpp v4, v4, v4 quad_perm:[1,0,3,2] row_mask:0xf bank_mask:0xf
    v_add_f32_dpp v5, v5, v5 quad_perm:[1,0,3,2] row_mask:0xf bank_mask:0xf
    s_nop 0
    v_add_f32_dpp v4, v4, v4 quad_perm:[2,3,0,1] row_mask:0xf bank_mask:0xf
    v_add_f32_dpp v5, v5, v5 quad_perm:[2,3,0,1] row_mask:0xf bank_mask:0xf
    s_nop 0
    v_add_f32_dpp v4, v4, v4 row_half_mirror row_mask:0xf bank_mask:0xf
    v_add_f32_dpp v5, v5, v5 row_half_mirror row_mask:0xf bank_mask:0xf
    v_mul_f32 v4, 0x3b124925, v4
    v_mul_f32 v13, 0x3b124925, v5
    v_fma_f32 v13, -v4, v4, v13
    v_max_f32 v13, 0, v13
    v_cvt_pk_bf16_f32 v12, v4, v4
    v_lshlrev_b32 v4, 16, v12
    v_cvt_pk_bf16_f32 v12, v13, v13
    v_lshlrev_b32 v13, 16, v12
    v_add_f32 v13, 0x3727c5ac, v13
    v_cvt_pk_bf16_f32 v12, v13, v13
    v_lshlrev_b32 v13, 16, v12
    v_sqrt_f32 v13, v13
    s_nop 0
    v_cvt_pk_bf16_f32 v12, v13, v13
    v_lshlrev_b32 v13, 16, v12
    v_rcp_f32 v5, v13
    s_mov_b32 exec_lo, 0x01010101
    s_mov_b32 exec_hi, 0x01010101
    buffer_store_dwordx2 v[4:5], v6, s[44:47], 0 offen sc1
    s_mov_b64 exec, -1
    s_cmp_lg_u32 s3, 7
    s_cbranch_scc1 AO_29
    s_mov_b64 exec, 1
    s_waitcnt vmcnt(1)
    v_mov_b32 v122, 0x80
    v_mov_b32 v124, 0x40000000
    v_cmp_eq_u32 vcc, 31, v123
    s_nop 1
    v_cndmask_b32 v122, v124, v122, vcc
    v_mov_b32 v123, 1
    buffer_store_dword v123, v122, s[32:35], 0 offen sc1
    s_mov_b64 exec, -1
AO_29:
    buffer_load_dwordx4 v[52:55], v14, s[28:31], s61 offen
    s_add_u32 s61, s61, 0x3800
    buffer_load_dwordx4 v[56:59], v14, s[28:31], s61 offen
    s_add_u32 s61, s61, 0x3800
    buffer_load_dwordx4 v[60:63], v14, s[28:31], s61 offen
    s_add_u32 s61, s61, 0x3800
    buffer_load_dwordx4 v[64:67], v14, s[28:31], s61 offen
    s_add_u32 s61, s61, 0x3800
    buffer_load_dwordx4 v[68:71], v14, s[28:31], s61 offen
    s_add_u32 s61, s61, 0x3800
    buffer_load_dwordx4 v[72:75], v14, s[28:31], s61 offen
    s_add_u32 s61, s61, 0x3800
    buffer_load_dwordx4 v[76:79], v14, s[28:31], s61 offen
    s_add_u32 s61, s61, 0x3800
    buffer_load_dwordx4 v[80:83], v14, s[28:31], s61 offen
    s_add_u32 s61, s61, 0x3800
    buffer_load_dwordx4 v[84:87], v14, s[28:31], s61 offen
    s_add_u32 s61, s61, 0x3800
    buffer_load_dwordx4 v[88:91], v14, s[28:31], s61 offen
    s_add_u32 s61, s61, 0x3800
    buffer_load_dwordx4 v[92:95], v14, s[28:31], s61 offen
    s_add_u32 s61, s61, 0x3800
    buffer_load_dwordx4 v[96:99], v14, s[28:31], s61 offen
    v_mov_b32 v108, 0
    v_mov_b32 v109, 0
    v_mov_b32 v110, 0
    v_mov_b32 v111, 0
    v_mov_b32 v112, 0
    v_mov_b32 v113, 0
    v_mov_b32 v114, 0
    v_mov_b32 v115, 0
    s_waitcnt vmcnt(15)
    s_barrier
    v_and_b32 v12, 15, v1
    v_mul_u32_u24 v13, 0x1c2, v12
    v_lshrrev_b32 v14, 4, v1
    s_lshl_b32 s59, s3, 2
    v_add_u32 v14, s59, v14
    v_lshl_add_u32 v13, v14, 1, v13
    v_add_u32 v13, 0x10000, v13
    v_lshlrev_b32 v12, 4, v12
    v_lshl_add_u32 v12, v14, 13, v12
    v_mov_b32 v15, 0x40000000
    v_cmp_eq_u32 vcc, 0, v14
    s_nop 1
    v_cndmask_b32 v15, v15, v12, vcc
    s_lshl_b32 s59, s56, 8
    s_add_u32 s59, s59, 0xa00000
    ds_read_u16 v128, v13
    ds_read_u16 v129, v13 offset:8192
    ds_read_u16 v130, v13 offset:16384
    ds_read_u16 v131, v13 offset:24576
    ds_read_u16 v132, v13 offset:32768
    ds_read_u16 v133, v13 offset:40960
    ds_read_u16 v134, v13 offset:49152
    ds_read_u16 v135, v13 offset:57344
    ds_read_u16 v136, v13 offset:64
    ds_read_u16 v137, v13 offset:8256
    ds_read_u16 v138, v13 offset:16448
    ds_read_u16 v139, v13 offset:24640
    ds_read_u16 v140, v13 offset:32832
    ds_read_u16 v141, v13 offset:41024
    s_waitcnt lgkmcnt(6)
    ds_read_u16 v142, v13 offset:49216
    ds_read_u16 v143, v13 offset:57408
    v_lshl_or_b32 v128, v129, 16, v128
    v_lshl_or_b32 v129, v131, 16, v130
    v_lshl_or_b32 v130, v133, 16, v132
    v_lshl_or_b32 v131, v135, 16, v134
    buffer_store_dwordx4 v[128:131], v12, s[44:47], s59 offen sc1
    s_add_u32 s59, s59, 0x40000
    ds_read_u16 v144, v13 offset:128
    ds_read_u16 v145, v13 offset:8320
    ds_read_u16 v146, v13 offset:16512
    ds_read_u16 v147, v13 offset:24704
    ds_read_u16 v148, v13 offset:32896
    ds_read_u16 v149, v13 offset:41088
    s_waitcnt lgkmcnt(6)
    ds_read_u16 v150, v13 offset:49280
    ds_read_u16 v151, v13 offset:57472
    v_lshl_or_b32 v136, v137, 16, v136
    v_lshl_or_b32 v137, v139, 16, v138
    v_lshl_or_b32 v138, v141, 16, v140
    v_lshl_or_b32 v139, v143, 16, v142
    buffer_store_dwordx4 v[136:139], v12, s[44:47], s59 offen sc1
    s_add_u32 s59, s59, 0x40000
    ds_read_u16 v152, v13 offset:192
    ds_read_u16 v153, v13 offset:8384
    ds_read_u16 v154, v13 offset:16576
    ds_read_u16 v155, v13 offset:24768
    ds_read_u16 v156, v13 offset:32960
    ds_read_u16 v157, v13 offset:41152
    s_waitcnt lgkmcnt(6)
    ds_read_u16 v158, v13 offset:49344
    ds_read_u16 v159, v13 offset:57536
    v_lshl_or_b32 v144, v145, 16, v144
    v_lshl_or_b32 v145, v147, 16, v146
    v_lshl_or_b32 v146, v149, 16, v148
    v_lshl_or_b32 v147, v151, 16, v150
    buffer_store_dwordx4 v[144:147], v12, s[44:47], s59 offen sc1
    s_add_u32 s59, s59, 0x40000
    ds_read_u16 v160, v13 offset:256
    ds_read_u16 v161, v13 offset:8448
    ds_read_u16 v162, v13 offset:16640
    ds_read_u16 v163, v13 offset:24832
    ds_read_u16 v164, v13 offset:33024
    ds_read_u16 v165, v13 offset:41216
    s_waitcnt lgkmcnt(6)
    ds_read_u16 v166, v13 offset:49408
    ds_read_u16 v167, v13 offset:57600
    v_lshl_or_b32 v152, v153, 16, v152
    v_lshl_or_b32 v153, v155, 16, v154
    v_lshl_or_b32 v154, v157, 16, v156
    v_lshl_or_b32 v155, v159, 16, v158
    buffer_store_dwordx4 v[152:155], v12, s[44:47], s59 offen sc1
    s_add_u32 s59, s59, 0x40000
    ds_read_u16 v168, v13 offset:320
    ds_read_u16 v169, v13 offset:8512
    ds_read_u16 v170, v13 offset:16704
    ds_read_u16 v171, v13 offset:24896
    ds_read_u16 v172, v13 offset:33088
    ds_read_u16 v173, v13 offset:41280
    s_waitcnt lgkmcnt(6)
    ds_read_u16 v174, v13 offset:49472
    ds_read_u16 v175, v13 offset:57664
    v_lshl_or_b32 v160, v161, 16, v160
    v_lshl_or_b32 v161, v163, 16, v162
    v_lshl_or_b32 v162, v165, 16, v164
    v_lshl_or_b32 v163, v167, 16, v166
    buffer_store_dwordx4 v[160:163], v12, s[44:47], s59 offen sc1
    s_add_u32 s59, s59, 0x40000
    ds_read_u16 v176, v13 offset:384
    ds_read_u16 v177, v13 offset:8576
    ds_read_u16 v178, v13 offset:16768
    ds_read_u16 v179, v13 offset:24960
    ds_read_u16 v180, v13 offset:33152
    ds_read_u16 v181, v13 offset:41344
    s_waitcnt lgkmcnt(6)
    ds_read_u16 v182, v13 offset:49536
    ds_read_u16 v183, v13 offset:57728
    v_lshl_or_b32 v168, v169, 16, v168
    v_lshl_or_b32 v169, v171, 16, v170
    v_lshl_or_b32 v170, v173, 16, v172
    v_lshl_or_b32 v171, v175, 16, v174
    buffer_store_dwordx4 v[168:171], v12, s[44:47], s59 offen sc1
    s_add_u32 s59, s59, 0x40000
    ds_read_u16 v184, v13 offset:448
    ds_read_u16 v185, v13 offset:8640
    ds_read_u16 v186, v13 offset:16832
    ds_read_u16 v187, v13 offset:25024
    ds_read_u16 v188, v13 offset:33216
    ds_read_u16 v189, v13 offset:41408
    s_waitcnt lgkmcnt(6)
    ds_read_u16 v190, v13 offset:49600
    ds_read_u16 v191, v13 offset:57792
    v_lshl_or_b32 v176, v177, 16, v176
    v_lshl_or_b32 v177, v179, 16, v178
    v_lshl_or_b32 v178, v181, 16, v180
    v_lshl_or_b32 v179, v183, 16, v182
    buffer_store_dwordx4 v[176:179], v12, s[44:47], s59 offen sc1
    s_add_u32 s59, s59, 0x40000
    s_waitcnt lgkmcnt(0)
    v_lshl_or_b32 v184, v185, 16, v184
    v_lshl_or_b32 v185, v187, 16, v186
    v_lshl_or_b32 v186, v189, 16, v188
    v_lshl_or_b32 v187, v191, 16, v190
    buffer_store_dwordx4 v[184:187], v15, s[44:47], s59 offen sc1
    s_waitcnt vmcnt(22)
    v_dot2c_f32_bf16 v108, v44, v126
    v_dot2c_f32_bf16 v109, v44, v127
    v_dot2c_f32_bf16 v110, v45, v126
    v_dot2c_f32_bf16 v111, v45, v127
    v_dot2c_f32_bf16 v112, v46, v126
    v_dot2c_f32_bf16 v113, v46, v127
    v_dot2c_f32_bf16 v114, v47, v126
    v_dot2c_f32_bf16 v115, v47, v127
    s_waitcnt vmcnt(21)
    v_dot2c_f32_bf16 v108, v48, v126
    v_dot2c_f32_bf16 v109, v48, v127
    v_dot2c_f32_bf16 v110, v49, v126
    v_dot2c_f32_bf16 v111, v49, v127
    v_dot2c_f32_bf16 v112, v50, v126
    v_dot2c_f32_bf16 v113, v50, v127
    v_dot2c_f32_bf16 v114, v51, v126
    v_dot2c_f32_bf16 v115, v51, v127
    s_waitcnt vmcnt(19)
    v_dot2c_f32_bf16 v108, v52, v126
    v_dot2c_f32_bf16 v109, v52, v127
    v_dot2c_f32_bf16 v110, v53, v126
    v_dot2c_f32_bf16 v111, v53, v127
    v_dot2c_f32_bf16 v112, v54, v126
    v_dot2c_f32_bf16 v113, v54, v127
    v_dot2c_f32_bf16 v114, v55, v126
    v_dot2c_f32_bf16 v115, v55, v127
    s_waitcnt vmcnt(18)
    v_dot2c_f32_bf16 v108, v56, v126
    v_dot2c_f32_bf16 v109, v56, v127
    v_dot2c_f32_bf16 v110, v57, v126
    v_dot2c_f32_bf16 v111, v57, v127
    v_dot2c_f32_bf16 v112, v58, v126
    v_dot2c_f32_bf16 v113, v58, v127
    v_dot2c_f32_bf16 v114, v59, v126
    v_dot2c_f32_bf16 v115, v59, v127
    s_waitcnt vmcnt(17)
    v_dot2c_f32_bf16 v108, v60, v126
    v_dot2c_f32_bf16 v109, v60, v127
    v_dot2c_f32_bf16 v110, v61, v126
    v_dot2c_f32_bf16 v111, v61, v127
    v_dot2c_f32_bf16 v112, v62, v126
    v_dot2c_f32_bf16 v113, v62, v127
    v_dot2c_f32_bf16 v114, v63, v126
    v_dot2c_f32_bf16 v115, v63, v127
    s_waitcnt vmcnt(16)
    v_dot2c_f32_bf16 v108, v64, v126
    v_dot2c_f32_bf16 v109, v64, v127
    v_dot2c_f32_bf16 v110, v65, v126
    v_dot2c_f32_bf16 v111, v65, v127
    v_dot2c_f32_bf16 v112, v66, v126
    v_dot2c_f32_bf16 v113, v66, v127
    v_dot2c_f32_bf16 v114, v67, v126
    v_dot2c_f32_bf16 v115, v67, v127
    s_waitcnt vmcnt(15)
    v_dot2c_f32_bf16 v108, v68, v126
    v_dot2c_f32_bf16 v109, v68, v127
    v_dot2c_f32_bf16 v110, v69, v126
    v_dot2c_f32_bf16 v111, v69, v127
    v_dot2c_f32_bf16 v112, v70, v126
    v_dot2c_f32_bf16 v113, v70, v127
    v_dot2c_f32_bf16 v114, v71, v126
    v_dot2c_f32_bf16 v115, v71, v127
    s_waitcnt vmcnt(14)
    v_dot2c_f32_bf16 v108, v72, v126
    v_dot2c_f32_bf16 v109, v72, v127
    v_dot2c_f32_bf16 v110, v73, v126
    v_dot2c_f32_bf16 v111, v73, v127
    v_dot2c_f32_bf16 v112, v74, v126
    v_dot2c_f32_bf16 v113, v74, v127
    v_dot2c_f32_bf16 v114, v75, v126
    v_dot2c_f32_bf16 v115, v75, v127
    s_waitcnt vmcnt(13)
    v_dot2c_f32_bf16 v108, v76, v126
    v_dot2c_f32_bf16 v109, v76, v127
    v_dot2c_f32_bf16 v110, v77, v126
    v_dot2c_f32_bf16 v111, v77, v127
    v_dot2c_f32_bf16 v112, v78, v126
    v_dot2c_f32_bf16 v113, v78, v127
    v_dot2c_f32_bf16 v114, v79, v126
    v_dot2c_f32_bf16 v115, v79, v127
    s_waitcnt vmcnt(12)
    v_dot2c_f32_bf16 v108, v80, v126
    v_dot2c_f32_bf16 v109, v80, v127
    v_dot2c_f32_bf16 v110, v81, v126
    v_dot2c_f32_bf16 v111, v81, v127
    v_dot2c_f32_bf16 v112, v82, v126
    v_dot2c_f32_bf16 v113, v82, v127
    v_dot2c_f32_bf16 v114, v83, v126
    v_dot2c_f32_bf16 v115, v83, v127
    s_waitcnt vmcnt(11)
    v_dot2c_f32_bf16 v108, v84, v126
    v_dot2c_f32_bf16 v109, v84, v127
    v_dot2c_f32_bf16 v110, v85, v126
    v_dot2c_f32_bf16 v111, v85, v127
    v_dot2c_f32_bf16 v112, v86, v126
    v_dot2c_f32_bf16 v113, v86, v127
    v_dot2c_f32_bf16 v114, v87, v126
    v_dot2c_f32_bf16 v115, v87, v127
    s_waitcnt vmcnt(10)
    v_dot2c_f32_bf16 v108, v88, v126
    v_dot2c_f32_bf16 v109, v88, v127
    v_dot2c_f32_bf16 v110, v89, v126
    v_dot2c_f32_bf16 v111, v89, v127
    v_dot2c_f32_bf16 v112, v90, v126
    v_dot2c_f32_bf16 v113, v90, v127
    v_dot2c_f32_bf16 v114, v91, v126
    v_dot2c_f32_bf16 v115, v91, v127
    s_waitcnt vmcnt(9)
    v_dot2c_f32_bf16 v108, v92, v126
    v_dot2c_f32_bf16 v109, v92, v127
    v_dot2c_f32_bf16 v110, v93, v126
    v_dot2c_f32_bf16 v111, v93, v127
    v_dot2c_f32_bf16 v112, v94, v126
    v_dot2c_f32_bf16 v113, v94, v127
    v_dot2c_f32_bf16 v114, v95, v126
    v_dot2c_f32_bf16 v115, v95, v127
    s_waitcnt vmcnt(8)
    v_dot2c_f32_bf16 v108, v96, v126
    v_dot2c_f32_bf16 v109, v96, v127
    v_dot2c_f32_bf16 v110, v97, v126
    v_dot2c_f32_bf16 v111, v97, v127
    v_dot2c_f32_bf16 v112, v98, v126
    v_dot2c_f32_bf16 v113, v98, v127
    v_dot2c_f32_bf16 v114, v99, v126
    v_dot2c_f32_bf16 v115, v99, v127
    ds_write_b128 v8, v[108:111]
    s_nop 1
    ds_write_b128 v8, v[112:115] offset:16
    s_waitcnt vmcnt(0) lgkmcnt(0)
    s_barrier
    s_cmp_lg_u32 s3, 7
    s_cbranch_scc1 AO_30
    v_mov_b32 v122, 8
    v_mov_b32 v123, 1
    s_mov_b64 exec, 1
    buffer_atomic_add v123, v122, s[32:35], 0 offen sc0
    s_waitcnt vmcnt(0)
    s_nop 0
    v_readfirstlane_b32 s59, v123
    s_mov_b64 exec, -1
    s_nop 3
    s_cmp_eq_u32 s59, 31
    s_cselect_b32 s59, 0xed8000, 0x40000000
    v_lshlrev_b32 v122, 7, v1
    s_nop 1
    v_add_u32 v122, s59, v122
    v_mov_b32 v123, 1
    buffer_store_dword v123, v122, s[44:47], 0 offen sc1
AO_30:
    s_cmp_lg_u32 s3, 0
    s_cbranch_scc1 K_AUXP
    v_lshlrev_b32 v12, 3, v1
    ds_read_b64 v[16:17], v12
    ds_read_b64 v[18:19], v12 offset:448
    ds_read_b64 v[20:21], v12 offset:896
    ds_read_b64 v[22:23], v12 offset:1344
    ds_read_b64 v[24:25], v12 offset:1792
    ds_read_b64 v[26:27], v12 offset:2240
    ds_read_b64 v[28:29], v12 offset:2688
    ds_read_b64 v[30:31], v12 offset:3136
    ds_read_b64 v[32:33], v12 offset:3584
    ds_read_b64 v[34:35], v12 offset:4032
    ds_read_b64 v[36:37], v12 offset:4480
    ds_read_b64 v[38:39], v12 offset:4928
    ds_read_b64 v[40:41], v12 offset:5376
    s_waitcnt lgkmcnt(12)
    ds_read_b64 v[42:43], v12 offset:5824
    s_waitcnt lgkmcnt(12)
    ds_read_b64 v[44:45], v12 offset:6272
    s_waitcnt lgkmcnt(12)
    ds_read_b64 v[46:47], v12 offset:6720
    s_waitcnt lgkmcnt(12)
    ds_read_b64 v[48:49], v12 offset:7168
    s_waitcnt lgkmcnt(12)
    ds_read_b64 v[50:51], v12 offset:7616
    s_waitcnt lgkmcnt(12)
    ds_read_b64 v[52:53], v12 offset:8064
    s_waitcnt lgkmcnt(12)
    ds_read_b64 v[54:55], v12 offset:8512
    s_waitcnt lgkmcnt(12)
    ds_read_b64 v[56:57], v12 offset:8960
    s_waitcnt lgkmcnt(12)
    ds_read_b64 v[58:59], v12 offset:9408
    s_waitcnt lgkmcnt(12)
    ds_read_b64 v[60:61], v12 offset:9856
    s_waitcnt lgkmcnt(12)
    ds_read_b64 v[62:63], v12 offset:10304
    s_waitcnt lgkmcnt(12)
    ds_read_b64 v[64:65], v12 offset:10752
    s_waitcnt lgkmcnt(12)
    ds_read_b64 v[66:67], v12 offset:11200
    s_waitcnt lgkmcnt(12)
    ds_read_b64 v[68:69], v12 offset:11648
    s_waitcnt lgkmcnt(12)
    ds_read_b64 v[70:71], v12 offset:12096
    s_waitcnt lgkmcnt(12)
    ds_read_b64 v[72:73], v12 offset:12544
    s_waitcnt lgkmcnt(12)
    ds_read_b64 v[74:75], v12 offset:12992
    s_waitcnt lgkmcnt(12)
    ds_read_b64 v[76:77], v12 offset:13440
    s_waitcnt lgkmcnt(12)
    ds_read_b64 v[78:79], v12 offset:13888
    s_waitcnt lgkmcnt(12)
    s_waitcnt lgkmcnt(0)
    v_pk_add_f32 v[16:17], v[16:17], v[48:49]
    v_pk_add_f32 v[18:19], v[18:19], v[50:51]
    v_pk_add_f32 v[20:21], v[20:21], v[52:53]
    v_pk_add_f32 v[22:23], v[22:23], v[54:55]
    v_pk_add_f32 v[24:25], v[24:25], v[56:57]
    v_pk_add_f32 v[26:27], v[26:27], v[58:59]
    v_pk_add_f32 v[28:29], v[28:29], v[60:61]
    v_pk_add_f32 v[30:31], v[30:31], v[62:63]
    v_pk_add_f32 v[32:33], v[32:33], v[64:65]
    v_pk_add_f32 v[34:35], v[34:35], v[66:67]
    v_pk_add_f32 v[36:37], v[36:37], v[68:69]
    v_pk_add_f32 v[38:39], v[38:39], v[70:71]
    v_pk_add_f32 v[40:41], v[40:41], v[72:73]
    v_pk_add_f32 v[42:43], v[42:43], v[74:75]
    v_pk_add_f32 v[44:45], v[44:45], v[76:77]
    v_pk_add_f32 v[46:47], v[46:47], v[78:79]
    v_pk_add_f32 v[16:17], v[16:17], v[32:33]
    v_pk_add_f32 v[18:19], v[18:19], v[34:35]
    v_pk_add_f32 v[20:21], v[20:21], v[36:37]
    v_pk_add_f32 v[22:23], v[22:23], v[38:39]
    v_pk_add_f32 v[24:25], v[24:25], v[40:41]
    v_pk_add_f32 v[26:27], v[26:27], v[42:43]
    v_pk_add_f32 v[28:29], v[28:29], v[44:45]
    v_pk_add_f32 v[30:31], v[30:31], v[46:47]
    v_pk_add_f32 v[16:17], v[16:17], v[24:25]
    v_pk_add_f32 v[18:19], v[18:19], v[26:27]
    v_pk_add_f32 v[20:21], v[20:21], v[28:29]
    v_pk_add_f32 v[22:23], v[22:23], v[30:31]
    v_pk_add_f32 v[16:17], v[16:17], v[20:21]
    v_pk_add_f32 v[18:19], v[18:19], v[22:23]
    v_pk_add_f32 v[16:17], v[16:17], v[18:19]
    v_cvt_pk_bf16_f32 v13, v16, v16
    v_lshlrev_b32 v14, 16, v13
    v_sub_f32 v16, v16, v14
    v_cvt_pk_bf16_f32 v24, v14, v16
    v_and_b32 v14, 0xffff0000, v24
    v_sub_f32 v16, v16, v14
    v_cvt_pk_bf16_f32 v25, v16, 1.0
    v_cvt_pk_bf16_f32 v13, v17, v17
    v_lshlrev_b32 v14, 16, v13
    v_sub_f32 v17, v17, v14
    v_cvt_pk_bf16_f32 v26, v14, v17
    v_and_b32 v14, 0xffff0000, v26
    v_sub_f32 v17, v17, v14
    v_cvt_pk_bf16_f32 v27, v17, 1.0
    s_mov_b32 exec_hi, 0x00ffffff
    buffer_store_dwordx4 v[24:27], v3, s[44:47], s64 offen sc1
    s_mov_b32 exec_hi, -1
K_AUXP:
    v_mov_b32 v14, 0
    v_lshlrev_b32 v13, 2, v1
    v_add_u32 v13, 0x27c00, v13
    ds_write_b32 v13, v14
    s_waitcnt vmcnt(0) lgkmcnt(0)
K_AUXR:
    s_barrier
    s_lshr_b32 s59, s3, 2
    s_or_b32 s59, s59, s56
    s_cbranch_scc0 K_AUXF
    s_waitcnt vmcnt(0)
    s_endpgm
K_AUXF:
    s_mov_b32 s59, 0xc4000
    buffer_load_dwordx4 v[226:229], v3, s[48:51], s59 offen
    s_mov_b32 s59, 0xc4400
    buffer_load_dwordx4 v[232:235], v3, s[48:51], s59 offen
    s_mov_b32 s59, 0xc4800
    buffer_load_dwordx4 v[238:241], v3, s[48:51], s59 offen
    s_mov_b32 s59, 0xc4c00
    buffer_load_dwordx4 v[244:247], v3, s[48:51], s59 offen
    s_mul_i32 s59, s57, 0x800
    s_add_u32 s59, s59, 0xc9000
    buffer_load_dwordx4 v[48:51], v3, s[48:51], s59 offen
    s_mul_i32 s59, s57, 0x800
    s_add_u32 s59, s59, 0xc9400
    buffer_load_dwordx4 v[52:55], v3, s[48:51], s59 offen
    s_mul_i32 s59, s57, 0x1000
    s_add_u32 s59, s59, 0xc5000
    buffer_load_dwordx4 v[194:197], v3, s[48:51], s59 offen
    s_mul_i32 s59, s57, 0x1000
    s_add_u32 s59, s59, 0xc5400
    buffer_load_dwordx4 v[200:203], v3, s[48:51], s59 offen
    s_mul_i32 s59, s57, 0x1000
    s_add_u32 s59, s59, 0xc5800
    buffer_load_dwordx4 v[206:209], v3, s[48:51], s59 offen
    s_mul_i32 s59, s57, 0x1000
    s_add_u32 s59, s59, 0xc5c00
    buffer_load_dwordx4 v[212:215], v3, s[48:51], s59 offen
    s_mul_i32 s59, s57, 0x800
    s_add_u32 s59, s59, 0xcb000
    buffer_load_dwordx4 v[56:59], v3, s[48:51], s59 offen
    s_mul_i32 s59, s57, 0x800
    s_add_u32 s59, s59, 0xcb400
    buffer_load_dwordx4 v[60:63], v3, s[48:51], s59 offen
    s_add_u32 s59, s58, 0x24000
    v_add_u32 v7, s59, v3
    v_mov_b32 v2, 0x40000000
    v_mov_b32 v11, 0x40000000
    v_mov_b32 v8, 0x40000000
    v_mov_b32 v12, 0x80
AX_P:
    s_add_u32 s66, s66, 1
    buffer_load_dword v14, v12, s[32:35], 0 offen sc1
    s_waitcnt vmcnt(0)
    v_cmp_ne_u32 vcc, 1, v14
    s_nop 4
    s_nop 4
    s_cbranch_vccz AX_G
    s_cmp_ge_u32 s66, 0xfa0
    s_cbranch_scc1 AX_G
    s_sleep 8
    s_branch AX_P
AX_G:
    v_xor_b32 v224, 0x80008000, v228
    v_xor_b32 v225, 0x80008000, v229
    v_xor_b32 v230, 0x80008000, v234
    v_xor_b32 v231, 0x80008000, v235
    v_xor_b32 v236, 0x80008000, v240
    v_xor_b32 v237, 0x80008000, v241
    v_xor_b32 v242, 0x80008000, v246
    v_xor_b32 v243, 0x80008000, v247
    v_xor_b32 v192, 0x80008000, v196
    v_xor_b32 v193, 0x80008000, v197
    v_xor_b32 v198, 0x80008000, v202
    v_xor_b32 v199, 0x80008000, v203
    v_xor_b32 v204, 0x80008000, v208
    v_xor_b32 v205, 0x80008000, v209
    v_xor_b32 v210, 0x80008000, v214
    v_xor_b32 v211, 0x80008000, v215
    s_movk_i32 s65, 0xe0
    s_mov_b32 s64, 0
    s_branch K_FFT
K_END:
    s_endpgm
K_CEND:
.section .rodata,"a"
.p2align 6
.amdhsa_kernel k1_kernel
  .amdhsa_next_free_vgpr 256
  .amdhsa_next_free_sgpr 102
  .amdhsa_accum_offset 256
  .amdhsa_group_segment_fixed_size 0
  .amdhsa_kernarg_size 80
  .amdhsa_user_sgpr_count 2
  .amdhsa_user_sgpr_kernarg_segment_ptr 1
  .amdhsa_system_sgpr_workgroup_id_x 1
  .amdhsa_float_denorm_mode_32 3
.end_amdhsa_kernel
.section .rodata,"a"
.p2align 12
.set zc0,16256
.set zc1,16256
.set zc2,16256
.set zc3,16256
.set zc4,16256
.set zc5,16255
.set zc6,16255
.set zc7,16255
.set zc8,16254
.set zc9,16254
.set zc10,16253
.set zc11,16253
.set zc12,16252
.set zc13,16252
.set zc14,16251
.set zc15,16250
.set zc16,16250
.set zc17,16249
.set zc18,16248
.set zc19,16247
.set zc20,16246
.set zc21,16245
.set zc22,16244
.set zc23,16243
.set zc24,16242
.set zc25,16240
.set zc26,16239
.set zc27,16238
.set zc28,16237
.set zc29,16235
.set zc30,16234
.set zc31,16232
.set zc32,16231
.set zc33,16229
.set zc34,16227
.set zc35,16226
.set zc36,16224
.set zc37,16222
.set zc38,16220
.set zc39,16219
.set zc40,16217
.set zc41,16215
.set zc42,16213
.set zc43,16211
.set zc44,16209
.set zc45,16207
.set zc46,16205
.set zc47,16202
.set zc48,16200
.set zc49,16198
.set zc50,16196
.set zc51,16193
.set zc52,16191
.set zc53,16188
.set zc54,16186
.set zc55,16184
.set zc56,16181
.set zc57,16178
.set zc58,16176
.set zc59,16173
.set zc60,16171
.set zc61,16168
.set zc62,16165
.set zc63,16162
.set zc64,16160
.set zc65,16157
.set zc66,16154
.set zc67,16151
.set zc68,16148
.set zc69,16145
.set zc70,16142
.set zc71,16139
.set zc72,16136
.set zc73,16133
.set zc74,16130
.set zc75,16126
.set zc76,16120
.set zc77,16113
.set zc78,16107
.set zc79,16101
.set zc80,16094
.set zc81,16088
.set zc82,16081
.set zc83,16075
.set zc84,16068
.set zc85,16061
.set zc86,16055
.set zc87,16048
.set zc88,16041
.set zc89,16034
.set zc90,16027
.set zc91,16021
.set zc92,16014
.set zc93,16007
.set zc94,16000
.set zc95,15986
.set zc96,15972
.set zc97,15958
.set zc98,15944
.set zc99,15930
.set zc100,15916
.set zc101,15901
.set zc102,15887
.set zc103,15873
.set zc104,15845
.set zc105,15817
.set zc106,15788
.set zc107,15759
.set zc108,15718
.set zc109,15660
.set zc110,15590
.set zc111,15462
.set zc112,0
.set zc113,48230
.set zc114,48358
.set zc115,48428
.set zc116,48486
.set zc117,48527
.set zc118,48556
.set zc119,48585
.set zc120,48613
.set zc121,48641
.set zc122,48655
.set zc123,48669
.set zc124,48684
.set zc125,48698
.set zc126,48712
.set zc127,48726
.set zc128,48740
.set zc129,48754
.set zc130,48768
.set zc131,48775
.set zc132,48782
.set zc133,48789
.set zc134,48795
.set zc135,48802
.set zc136,48809
.set zc137,48816
.set zc138,48823
.set zc139,48829
.set zc140,48836
.set zc141,48843
.set zc142,48849
.set zc143,48856
.set zc144,48862
.set zc145,48869
.set zc146,48875
.set zc147,48881
.set zc148,48888
.set zc149,48894
.set zc150,48898
.set zc151,48901
.set zc152,48904
.set zc153,48907
.set zc154,48910
.set zc155,48913
.set zc156,48916
.set zc157,48919
.set zc158,48922
.set zc159,48925
.set zc160,48928
.set zc161,48930
.set zc162,48933
.set zc163,48936
.set zc164,48939
.set zc165,48941
.set zc166,48944
.set zc167,48946
.set zc168,48949
.set zc169,48952
.set zc170,48954
.set zc171,48956
.set zc172,48959
.set zc173,48961
.set zc174,48964
.set zc175,48966
.set zc176,48968
.set zc177,48970
.set zc178,48973
.set zc179,48975
.set zc180,48977
.set zc181,48979
.set zc182,48981
.set zc183,48983
.set zc184,48985
.set zc185,48987
.set zc186,48988
.set zc187,48990
.set zc188,48992
.set zc189,48994
.set zc190,48995
.set zc191,48997
.set zc192,48999
.set zc193,49000
.set zc194,49002
.set zc195,49003
.set zc196,49005
.set zc197,49006
.set zc198,49007
.set zc199,49008
.set zc200,49010
.set zc201,49011
.set zc202,49012
.set zc203,49013
.set zc204,49014
.set zc205,49015
.set zc206,49016
.set zc207,49017
.set zc208,49018
.set zc209,49018
.set zc210,49019
.set zc211,49020
.set zc212,49020
.set zc213,49021
.set zc214,49021
.set zc215,49022
.set zc216,49022
.set zc217,49023
.set zc218,49023
.set zc219,49023
.set zc220,49024
.set zc221,49024
.set zc222,49024
.set zc223,49024
.set zc224,49024
.set zc225,49024
.set zc226,49024
.set zc227,49024
.set zc228,49024
.set zc229,49023
.set zc230,49023
.set zc231,49023
.set zc232,49022
.set zc233,49022
.set zc234,49021
.set zc235,49021
.set zc236,49020
.set zc237,49020
.set zc238,49019
.set zc239,49018
.set zc240,49018
.set zc241,49017
.set zc242,49016
.set zc243,49015
.set zc244,49014
.set zc245,49013
.set zc246,49012
.set zc247,49011
.set zc248,49010
.set zc249,49008
.set zc250,49007
.set zc251,49006
.set zc252,49005
.set zc253,49003
.set zc254,49002
.set zc255,49000
.set zc256,48999
.set zc257,48997
.set zc258,48995
.set zc259,48994
.set zc260,48992
.set zc261,48990
.set zc262,48988
.set zc263,48987
.set zc264,48985
.set zc265,48983
.set zc266,48981
.set zc267,48979
.set zc268,48977
.set zc269,48975
.set zc270,48973
.set zc271,48970
.set zc272,48968
.set zc273,48966
.set zc274,48964
.set zc275,48961
.set zc276,48959
.set zc277,48956
.set zc278,48954
.set zc279,48952
.set zc280,48949
.set zc281,48946
.set zc282,48944
.set zc283,48941
.set zc284,48939
.set zc285,48936
.set zc286,48933
.set zc287,48930
.set zc288,48928
.set zc289,48925
.set zc290,48922
.set zc291,48919
.set zc292,48916
.set zc293,48913
.set zc294,48910
.set zc295,48907
.set zc296,48904
.set zc297,48901
.set zc298,48898
.set zc299,48894
.set zc300,48888
.set zc301,48881
.set zc302,48875
.set zc303,48869
.set zc304,48862
.set zc305,48856
.set zc306,48849
.set zc307,48843
.set zc308,48836
.set zc309,48829
.set zc310,48823
.set zc311,48816
.set zc312,48809
.set zc313,48802
.set zc314,48795
.set zc315,48789
.set zc316,48782
.set zc317,48775
.set zc318,48768
.set zc319,48754
.set zc320,48740
.set zc321,48726
.set zc322,48712
.set zc323,48698
.set zc324,48684
.set zc325,48669
.set zc326,48655
.set zc327,48641
.set zc328,48613
.set zc329,48585
.set zc330,48556
.set zc331,48527
.set zc332,48486
.set zc333,48428
.set zc334,48358
.set zc335,48230
.set zc336,0
.set zc337,15462
.set zc338,15590
.set zc339,15660
.set zc340,15718
.set zc341,15759
.set zc342,15788
.set zc343,15817
.set zc344,15845
.set zc345,15873
.set zc346,15887
.set zc347,15901
.set zc348,15916
.set zc349,15930
.set zc350,15944
.set zc351,15958
.set zc352,15972
.set zc353,15986
.set zc354,16000
.set zc355,16007
.set zc356,16014
.set zc357,16021
.set zc358,16027
.set zc359,16034
.set zc360,16041
.set zc361,16048
.set zc362,16055
.set zc363,16061
.set zc364,16068
.set zc365,16075
.set zc366,16081
.set zc367,16088
.set zc368,16094
.set zc369,16101
.set zc370,16107
.set zc371,16113
.set zc372,16120
.set zc373,16126
.set zc374,16130
.set zc375,16133
.set zc376,16136
.set zc377,16139
.set zc378,16142
.set zc379,16145
.set zc380,16148
.set zc381,16151
.set zc382,16154
.set zc383,16157
.set zc384,16160
.set zc385,16162
.set zc386,16165
.set zc387,16168
.set zc388,16171
.set zc389,16173
.set zc390,16176
.set zc391,16178
.set zc392,16181
.set zc393,16184
.set zc394,16186
.set zc395,16188
.set zc396,16191
.set zc397,16193
.set zc398,16196
.set zc399,16198
.set zc400,16200
.set zc401,16202
.set zc402,16205
.set zc403,16207
.set zc404,16209
.set zc405,16211
.set zc406,16213
.set zc407,16215
.set zc408,16217
.set zc409,16219
.set zc410,16220
.set zc411,16222
.set zc412,16224
.set zc413,16226
.set zc414,16227
.set zc415,16229
.set zc416,16231
.set zc417,16232
.set zc418,16234
.set zc419,16235
.set zc420,16237
.set zc421,16238
.set zc422,16239
.set zc423,16240
.set zc424,16242
.set zc425,16243
.set zc426,16244
.set zc427,16245
.set zc428,16246
.set zc429,16247
.set zc430,16248
.set zc431,16249
.set zc432,16250
.set zc433,16250
.set zc434,16251
.set zc435,16252
.set zc436,16252
.set zc437,16253
.set zc438,16253
.set zc439,16254
.set zc440,16254
.set zc441,16255
.set zc442,16255
.set zc443,16255
.set zc444,16256
.set zc445,16256
.set zc446,16256
.set zc447,16256
.set zn0,0
.set zn1,48230
.set zn2,48358
.set zn3,48428
.set zn4,48486
.set zn5,48527
.set zn6,48556
.set zn7,48585
.set zn8,48613
.set zn9,48641
.set zn10,48655
.set zn11,48669
.set zn12,48684
.set zn13,48698
.set zn14,48712
.set zn15,48726
.set zn16,48740
.set zn17,48754
.set zn18,48768
.set zn19,48775
.set zn20,48782
.set zn21,48789
.set zn22,48795
.set zn23,48802
.set zn24,48809
.set zn25,48816
.set zn26,48823
.set zn27,48829
.set zn28,48836
.set zn29,48843
.set zn30,48849
.set zn31,48856
.set zn32,48862
.set zn33,48869
.set zn34,48875
.set zn35,48881
.set zn36,48888
.set zn37,48894
.set zn38,48898
.set zn39,48901
.set zn40,48904
.set zn41,48907
.set zn42,48910
.set zn43,48913
.set zn44,48916
.set zn45,48919
.set zn46,48922
.set zn47,48925
.set zn48,48928
.set zn49,48930
.set zn50,48933
.set zn51,48936
.set zn52,48939
.set zn53,48941
.set zn54,48944
.set zn55,48946
.set zn56,48949
.set zn57,48952
.set zn58,48954
.set zn59,48956
.set zn60,48959
.set zn61,48961
.set zn62,48964
.set zn63,48966
.set zn64,48968
.set zn65,48970
.set zn66,48973
.set zn67,48975
.set zn68,48977
.set zn69,48979
.set zn70,48981
.set zn71,48983
.set zn72,48985
.set zn73,48987
.set zn74,48988
.set zn75,48990
.set zn76,48992
.set zn77,48994
.set zn78,48995
.set zn79,48997
.set zn80,48999
.set zn81,49000
.set zn82,49002
.set zn83,49003
.set zn84,49005
.set zn85,49006
.set zn86,49007
.set zn87,49008
.set zn88,49010
.set zn89,49011
.set zn90,49012
.set zn91,49013
.set zn92,49014
.set zn93,49015
.set zn94,49016
.set zn95,49017
.set zn96,49018
.set zn97,49018
.set zn98,49019
.set zn99,49020
.set zn100,49020
.set zn101,49021
.set zn102,49021
.set zn103,49022
.set zn104,49022
.set zn105,49023
.set zn106,49023
.set zn107,49023
.set zn108,49024
.set zn109,49024
.set zn110,49024
.set zn111,49024
.set zn112,49024
.set zn113,49024
.set zn114,49024
.set zn115,49024
.set zn116,49024
.set zn117,49023
.set zn118,49023
.set zn119,49023
.set zn120,49022
.set zn121,49022
.set zn122,49021
.set zn123,49021
.set zn124,49020
.set zn125,49020
.set zn126,49019
.set zn127,49018
.set zn128,49018
.set zn129,49017
.set zn130,49016
.set zn131,49015
.set zn132,49014
.set zn133,49013
.set zn134,49012
.set zn135,49011
.set zn136,49010
.set zn137,49008
.set zn138,49007
.set zn139,49006
.set zn140,49005
.set zn141,49003
.set zn142,49002
.set zn143,49000
.set zn144,48999
.set zn145,48997
.set zn146,48995
.set zn147,48994
.set zn148,48992
.set zn149,48990
.set zn150,48988
.set zn151,48987
.set zn152,48985
.set zn153,48983
.set zn154,48981
.set zn155,48979
.set zn156,48977
.set zn157,48975
.set zn158,48973
.set zn159,48970
.set zn160,48968
.set zn161,48966
.set zn162,48964
.set zn163,48961
.set zn164,48959
.set zn165,48956
.set zn166,48954
.set zn167,48952
.set zn168,48949
.set zn169,48946
.set zn170,48944
.set zn171,48941
.set zn172,48939
.set zn173,48936
.set zn174,48933
.set zn175,48930
.set zn176,48928
.set zn177,48925
.set zn178,48922
.set zn179,48919
.set zn180,48916
.set zn181,48913
.set zn182,48910
.set zn183,48907
.set zn184,48904
.set zn185,48901
.set zn186,48898
.set zn187,48894
.set zn188,48888
.set zn189,48881
.set zn190,48875
.set zn191,48869
.set zn192,48862
.set zn193,48856
.set zn194,48849
.set zn195,48843
.set zn196,48836
.set zn197,48829
.set zn198,48823
.set zn199,48816
.set zn200,48809
.set zn201,48802
.set zn202,48795
.set zn203,48789
.set zn204,48782
.set zn205,48775
.set zn206,48768
.set zn207,48754
.set zn208,48740
.set zn209,48726
.set zn210,48712
.set zn211,48698
.set zn212,48684
.set zn213,48669
.set zn214,48655
.set zn215,48641
.set zn216,48613
.set zn217,48585
.set zn218,48556
.set zn219,48527
.set zn220,48486
.set zn221,48428
.set zn222,48358
.set zn223,48230
.set zn224,0
.set zn225,15462
.set zn226,15590
.set zn227,15660
.set zn228,15718
.set zn229,15759
.set zn230,15788
.set zn231,15817
.set zn232,15845
.set zn233,15873
.set zn234,15887
.set zn235,15901
.set zn236,15916
.set zn237,15930
.set zn238,15944
.set zn239,15958
.set zn240,15972
.set zn241,15986
.set zn242,16000
.set zn243,16007
.set zn244,16014
.set zn245,16021
.set zn246,16027
.set zn247,16034
.set zn248,16041
.set zn249,16048
.set zn250,16055
.set zn251,16061
.set zn252,16068
.set zn253,16075
.set zn254,16081
.set zn255,16088
.set zn256,16094
.set zn257,16101
.set zn258,16107
.set zn259,16113
.set zn260,16120
.set zn261,16126
.set zn262,16130
.set zn263,16133
.set zn264,16136
.set zn265,16139
.set zn266,16142
.set zn267,16145
.set zn268,16148
.set zn269,16151
.set zn270,16154
.set zn271,16157
.set zn272,16160
.set zn273,16162
.set zn274,16165
.set zn275,16168
.set zn276,16171
.set zn277,16173
.set zn278,16176
.set zn279,16178
.set zn280,16181
.set zn281,16184
.set zn282,16186
.set zn283,16188
.set zn284,16191
.set zn285,16193
.set zn286,16196
.set zn287,16198
.set zn288,16200
.set zn289,16202
.set zn290,16205
.set zn291,16207
.set zn292,16209
.set zn293,16211
.set zn294,16213
.set zn295,16215
.set zn296,16217
.set zn297,16219
.set zn298,16220
.set zn299,16222
.set zn300,16224
.set zn301,16226
.set zn302,16227
.set zn303,16229
.set zn304,16231
.set zn305,16232
.set zn306,16234
.set zn307,16235
.set zn308,16237
.set zn309,16238
.set zn310,16239
.set zn311,16240
.set zn312,16242
.set zn313,16243
.set zn314,16244
.set zn315,16245
.set zn316,16246
.set zn317,16247
.set zn318,16248
.set zn319,16249
.set zn320,16250
.set zn321,16250
.set zn322,16251
.set zn323,16252
.set zn324,16252
.set zn325,16253
.set zn326,16253
.set zn327,16254
.set zn328,16254
.set zn329,16255
.set zn330,16255
.set zn331,16255
.set zn332,16256
.set zn333,16256
.set zn334,16256
.set zn335,16256
.set zn336,16256
.set zn337,16256
.set zn338,16256
.set zn339,16256
.set zn340,16256
.set zn341,16255
.set zn342,16255
.set zn343,16255
.set zn344,16254
.set zn345,16254
.set zn346,16253
.set zn347,16253
.set zn348,16252
.set zn349,16252
.set zn350,16251
.set zn351,16250
.set zn352,16250
.set zn353,16249
.set zn354,16248
.set zn355,16247
.set zn356,16246
.set zn357,16245
.set zn358,16244
.set zn359,16243
.set zn360,16242
.set zn361,16240
.set zn362,16239
.set zn363,16238
.set zn364,16237
.set zn365,16235
.set zn366,16234
.set zn367,16232
.set zn368,16231
.set zn369,16229
.set zn370,16227
.set zn371,16226
.set zn372,16224
.set zn373,16222
.set zn374,16220
.set zn375,16219
.set zn376,16217
.set zn377,16215
.set zn378,16213
.set zn379,16211
.set zn380,16209
.set zn381,16207
.set zn382,16205
.set zn383,16202
.set zn384,16200
.set zn385,16198
.set zn386,16196
.set zn387,16193
.set zn388,16191
.set zn389,16188
.set zn390,16186
.set zn391,16184
.set zn392,16181
.set zn393,16178
.set zn394,16176
.set zn395,16173
.set zn396,16171
.set zn397,16168
.set zn398,16165
.set zn399,16162
.set zn400,16160
.set zn401,16157
.set zn402,16154
.set zn403,16151
.set zn404,16148
.set zn405,16145
.set zn406,16142
.set zn407,16139
.set zn408,16136
.set zn409,16133
.set zn410,16130
.set zn411,16126
.set zn412,16120
.set zn413,16113
.set zn414,16107
.set zn415,16101
.set zn416,16094
.set zn417,16088
.set zn418,16081
.set zn419,16075
.set zn420,16068
.set zn421,16061
.set zn422,16055
.set zn423,16048
.set zn424,16041
.set zn425,16034
.set zn426,16027
.set zn427,16021
.set zn428,16014
.set zn429,16007
.set zn430,16000
.set zn431,15986
.set zn432,15972
.set zn433,15958
.set zn434,15944
.set zn435,15930
.set zn436,15916
.set zn437,15901
.set zn438,15887
.set zn439,15873
.set zn440,15845
.set zn441,15817
.set zn442,15788
.set zn443,15759
.set zn444,15718
.set zn445,15660
.set zn446,15590
.set zn447,15462
.set zC0,13842
.set zC1,13842
.set zC2,13842
.set zC3,13842
.set zC4,13842
.set zC5,13842
.set zC6,13842
.set zC7,13842
.set zC8,13841
.set zC9,13841
.set zC10,13841
.set zC11,13841
.set zC12,13840
.set zC13,13840
.set zC14,13839
.set zC15,13839
.set zC16,13839
.set zC17,13838
.set zC18,13838
.set zC19,13837
.set zC20,13837
.set zC21,13836
.set zC22,13835
.set zC23,13835
.set zC24,13834
.set zC25,13833
.set zC26,13833
.set zC27,13832
.set zC28,13831
.set zC29,13830
.set zC30,13830
.set zC31,13829
.set zC32,13828
.set zC33,13827
.set zC34,13826
.set zC35,13825
.set zC36,13824
.set zC37,13822
.set zC38,13820
.set zC39,13818
.set zC40,13816
.set zC41,13814
.set zC42,13811
.set zC43,13809
.set zC44,13807
.set zC45,13804
.set zC46,13802
.set zC47,13799
.set zC48,13797
.set zC49,13794
.set zC50,13792
.set zC51,13789
.set zC52,13786
.set zC53,13783
.set zC54,13781
.set zC55,13778
.set zC56,13775
.set zC57,13772
.set zC58,13769
.set zC59,13766
.set zC60,13763
.set zC61,13760
.set zC62,13757
.set zC63,13754
.set zC64,13750
.set zC65,13747
.set zC66,13744
.set zC67,13741
.set zC68,13737
.set zC69,13734
.set zC70,13731
.set zC71,13727
.set zC72,13724
.set zC73,13720
.set zC74,13717
.set zC75,13713
.set zC76,13710
.set zC77,13706
.set zC78,13702
.set zC79,13699
.set zC80,13694
.set zC81,13686
.set zC82,13679
.set zC83,13671
.set zC84,13664
.set zC85,13656
.set zC86,13649
.set zC87,13641
.set zC88,13633
.set zC89,13625
.set zC90,13618
.set zC91,13610
.set zC92,13602
.set zC93,13594
.set zC94,13586
.set zC95,13578
.set zC96,13570
.set zC97,13556
.set zC98,13540
.set zC99,13524
.set zC100,13508
.set zC101,13492
.set zC102,13476
.set zC103,13459
.set zC104,13443
.set zC105,13413
.set zC106,13381
.set zC107,13348
.set zC108,13315
.set zC109,13253
.set zC110,13187
.set zC111,13059
.set zC112,0
.set zC113,45827
.set zC114,45955
.set zC115,46021
.set zC116,46083
.set zC117,46116
.set zC118,46149
.set zC119,46181
.set zC120,46211
.set zC121,46227
.set zC122,46244
.set zC123,46260
.set zC124,46276
.set zC125,46292
.set zC126,46308
.set zC127,46324
.set zC128,46338
.set zC129,46346
.set zC130,46354
.set zC131,46362
.set zC132,46370
.set zC133,46378
.set zC134,46386
.set zC135,46393
.set zC136,46401
.set zC137,46409
.set zC138,46417
.set zC139,46424
.set zC140,46432
.set zC141,46439
.set zC142,46447
.set zC143,46454
.set zC144,46462
.set zC145,46467
.set zC146,46470
.set zC147,46474
.set zC148,46478
.set zC149,46481
.set zC150,46485
.set zC151,46488
.set zC152,46492
.set zC153,46495
.set zC154,46499
.set zC155,46502
.set zC156,46505
.set zC157,46509
.set zC158,46512
.set zC159,46515
.set zC160,46518
.set zC161,46522
.set zC162,46525
.set zC163,46528
.set zC164,46531
.set zC165,46534
.set zC166,46537
.set zC167,46540
.set zC168,46543
.set zC169,46546
.set zC170,46549
.set zC171,46551
.set zC172,46554
.set zC173,46557
.set zC174,46560
.set zC175,46562
.set zC176,46565
.set zC177,46567
.set zC178,46570
.set zC179,46572
.set zC180,46575
.set zC181,46577
.set zC182,46579
.set zC183,46582
.set zC184,46584
.set zC185,46586
.set zC186,46588
.set zC187,46590
.set zC188,46592
.set zC189,46593
.set zC190,46594
.set zC191,46595
.set zC192,46596
.set zC193,46597
.set zC194,46598
.set zC195,46598
.set zC196,46599
.set zC197,46600
.set zC198,46601
.set zC199,46601
.set zC200,46602
.set zC201,46603
.set zC202,46603
.set zC203,46604
.set zC204,46605
.set zC205,46605
.set zC206,46606
.set zC207,46606
.set zC208,46607
.set zC209,46607
.set zC210,46607
.set zC211,46608
.set zC212,46608
.set zC213,46609
.set zC214,46609
.set zC215,46609
.set zC216,46609
.set zC217,46610
.set zC218,46610
.set zC219,46610
.set zC220,46610
.set zC221,46610
.set zC222,46610
.set zC223,46610
.set zC224,46610
.set zC225,46610
.set zC226,46610
.set zC227,46610
.set zC228,46610
.set zC229,46610
.set zC230,46610
.set zC231,46610
.set zC232,46609
.set zC233,46609
.set zC234,46609
.set zC235,46609
.set zC236,46608
.set zC237,46608
.set zC238,46607
.set zC239,46607
.set zC240,46607
.set zC241,46606
.set zC242,46606
.set zC243,46605
.set zC244,46605
.set zC245,46604
.set zC246,46603
.set zC247,46603
.set zC248,46602
.set zC249,46601
.set zC250,46601
.set zC251,46600
.set zC252,46599
.set zC253,46598
.set zC254,46598
.set zC255,46597
.set zC256,46596
.set zC257,46595
.set zC258,46594
.set zC259,46593
.set zC260,46592
.set zC261,46590
.set zC262,46588
.set zC263,46586
.set zC264,46584
.set zC265,46582
.set zC266,46579
.set zC267,46577
.set zC268,46575
.set zC269,46572
.set zC270,46570
.set zC271,46567
.set zC272,46565
.set zC273,46562
.set zC274,46560
.set zC275,46557
.set zC276,46554
.set zC277,46551
.set zC278,46549
.set zC279,46546
.set zC280,46543
.set zC281,46540
.set zC282,46537
.set zC283,46534
.set zC284,46531
.set zC285,46528
.set zC286,46525
.set zC287,46522
.set zC288,46518
.set zC289,46515
.set zC290,46512
.set zC291,46509
.set zC292,46505
.set zC293,46502
.set zC294,46499
.set zC295,46495
.set zC296,46492
.set zC297,46488
.set zC298,46485
.set zC299,46481
.set zC300,46478
.set zC301,46474
.set zC302,46470
.set zC303,46467
.set zC304,46462
.set zC305,46454
.set zC306,46447
.set zC307,46439
.set zC308,46432
.set zC309,46424
.set zC310,46417
.set zC311,46409
.set zC312,46401
.set zC313,46393
.set zC314,46386
.set zC315,46378
.set zC316,46370
.set zC317,46362
.set zC318,46354
.set zC319,46346
.set zC320,46338
.set zC321,46324
.set zC322,46308
.set zC323,46292
.set zC324,46276
.set zC325,46260
.set zC326,46244
.set zC327,46227
.set zC328,46211
.set zC329,46181
.set zC330,46149
.set zC331,46116
.set zC332,46083
.set zC333,46021
.set zC334,45955
.set zC335,45827
.set zC336,0
.set zC337,13059
.set zC338,13187
.set zC339,13253
.set zC340,13315
.set zC341,13348
.set zC342,13381
.set zC343,13413
.set zC344,13443
.set zC345,13459
.set zC346,13476
.set zC347,13492
.set zC348,13508
.set zC349,13524
.set zC350,13540
.set zC351,13556
.set zC352,13570
.set zC353,13578
.set zC354,13586
.set zC355,13594
.set zC356,13602
.set zC357,13610
.set zC358,13618
.set zC359,13625
.set zC360,13633
.set zC361,13641
.set zC362,13649
.set zC363,13656
.set zC364,13664
.set zC365,13671
.set zC366,13679
.set zC367,13686
.set zC368,13694
.set zC369,13699
.set zC370,13702
.set zC371,13706
.set zC372,13710
.set zC373,13713
.set zC374,13717
.set zC375,13720
.set zC376,13724
.set zC377,13727
.set zC378,13731
.set zC379,13734
.set zC380,13737
.set zC381,13741
.set zC382,13744
.set zC383,13747
.set zC384,13750
.set zC385,13754
.set zC386,13757
.set zC387,13760
.set zC388,13763
.set zC389,13766
.set zC390,13769
.set zC391,13772
.set zC392,13775
.set zC393,13778
.set zC394,13781
.set zC395,13783
.set zC396,13786
.set zC397,13789
.set zC398,13792
.set zC399,13794
.set zC400,13797
.set zC401,13799
.set zC402,13802
.set zC403,13804
.set zC404,13807
.set zC405,13809
.set zC406,13811
.set zC407,13814
.set zC408,13816
.set zC409,13818
.set zC410,13820
.set zC411,13822
.set zC412,13824
.set zC413,13825
.set zC414,13826
.set zC415,13827
.set zC416,13828
.set zC417,13829
.set zC418,13830
.set zC419,13830
.set zC420,13831
.set zC421,13832
.set zC422,13833
.set zC423,13833
.set zC424,13834
.set zC425,13835
.set zC426,13835
.set zC427,13836
.set zC428,13837
.set zC429,13837
.set zC430,13838
.set zC431,13838
.set zC432,13839
.set zC433,13839
.set zC434,13839
.set zC435,13840
.set zC436,13840
.set zC437,13841
.set zC438,13841
.set zC439,13841
.set zC440,13841
.set zC441,13842
.set zC442,13842
.set zC443,13842
.set zC444,13842
.set zC445,13842
.set zC446,13842
.set zC447,13842
.set zN0,0
.set zN1,45827
.set zN2,45955
.set zN3,46021
.set zN4,46083
.set zN5,46116
.set zN6,46149
.set zN7,46181
.set zN8,46211
.set zN9,46227
.set zN10,46244
.set zN11,46260
.set zN12,46276
.set zN13,46292
.set zN14,46308
.set zN15,46324
.set zN16,46338
.set zN17,46346
.set zN18,46354
.set zN19,46362
.set zN20,46370
.set zN21,46378
.set zN22,46386
.set zN23,46393
.set zN24,46401
.set zN25,46409
.set zN26,46417
.set zN27,46424
.set zN28,46432
.set zN29,46439
.set zN30,46447
.set zN31,46454
.set zN32,46462
.set zN33,46467
.set zN34,46470
.set zN35,46474
.set zN36,46478
.set zN37,46481
.set zN38,46485
.set zN39,46488
.set zN40,46492
.set zN41,46495
.set zN42,46499
.set zN43,46502
.set zN44,46505
.set zN45,46509
.set zN46,46512
.set zN47,46515
.set zN48,46518
.set zN49,46522
.set zN50,46525
.set zN51,46528
.set zN52,46531
.set zN53,46534
.set zN54,46537
.set zN55,46540
.set zN56,46543
.set zN57,46546
.set zN58,46549
.set zN59,46551
.set zN60,46554
.set zN61,46557
.set zN62,46560
.set zN63,46562
.set zN64,46565
.set zN65,46567
.set zN66,46570
.set zN67,46572
.set zN68,46575
.set zN69,46577
.set zN70,46579
.set zN71,46582
.set zN72,46584
.set zN73,46586
.set zN74,46588
.set zN75,46590
.set zN76,46592
.set zN77,46593
.set zN78,46594
.set zN79,46595
.set zN80,46596
.set zN81,46597
.set zN82,46598
.set zN83,46598
.set zN84,46599
.set zN85,46600
.set zN86,46601
.set zN87,46601
.set zN88,46602
.set zN89,46603
.set zN90,46603
.set zN91,46604
.set zN92,46605
.set zN93,46605
.set zN94,46606
.set zN95,46606
.set zN96,46607
.set zN97,46607
.set zN98,46607
.set zN99,46608
.set zN100,46608
.set zN101,46609
.set zN102,46609
.set zN103,46609
.set zN104,46609
.set zN105,46610
.set zN106,46610
.set zN107,46610
.set zN108,46610
.set zN109,46610
.set zN110,46610
.set zN111,46610
.set zN112,46610
.set zN113,46610
.set zN114,46610
.set zN115,46610
.set zN116,46610
.set zN117,46610
.set zN118,46610
.set zN119,46610
.set zN120,46609
.set zN121,46609
.set zN122,46609
.set zN123,46609
.set zN124,46608
.set zN125,46608
.set zN126,46607
.set zN127,46607
.set zN128,46607
.set zN129,46606
.set zN130,46606
.set zN131,46605
.set zN132,46605
.set zN133,46604
.set zN134,46603
.set zN135,46603
.set zN136,46602
.set zN137,46601
.set zN138,46601
.set zN139,46600
.set zN140,46599
.set zN141,46598
.set zN142,46598
.set zN143,46597
.set zN144,46596
.set zN145,46595
.set zN146,46594
.set zN147,46593
.set zN148,46592
.set zN149,46590
.set zN150,46588
.set zN151,46586
.set zN152,46584
.set zN153,46582
.set zN154,46579
.set zN155,46577
.set zN156,46575
.set zN157,46572
.set zN158,46570
.set zN159,46567
.set zN160,46565
.set zN161,46562
.set zN162,46560
.set zN163,46557
.set zN164,46554
.set zN165,46551
.set zN166,46549
.set zN167,46546
.set zN168,46543
.set zN169,46540
.set zN170,46537
.set zN171,46534
.set zN172,46531
.set zN173,46528
.set zN174,46525
.set zN175,46522
.set zN176,46518
.set zN177,46515
.set zN178,46512
.set zN179,46509
.set zN180,46505
.set zN181,46502
.set zN182,46499
.set zN183,46495
.set zN184,46492
.set zN185,46488
.set zN186,46485
.set zN187,46481
.set zN188,46478
.set zN189,46474
.set zN190,46470
.set zN191,46467
.set zN192,46462
.set zN193,46454
.set zN194,46447
.set zN195,46439
.set zN196,46432
.set zN197,46424
.set zN198,46417
.set zN199,46409
.set zN200,46401
.set zN201,46393
.set zN202,46386
.set zN203,46378
.set zN204,46370
.set zN205,46362
.set zN206,46354
.set zN207,46346
.set zN208,46338
.set zN209,46324
.set zN210,46308
.set zN211,46292
.set zN212,46276
.set zN213,46260
.set zN214,46244
.set zN215,46227
.set zN216,46211
.set zN217,46181
.set zN218,46149
.set zN219,46116
.set zN220,46083
.set zN221,46021
.set zN222,45955
.set zN223,45827
.set zN224,0
.set zN225,13059
.set zN226,13187
.set zN227,13253
.set zN228,13315
.set zN229,13348
.set zN230,13381
.set zN231,13413
.set zN232,13443
.set zN233,13459
.set zN234,13476
.set zN235,13492
.set zN236,13508
.set zN237,13524
.set zN238,13540
.set zN239,13556
.set zN240,13570
.set zN241,13578
.set zN242,13586
.set zN243,13594
.set zN244,13602
.set zN245,13610
.set zN246,13618
.set zN247,13625
.set zN248,13633
.set zN249,13641
.set zN250,13649
.set zN251,13656
.set zN252,13664
.set zN253,13671
.set zN254,13679
.set zN255,13686
.set zN256,13694
.set zN257,13699
.set zN258,13702
.set zN259,13706
.set zN260,13710
.set zN261,13713
.set zN262,13717
.set zN263,13720
.set zN264,13724
.set zN265,13727
.set zN266,13731
.set zN267,13734
.set zN268,13737
.set zN269,13741
.set zN270,13744
.set zN271,13747
.set zN272,13750
.set zN273,13754
.set zN274,13757
.set zN275,13760
.set zN276,13763
.set zN277,13766
.set zN278,13769
.set zN279,13772
.set zN280,13775
.set zN281,13778
.set zN282,13781
.set zN283,13783
.set zN284,13786
.set zN285,13789
.set zN286,13792
.set zN287,13794
.set zN288,13797
.set zN289,13799
.set zN290,13802
.set zN291,13804
.set zN292,13807
.set zN293,13809
.set zN294,13811
.set zN295,13814
.set zN296,13816
.set zN297,13818
.set zN298,13820
.set zN299,13822
.set zN300,13824
.set zN301,13825
.set zN302,13826
.set zN303,13827
.set zN304,13828
.set zN305,13829
.set zN306,13830
.set zN307,13830
.set zN308,13831
.set zN309,13832
.set zN310,13833
.set zN311,13833
.set zN312,13834
.set zN313,13835
.set zN314,13835
.set zN315,13836
.set zN316,13837
.set zN317,13837
.set zN318,13838
.set zN319,13838
.set zN320,13839
.set zN321,13839
.set zN322,13839
.set zN323,13840
.set zN324,13840
.set zN325,13841
.set zN326,13841
.set zN327,13841
.set zN328,13841
.set zN329,13842
.set zN330,13842
.set zN331,13842
.set zN332,13842
.set zN333,13842
.set zN334,13842
.set zN335,13842
.set zN336,13842
.set zN337,13842
.set zN338,13842
.set zN339,13842
.set zN340,13842
.set zN341,13842
.set zN342,13842
.set zN343,13842
.set zN344,13841
.set zN345,13841
.set zN346,13841
.set zN347,13841
.set zN348,13840
.set zN349,13840
.set zN350,13839
.set zN351,13839
.set zN352,13839
.set zN353,13838
.set zN354,13838
.set zN355,13837
.set zN356,13837
.set zN357,13836
.set zN358,13835
.set zN359,13835
.set zN360,13834
.set zN361,13833
.set zN362,13833
.set zN363,13832
.set zN364,13831
.set zN365,13830
.set zN366,13830
.set zN367,13829
.set zN368,13828
.set zN369,13827
.set zN370,13826
.set zN371,13825
.set zN372,13824
.set zN373,13822
.set zN374,13820
.set zN375,13818
.set zN376,13816
.set zN377,13814
.set zN378,13811
.set zN379,13809
.set zN380,13807
.set zN381,13804
.set zN382,13802
.set zN383,13799
.set zN384,13797
.set zN385,13794
.set zN386,13792
.set zN387,13789
.set zN388,13786
.set zN389,13783
.set zN390,13781
.set zN391,13778
.set zN392,13775
.set zN393,13772
.set zN394,13769
.set zN395,13766
.set zN396,13763
.set zN397,13760
.set zN398,13757
.set zN399,13754
.set zN400,13750
.set zN401,13747
.set zN402,13744
.set zN403,13741
.set zN404,13737
.set zN405,13734
.set zN406,13731
.set zN407,13727
.set zN408,13724
.set zN409,13720
.set zN410,13717
.set zN411,13713
.set zN412,13710
.set zN413,13706
.set zN414,13702
.set zN415,13699
.set zN416,13694
.set zN417,13686
.set zN418,13679
.set zN419,13671
.set zN420,13664
.set zN421,13656
.set zN422,13649
.set zN423,13641
.set zN424,13633
.set zN425,13625
.set zN426,13618
.set zN427,13610
.set zN428,13602
.set zN429,13594
.set zN430,13586
.set zN431,13578
.set zN432,13570
.set zN433,13556
.set zN434,13540
.set zN435,13524
.set zN436,13508
.set zN437,13492
.set zN438,13476
.set zN439,13459
.set zN440,13443
.set zN441,13413
.set zN442,13381
.set zN443,13348
.set zN444,13315
.set zN445,13253
.set zN446,13187
.set zN447,13059
.altmacro
.macro e4 p,a,b,c,d
.short z\p\()\a,z\p\()\b,z\p\()\c,z\p\()\d
.endm
.macro r8 p,d,k
e4 \p,%((\d*(\k))%448),%((\d*(\k+1))%448),%((\d*(\k+2))%448),%((\d*(\k+3))%448)
e4 \p,%((\d*(\k+4))%448),%((\d*(\k+5))%448),%((\d*(\k+6))%448),%((\d*(\k+7))%448)
.endm
.macro fg nt,n0
.set zk,8*\nt
.rept 8
r8 c,%zk,\n0
.set zk,zk+1
.endr
.set zk,8*\nt
.rept 8
r8 n,%zk,\n0
.set zk,zk+1
.endr
.endm
.macro fblk nt
.set zn,0
.rept 7
fg \nt,%(zn)
fg \nt,%(zn+8)
fg \nt,%(zn+16)
fg \nt,%(zn+24)
fg \nt,%(zn+32)
fg \nt,%(zn+40)
fg \nt,%(zn+48)
fg \nt,%(zn+56)
.set zn,zn+64
.endr
.endm
.macro i4 a,b,c,d
.short zC\a,zN\a,zC\b,zN\b,zC\c,zN\c,zC\d,zN\d
.endm
.macro irow k
.set zd,zb
.rept 32
i4 %((zd*(\k))%448),%((zd*(\k+1))%448),%((zd*(\k+2))%448),%((zd*(\k+3))%448)
.set zd,zd+1
.endr
.endm
.macro iblk g
.set zb,0
.rept 14
irow %(8*\g)
irow %(8*\g+4)
.set zb,zb+32
.endr
.endm
TABS:
.quad 0x3f803f803f803f80,0x3f803f803f803f80,0x3f803f803f803f80,0x3f7f3f7f3f7f3f80,0x3f7f3f803f803f80,0x3f7b3f7c3f7d3f7e,0x3f7e3f7f3f803f80,0x3f753f783f7a3f7c
.quad 0x3f7c3f7e3f803f80,0x3f6d3f723f763f7a,0x3f7a3f7d3f7f3f80,0x3f623f6a3f703f76,0x3f783f7c3f7f3f80,0x3f553f603f6a3f72,0x3f753f7b3f7f3f80,0x3f463f553f623f6d
.quad 0xbf803f80bf803f80,0xbf803f80bf803f80,0xbd2cbce6bc660000,0xbdc9bdacbd8fbd66,0xbdacbd66bce60000,0xbe48be2cbe0fbde5,0xbe01bdacbd2c0000,0xbe95be80be56be2c
.quad 0xbe2cbde5bd660000,0xbec4bea9be8ebe64,0xbe56be0fbd8f0000,0xbef1bed1beb0be8e,0xbe80be2cbdac0000,0xbf0ebef8bed1bea9,0xbe95be48bdc90000,0xbf22bf0ebef1bec4
.quad 0x3f803f803f803f80,0x3f803f803f803f80,0x3f7d3f7d3f7e3f7e,0x3f7a3f7b3f7c3f7c,0x3f743f763f783f7a,0x3f6a3f6d3f6f3f72,0x3f653f6a3f6e3f72,0x3f4f3f553f5b3f60
.quad 0x3f513f593f603f67,0x3f2b3f353f3f3f48,0x3f383f443f4f3f59,0x3efe3f0e3f1d3f2b,0x3f1a3f2b3f3a3f48,0x3e9b3ec43eeb3f08,0x3ef13f0e3f223f35,0x3dc93e483e953ec4
.quad 0xbf803f80bf803f80,0xbf803f80bf803f80,0xbe1dbe0fbe01bde5,0xbe56be48be3abe2c,0xbe9bbe8ebe80be64,0xbed1bec4beb7bea9,0xbee5bed1bebdbea9,0xbf17bf0ebf05bef8
.quad 0xbf14bf08bef8bede,0xbf3fbf35bf2bbf20,0xbf32bf25bf17bf08,0xbf5ebf55bf4abf3f,0xbf4dbf3fbf30bf20,0xbf74bf6dbf63bf59,0xbf62bf55bf46bf35,0xbf7fbf7bbf75bf6d
.quad 0x3f803f803f803f80,0x3f803f803f803f80,0x3f773f783f793f7a,0x3f733f743f753f76,0x3f5c3f603f633f67,0x3f4d3f513f553f59,0x3f323f3a3f413f48,0x3f113f1a3f223f2b
.quad 0x3ef83f083f143f20,0x3e8e3ea93ec43ede,0x3e723e9b3ebd3ede,0xbd2c3ce63dc93e2c,0xbce63d663e0f3e64,0xbeb7be8ebe48bde5,0xbe95be48bdc90000,0xbf22bf0ebef1bec4
.quad 0xbf803f80bf803f80,0xbf803f80bf803f80,0xbe87be80be72be64,0xbea2be9bbe95be8e,0xbf02bef8beebbede,0xbf1abf14bf0ebf08,0xbf38bf30bf28bf20,0xbf53bf4dbf46bf3f
.quad 0xbf60bf59bf51bf48,0xbf76bf72bf6dbf67,0xbf79bf74bf6ebf67,0xbf80bf80bf7fbf7c,0xbf80bf80bf7dbf7a,0xbf6fbf76bf7bbf7e,0xbf75bf7bbf7fbf80,0xbf46bf55bf62bf6d
.quad 0x3f803f803f803f80,0x3f803f803f803f80,0x3f6e3f6f3f703f72,0x3f683f6a3f6b3f6d,0x3f3a3f3f3f443f48,0x3f253f2b3f303f35,0x3ed83eeb3efe3f08,0x3e873e9b3eb03ec4
.quad 0x3d663de53e2c3e64,0xbe2cbde5bd660000,0xbea2be80be3abde5,0xbf11bf02bee5bec4,0xbf25bf14bf02bede,0xbf5cbf51bf44bf35,0xbf62bf55bf46bf35,0xbf7fbf7bbf75bf6d
.quad 0xbf803f80bf803f80,0xbf803f80bf803f80,0xbebdbeb7beb0bea9,0xbed8bed1becbbec4,0xbf30bf2bbf25bf20,0xbf44bf3fbf3abf35,0xbf68bf63bf5ebf59,0xbf77bf74bf70bf6d
.quad 0xbf80bf7ebf7cbf7a,0xbf7cbf7ebf80bf80,0xbf73bf78bf7cbf7e,0xbf53bf5cbf65bf6d,0xbf44bf51bf5cbf67,0xbf02bf14bf25bf35,0xbef1bf0ebf22bf35,0xbdc9be48be95bec4
.quad 0x3f803f803f803f80,0x3f803f803f803f80,0x3f623f633f653f67,0x3f5b3f5c3f5e3f60,0x3f0e3f143f1a3f20,0x3eeb3ef83f023f08,0x3dc93e0f3e3a3e64,0xbd8fbce63c663d66
.quad 0xbec4bea9be8ebe64,0xbf14bf08bef8bede,0xbf46bf3abf2dbf20,0xbf6bbf63bf5bbf51,0xbf7bbf76bf6fbf67,0xbf7dbf80bf80bf7e,0xbf75bf7bbf7fbf80,0xbf46bf55bf62bf6d
.quad 0xbf803f80bf803f80,0xbf803f80bf803f80,0xbef1beebbee5bede,0xbf05bf02befebef8,0xbf55bf51bf4dbf48,0xbf63bf60bf5cbf59,0xbf7fbf7dbf7cbf7a,0xbf7fbf80bf80bf80
.quad 0xbf6dbf72bf76bf7a,0xbf51bf59bf60bf67,0xbf22bf30bf3cbf48,0xbecbbeebbf05bf14,0xbe48be8ebeb7bede,0x3e0f3d66bce6bde5,0x3e953e483dc90000,0x3f223f0e3ef13ec4
.quad 0x3f803f803f803f80,0x3f803f803f803f80,0x3f533f553f573f59,0x3f4a3f4d3f4f3f51,0x3eb73ec43ed13ede,0x3e803e8e3e9b3ea9,0xbe72be48be1dbde5,0xbecbbeb7bea2be8e
.quad 0xbf3fbf35bf2bbf20,0xbf60bf59bf51bf48,0xbf7ebf7bbf77bf72,0xbf7dbf7fbf80bf80,0xbf63bf6dbf74bf7a,0xbf30bf3fbf4dbf59,0xbef1bf0ebf22bf35,0xbdc9be48be95bec4
.quad 0xbf803f80bf803f80,0xbf803f80bf803f80,0xbf11bf0ebf0bbf08,0xbf1dbf1abf17bf14,0xbf6fbf6dbf6abf67,0xbf78bf76bf74bf72,0xbf79bf7bbf7dbf7e,0xbf6bbf6fbf73bf76
.quad 0xbf2bbf35bf3fbf48,0xbef8bf08bf14bf20,0xbe01be48be87bea9,0x3e1d3dac3c66bd66,0x3eeb3ec43e9b3e64,0x3f3a3f2b3f1a3f08,0x3f623f553f463f35,0x3f7f3f7b3f753f6d
.quad 0x3f803f803f803f80,0x3f803f803f803f80,0x3f413f443f463f48,0x3f383f3a3f3c3f3f,0x3e0f3e2c3e483e64,0x3ce63d663dac3de5,0xbf0bbf02bef1bede,0xbf2dbf25bf1dbf14
.quad 0xbf76bf72bf6dbf67,0xbf80bf7ebf7cbf7a,0xbf68bf6fbf75bf7a,0xbf41bf4dbf57bf60,0xbed1bef8bf0ebf20,0xbdacbe2cbe80bea9,0x3e953e483dc90000,0x3f223f0e3ef13ec4
.quad 0xbf803f80bf803f80,0xbf803f80bf803f80,0xbf28bf25bf22bf20,0xbf32bf30bf2dbf2b,0xbf7dbf7cbf7bbf7a,0xbf80bf80bf7fbf7e,0xbf57bf5cbf62bf67,0xbf3cbf44bf4abf51
.quad 0xbe8ebea9bec4bede,0xbd66bde5be2cbe64,0x3ed83eb73e953e64,0x3f283f1a3f0b3ef8,0x3f6a3f603f553f48,0x3f7f3f7c3f783f72,0x3f753f7b3f7f3f80,0x3f463f553f623f6d
.quad 0x3f803f803f803f80,0x3f803f803f803f80,0x3f2d3f303f323f35,0x3f223f253f283f2b,0xbdacbd66bce60000,0xbe48be2cbe0fbde5,0xbf4abf44bf3cbf35,0xbf62bf5cbf57bf51
.quad 0xbf7cbf7ebf80bf80,0xbf6dbf72bf76bf7a,0xbf0bbf1abf28bf35,0xbe95beb7bed8bef8,0x3e803e2c3dac0000,0x3f0e3ef83ed13ea9,0x3f623f553f463f35,0x3f7f3f7b3f753f6d
.quad 0xbf803f80bf803f80,0xbf803f80bf803f80,0xbf3cbf3abf38bf35,0xbf46bf44bf41bf3f,0xbf7fbf80bf80bf80,0xbf7bbf7cbf7dbf7e,0xbf1dbf25bf2dbf35,0xbef1bf02bf0bbf14
.quad 0x3e2c3de53d660000,0x3ec43ea93e8e3e64,0x3f573f4d3f413f35,0x3f753f6f3f683f60,0x3f783f7c3f7f3f80,0x3f553f603f6a3f72,0x3ef13f0e3f223f35,0x3dc93e483e953ec4
.quad 0x3f803f803f803f80,0x3f803f803f803f80,0x3f173f1a3f1d3f20,0x3f0b3f0e3f113f14,0xbe9bbe8ebe80be64,0xbed1bec4beb7bea9,0xbf73bf6fbf6bbf67,0xbf7dbf7bbf79bf76
.quad 0xbf51bf59bf60bf67,0xbf2bbf35bf3fbf48,0xbc66bdacbe1dbe64,0x3e873e483e013d66,0x3f4d3f3f3f303f20,0x3f743f6d3f633f59,0x3f753f7b3f7f3f80,0x3f463f553f623f6d
.quad 0xbf803f80bf803f80,0xbf803f80bf803f80,0xbf4fbf4dbf4abf48,0xbf57bf55bf53bf51,0xbf74bf76bf78bf7a,0xbf6abf6dbf6fbf72,0xbea2beb7becbbede,0xbe1dbe48be72be8e
.quad 0x3f143f083ef83ede,0x3f3f3f353f2b3f20,0x3f803f7f3f7d3f7a,0x3f773f7b3f7e3f80,0x3f1a3f2b3f3a3f48,0x3e9b3ec43eeb3f08,0xbe95be48bdc90000,0xbf22bf0ebef1bec4
.quad 0x3f803f803f803f80,0x3f803f803f803f80,0x3efe3f023f053f08,0x3ee53eeb3ef13ef8,0xbf02bef8beebbede,0xbf1abf14bf0ebf08,0xbf80bf80bf7fbf7e,0xbf7cbf7dbf7fbf80
.quad 0xbef8bf08bf14bf20,0xbe8ebea9bec4bede,0x3f053eeb3ecb3ea9,0x3f3c3f303f223f14,0x3f803f803f7d3f7a,0x3f6f3f763f7b3f7e,0x3ef13f0e3f223f35,0x3dc93e483e953ec4
.quad 0xbf803f80bf803f80,0xbf803f80bf803f80,0xbf5ebf5cbf5bbf59,0xbf65bf63bf62bf60,0xbf5cbf60bf63bf67,0xbf4dbf51bf55bf59,0x3c66bce6bd8fbde5,0x3e3a3e0f3dc93d66
.quad 0x3f603f593f513f48,0x3f763f723f6d3f67,0x3f5b3f633f6b3f72,0x3f2d3f3a3f463f51,0xbce63d663e0f3e64,0xbeb7be8ebe48bde5,0xbf62bf55bf46bf35,0xbf7fbf7bbf75bf6d
.quad 0x3f803f803f803f80,0x3f803f803f803f80,0x3ecb3ed13ed83ede,0x3eb03eb73ebd3ec4,0xbf30bf2bbf25bf20,0xbf44bf3fbf3abf35,0xbf70bf74bf77bf7a,0xbf5ebf63bf68bf6d
.quad 0xbd66bde5be2cbe64,0x3e2c3de53d660000,0x3f653f5c3f533f48,0x3f7c3f783f733f6d,0x3f443f513f5c3f67,0x3f023f143f253f35,0xbe95be48bdc90000,0xbf22bf0ebef1bec4
.quad 0xbf803f80bf803f80,0xbf803f80bf803f80,0xbf6bbf6abf68bf67,0xbf70bf6fbf6ebf6d,0xbf3abf3fbf44bf48,0xbf25bf2bbf30bf35,0x3eb03e9b3e873e64,0x3efe3eeb3ed83ec4
.quad 0x3f803f7e3f7c3f7a,0x3f7c3f7e3f803f80,0x3ee53f023f113f20,0x3e3a3e803ea23ec4,0xbf25bf14bf02bede,0xbf5cbf51bf44bf35,0xbf75bf7bbf7fbf80,0xbf46bf55bf62bf6d
.quad 0x3f803f803f803f80,0x3f803f803f803f80,0x3e953e9b3ea23ea9,0x3e723e803e873e8e,0xbf55bf51bf4dbf48,0xbf63bf60bf5cbf59,0xbf46bf4dbf53bf59,0xbf28bf30bf38bf3f
.quad 0x3ec43ea93e8e3e64,0x3f143f083ef83ede,0x3f7f3f803f803f7e,0x3f6e3f743f793f7c,0x3e483e8e3eb73ede,0xbe0fbd663ce63de5,0xbf62bf55bf46bf35,0xbf7fbf7bbf75bf6d
.quad 0xbf803f80bf803f80,0xbf803f80bf803f80,0xbf75bf74bf73bf72,0xbf79bf78bf77bf76,0xbf0ebf14bf1abf20,0xbeebbef8bf02bf08,0x3f223f1a3f113f08,0x3f413f3a3f323f2b
.quad 0x3f6d3f723f763f7a,0x3f513f593f603f67,0xbdc9bce63d2c3de5,0xbebdbe9bbe72be2c,0xbf7bbf76bf6fbf67,0xbf7dbf80bf80bf7e,0xbef1bf0ebf22bf35,0xbdc9be48be95bec4
.quad 0x3f803f803f803f80,0x3f803f803f803f80,0x3e3a3e483e563e64,0x3e013e0f3e1d3e2c,0xbf6fbf6dbf6abf67,0xbf78bf76bf74bf72,0xbf05bf0ebf17bf20,0xbebdbed1bee5bef8
.quad 0x3f3f3f353f2b3f20,0x3f603f593f513f48,0x3f4a3f553f5e3f67,0x3f173f253f323f3f,0xbeebbec4be9bbe64,0xbf3abf2bbf1abf08,0xbf75bf7bbf7fbf80,0xbf46bf55bf62bf6d
.quad 0xbf803f80bf803f80,0xbf803f80bf803f80,0xbf7cbf7bbf7abf7a,0xbf7ebf7dbf7dbf7c,0xbeb7bec4bed1bede,0xbe80be8ebe9bbea9,0x3f5b3f553f4f3f48,0x3f6e3f6a3f653f60
.quad 0x3f2b3f353f3f3f48,0x3ef83f083f143f20,0xbf1dbf0ebefebede,0xbf4fbf44bf38bf2b,0xbf63bf6dbf74bf7a,0xbf30bf3fbf4dbf59,0x3e953e483dc90000,0x3f223f0e3ef13ec4
.quad 0x3f803f803f803f80,0x3f803f803f803f80,0x3d8f3dac3dc93de5,0x3c663ce63d2c3d66,0xbf7dbf7cbf7bbf7a,0xbf80bf80bf7fbf7e,0xbe56be80be95bea9,0xbd2cbdacbe01be2c
.quad 0x3f763f723f6d3f67,0x3f803f7e3f7c3f7a,0x3eb03ed13ef13f08,0x3d8f3e0f3e563e8e,0xbf6abf60bf55bf48,0xbf7fbf7cbf78bf72,0xbef1bf0ebf22bf35,0xbdc9be48be95bec4
.quad 0xbf803f80bf803f80,0xbf803f80bf803f80,0xbf7fbf7fbf7fbf7e,0xbf80bf80bf80bf80,0xbe0fbe2cbe48be64,0xbce6bd66bdacbde5,0x3f7a3f783f753f72,0x3f803f7f3f7e3f7c
.quad 0x3e8e3ea93ec43ede,0x3d663de53e2c3e64,0xbf70bf6abf62bf59,0xbf7fbf7dbf7abf76,0xbed1bef8bf0ebf20,0xbdacbe2cbe80bea9,0x3f623f553f463f35,0x3f7f3f7b3f753f6d
.quad 0x3f803f803f803f80,0x3f803f803f803f80,0xbd2cbce6bc660000,0xbdc9bdacbd8fbd66,0xbf7fbf80bf80bf80,0xbf7bbf7cbf7dbf7e,0x3e013dac3d2c0000,0x3e953e803e563e2c
.quad 0x3f7c3f7e3f803f80,0x3f6d3f723f763f7a,0xbe56be0fbd8f0000,0xbef1bed1beb0be8e,0xbf78bf7cbf7fbf80,0xbf55bf60bf6abf72,0x3e953e483dc90000,0x3f223f0e3ef13ec4
.quad 0xbf803f80bf803f80,0xbf803f80bf803f80,0xbf80bf80bf80bf80,0xbf7fbf7fbf7fbf80,0x3dac3d663ce60000,0x3e483e2c3e0f3de5,0x3f7e3f7f3f803f80,0x3f753f783f7a3f7c
.quad 0xbe2cbde5bd660000,0xbec4bea9be8ebe64,0xbf7abf7dbf7fbf80,0xbf62bf6abf70bf76,0x3e803e2c3dac0000,0x3f0e3ef83ed13ea9,0x3f753f7b3f7f3f80,0x3f463f553f623f6d
.quad 0x3f803f803f803f80,0x3f803f803f803f80,0xbe1dbe0fbe01bde5,0xbe56be48be3abe2c,0xbf74bf76bf78bf7a,0xbf6abf6dbf6fbf72,0x3ee53ed13ebd3ea9,0x3f173f0e3f053ef8
.quad 0x3f513f593f603f67,0x3f2b3f353f3f3f48,0xbf32bf25bf17bf08,0xbf5ebf55bf4abf3f,0xbf1abf2bbf3abf48,0xbe9bbec4beebbf08,0x3f623f553f463f35,0x3f7f3f7b3f753f6d
.quad 0xbf803f80bf803f80,0xbf803f80bf803f80,0xbf7dbf7dbf7ebf7e,0xbf7abf7bbf7cbf7c,0x3e9b3e8e3e803e64,0x3ed13ec43eb73ea9,0x3f653f6a3f6e3f72,0x3f4f3f553f5b3f60
.quad 0xbf14bf08bef8bede,0xbf3fbf35bf2bbf20,0xbf38bf44bf4fbf59,0xbefebf0ebf1dbf2b,0x3f4d3f3f3f303f20,0x3f743f6d3f633f59,0x3ef13f0e3f223f35,0x3dc93e483e953ec4
.quad 0x3f803f803f803f80,0x3f803f803f803f80,0xbe87be80be72be64,0xbea2be9bbe95be8e,0xbf5cbf60bf63bf67,0xbf4dbf51bf55bf59,0x3f383f303f283f20,0x3f533f4d3f463f3f
.quad 0x3ef83f083f143f20,0x3e8e3ea93ec43ede,0xbf79bf74bf6ebf67,0xbf80bf80bf7fbf7c,0x3ce6bd66be0fbe64,0x3eb73e8e3e483de5,0x3f753f7b3f7f3f80,0x3f463f553f623f6d
.quad 0xbf803f80bf803f80,0xbf803f80bf803f80,0xbf77bf78bf79bf7a,0xbf73bf74bf75bf76,0x3f023ef83eeb3ede,0x3f1a3f143f0e3f08,0x3f323f3a3f413f48,0x3f113f1a3f223f2b
.quad 0xbf60bf59bf51bf48,0xbf76bf72bf6dbf67,0xbe72be9bbebdbede,0x3d2cbce6bdc9be2c,0x3f803f803f7d3f7a,0x3f6f3f763f7b3f7e,0xbe95be48bdc90000,0xbf22bf0ebef1bec4
.quad 0x3f803f803f803f80,0x3f803f803f803f80,0xbebdbeb7beb0bea9,0xbed8bed1becbbec4,0xbf3abf3fbf44bf48,0xbf25bf2bbf30bf35,0x3f683f633f5e3f59,0x3f773f743f703f6d
.quad 0x3d663de53e2c3e64,0xbe2cbde5bd660000,0xbf73bf78bf7cbf7e,0xbf53bf5cbf65bf6d,0x3f253f143f023ede,0x3f5c3f513f443f35,0x3ef13f0e3f223f35,0x3dc93e483e953ec4
.quad 0xbf803f80bf803f80,0xbf803f80bf803f80,0xbf6ebf6fbf70bf72,0xbf68bf6abf6bbf6d,0x3f303f2b3f253f20,0x3f443f3f3f3a3f35,0x3ed83eeb3efe3f08,0x3e873e9b3eb03ec4
.quad 0xbf80bf7ebf7cbf7a,0xbf7cbf7ebf80bf80,0x3ea23e803e3a3de5,0x3f113f023ee53ec4,0x3f443f513f5c3f67,0x3f023f143f253f35,0xbf62bf55bf46bf35,0xbf7fbf7bbf75bf6d
.quad 0x3f803f803f803f80,0x3f803f803f803f80,0xbef1beebbee5bede,0xbf05bf02befebef8,0xbf0ebf14bf1abf20,0xbeebbef8bf02bf08,0x3f7f3f7d3f7c3f7a,0x3f7f3f803f803f80
.quad 0xbec4bea9be8ebe64,0xbf14bf08bef8bede,0xbf22bf30bf3cbf48,0xbecbbeebbf05bf14,0x3f7b3f763f6f3f67,0x3f7d3f803f803f7e,0xbe95be48bdc90000,0xbf22bf0ebef1bec4
.quad 0xbf803f80bf803f80,0xbf803f80bf803f80,0xbf62bf63bf65bf67,0xbf5bbf5cbf5ebf60,0x3f553f513f4d3f48,0x3f633f603f5c3f59,0x3dc93e0f3e3a3e64,0xbd8fbce63c663d66
.quad 0xbf6dbf72bf76bf7a,0xbf51bf59bf60bf67,0x3f463f3a3f2d3f20,0x3f6b3f633f5b3f51,0x3e483e8e3eb73ede,0xbe0fbd663ce63de5,0xbf75bf7bbf7fbf80,0xbf46bf55bf62bf6d
.quad 0x3f803f803f803f80,0x3f803f803f803f80,0xbf11bf0ebf0bbf08,0xbf1dbf1abf17bf14,0xbeb7bec4bed1bede,0xbe80be8ebe9bbea9,0x3f793f7b3f7d3f7e,0x3f6b3f6f3f733f76
.quad 0xbf3fbf35bf2bbf20,0xbf60bf59bf51bf48,0xbe01be48be87bea9,0x3e1d3dac3c66bd66,0x3f633f6d3f743f7a,0x3f303f3f3f4d3f59,0xbf62bf55bf46bf35,0xbf7fbf7bbf75bf6d
.quad 0xbf803f80bf803f80,0xbf803f80bf803f80,0xbf53bf55bf57bf59,0xbf4abf4dbf4fbf51,0x3f6f3f6d3f6a3f67,0x3f783f763f743f72,0xbe72be48be1dbde5,0xbecbbeb7bea2be8e
.quad 0xbf2bbf35bf3fbf48,0xbef8bf08bf14bf20,0x3f7e3f7b3f773f72,0x3f7d3f7f3f803f80,0xbeebbec4be9bbe64,0xbf3abf2bbf1abf08,0xbef1bf0ebf22bf35,0xbdc9be48be95bec4
.quad 0x3f803f803f803f80,0x3f803f803f803f80,0xbf28bf25bf22bf20,0xbf32bf30bf2dbf2b,0xbe0fbe2cbe48be64,0xbce6bd66bdacbde5,0x3f573f5c3f623f67,0x3f3c3f443f4a3f51
.quad 0xbf76bf72bf6dbf67,0xbf80bf7ebf7cbf7a,0x3ed83eb73e953e64,0x3f283f1a3f0b3ef8,0x3ed13ef83f0e3f20,0x3dac3e2c3e803ea9,0xbf75bf7bbf7fbf80,0xbf46bf55bf62bf6d
.quad 0xbf803f80bf803f80,0xbf803f80bf803f80,0xbf41bf44bf46bf48,0xbf38bf3abf3cbf3f,0x3f7d3f7c3f7b3f7a,0x3f803f803f7f3f7e,0xbf0bbf02bef1bede,0xbf2dbf25bf1dbf14
.quad 0xbe8ebea9bec4bede,0xbd66bde5be2cbe64,0x3f683f6f3f753f7a,0x3f413f4d3f573f60,0xbf6abf60bf55bf48,0xbf7fbf7cbf78bf72,0x3e953e483dc90000,0x3f223f0e3ef13ec4
.quad 0x3f803f803f803f80,0x3f803f803f803f80,0xbf3cbf3abf38bf35,0xbf46bf44bf41bf3f,0x3dac3d663ce60000,0x3e483e2c3e0f3de5,0x3f1d3f253f2d3f35,0x3ef13f023f0b3f14
.quad 0xbf7cbf7ebf80bf80,0xbf6dbf72bf76bf7a,0x3f573f4d3f413f35,0x3f753f6f3f683f60,0xbe80be2cbdac0000,0xbf0ebef8bed1bea9,0xbef1bf0ebf22bf35,0xbdc9be48be95bec4
.quad 0xbf803f80bf803f80,0xbf803f80bf803f80,0xbf2dbf30bf32bf35,0xbf22bf25bf28bf2b,0x3f7f3f803f803f80,0x3f7b3f7c3f7d3f7e,0xbf4abf44bf3cbf35,0xbf62bf5cbf57bf51
.quad 0x3e2c3de53d660000,0x3ec43ea93e8e3e64,0x3f0b3f1a3f283f35,0x3e953eb73ed83ef8,0xbf78bf7cbf7fbf80,0xbf55bf60bf6abf72,0x3f623f553f463f35,0x3f7f3f7b3f753f6d
.quad 0x3f803f803f803f80,0x3f803f803f803f80,0xbf4fbf4dbf4abf48,0xbf57bf55bf53bf51,0x3e9b3e8e3e803e64,0x3ed13ec43eb73ea9,0x3ea23eb73ecb3ede,0x3e1d3e483e723e8e
.quad 0xbf51bf59bf60bf67,0xbf2bbf35bf3fbf48,0x3f803f7f3f7d3f7a,0x3f773f7b3f7e3f80,0xbf4dbf3fbf30bf20,0xbf74bf6dbf63bf59,0x3e953e483dc90000,0x3f223f0e3ef13ec4
.quad 0xbf803f80bf803f80,0xbf803f80bf803f80,0xbf17bf1abf1dbf20,0xbf0bbf0ebf11bf14,0x3f743f763f783f7a,0x3f6a3f6d3f6f3f72,0xbf73bf6fbf6bbf67,0xbf7dbf7bbf79bf76
.quad 0x3f143f083ef83ede,0x3f3f3f353f2b3f20,0x3c663dac3e1d3e64,0xbe87be48be01bd66,0xbf1abf2bbf3abf48,0xbe9bbec4beebbf08,0x3f753f7b3f7f3f80,0x3f463f553f623f6d
.quad 0x3f803f803f803f80,0x3f803f803f803f80,0xbf5ebf5cbf5bbf59,0xbf65bf63bf62bf60,0x3f023ef83eeb3ede,0x3f1a3f143f0e3f08,0xbc663ce63d8f3de5,0xbe3abe0fbdc9bd66
.quad 0xbef8bf08bf14bf20,0xbe8ebea9bec4bede,0x3f5b3f633f6b3f72,0x3f2d3f3a3f463f51,0xbf80bf80bf7dbf7a,0xbf6fbf76bf7bbf7e,0x3f623f553f463f35,0x3f7f3f7b3f753f6d
.quad 0xbf803f80bf803f80,0xbf803f80bf803f80,0xbefebf02bf05bf08,0xbee5beebbef1bef8,0x3f5c3f603f633f67,0x3f4d3f513f553f59,0xbf80bf80bf7fbf7e,0xbf7cbf7dbf7fbf80
.quad 0x3f603f593f513f48,0x3f763f723f6d3f67,0xbf05beebbecbbea9,0xbf3cbf30bf22bf14,0x3ce6bd66be0fbe64,0x3eb73e8e3e483de5,0x3ef13f0e3f223f35,0x3dc93e483e953ec4
.quad 0x3f803f803f803f80,0x3f803f803f803f80,0xbf6bbf6abf68bf67,0xbf70bf6fbf6ebf6d,0x3f303f2b3f253f20,0x3f443f3f3f3a3f35,0xbeb0be9bbe87be64,0xbefebeebbed8bec4
.quad 0xbd66bde5be2cbe64,0x3e2c3de53d660000,0x3ee53f023f113f20,0x3e3a3e803ea23ec4,0xbf44bf51bf5cbf67,0xbf02bf14bf25bf35,0x3f753f7b3f7f3f80,0x3f463f553f623f6d
.quad 0xbf803f80bf803f80,0xbf803f80bf803f80,0xbecbbed1bed8bede,0xbeb0beb7bebdbec4,0x3f3a3f3f3f443f48,0x3f253f2b3f303f35,0xbf70bf74bf77bf7a,0xbf5ebf63bf68bf6d
.quad 0x3f803f7e3f7c3f7a,0x3f7c3f7e3f803f80,0xbf65bf5cbf53bf48,0xbf7cbf78bf73bf6d,0x3f253f143f023ede,0x3f5c3f513f443f35,0xbe95be48bdc90000,0xbf22bf0ebef1bec4
.quad 0x3f803f803f803f80,0x3f803f803f803f80,0xbf75bf74bf73bf72,0xbf79bf78bf77bf76,0x3f553f513f4d3f48,0x3f633f603f5c3f59,0xbf22bf1abf11bf08,0xbf41bf3abf32bf2b
.quad 0x3ec43ea93e8e3e64,0x3f143f083ef83ede,0xbdc9bce63d2c3de5,0xbebdbe9bbe72be2c,0xbe48be8ebeb7bede,0x3e0f3d66bce6bde5,0x3ef13f0e3f223f35,0x3dc93e483e953ec4
.quad 0xbf803f80bf803f80,0xbf803f80bf803f80,0xbe95be9bbea2bea9,0xbe72be80be87be8e,0x3f0e3f143f1a3f20,0x3eeb3ef83f023f08,0xbf46bf4dbf53bf59,0xbf28bf30bf38bf3f
.quad 0x3f6d3f723f763f7a,0x3f513f593f603f67,0xbf7fbf80bf80bf7e,0xbf6ebf74bf79bf7c,0x3f7b3f763f6f3f67,0x3f7d3f803f803f7e,0xbf62bf55bf46bf35,0xbf7fbf7bbf75bf6d
.quad 0x3f803f803f803f80,0x3f803f803f803f80,0xbf7cbf7bbf7abf7a,0xbf7ebf7dbf7dbf7c,0x3f6f3f6d3f6a3f67,0x3f783f763f743f72,0xbf5bbf55bf4fbf48,0xbf6ebf6abf65bf60
.quad 0x3f3f3f353f2b3f20,0x3f603f593f513f48,0xbf1dbf0ebefebede,0xbf4fbf44bf38bf2b,0x3eeb3ec43e9b3e64,0x3f3a3f2b3f1a3f08,0xbe95be48bdc90000,0xbf22bf0ebef1bec4
.quad 0xbf803f80bf803f80,0xbf803f80bf803f80,0xbe3abe48be56be64,0xbe01be0fbe1dbe2c,0x3eb73ec43ed13ede,0x3e803e8e3e9b3ea9,0xbf05bf0ebf17bf20,0xbebdbed1bee5bef8
.quad 0x3f2b3f353f3f3f48,0x3ef83f083f143f20,0xbf4abf55bf5ebf67,0xbf17bf25bf32bf3f,0x3f633f6d3f743f7a,0x3f303f3f3f4d3f59,0xbf75bf7bbf7fbf80,0xbf46bf55bf62bf6d
.quad 0x3f803f803f803f80,0x3f803f803f803f80,0xbf7fbf7fbf7fbf7e,0xbf80bf80bf80bf80,0x3f7d3f7c3f7b3f7a,0x3f803f803f7f3f7e,0xbf7abf78bf75bf72,0xbf80bf7fbf7ebf7c
.quad 0x3f763f723f6d3f67,0x3f803f7e3f7c3f7a,0xbf70bf6abf62bf59,0xbf7fbf7dbf7abf76,0x3f6a3f603f553f48,0x3f7f3f7c3f783f72,0xbf62bf55bf46bf35,0xbf7fbf7bbf75bf6d
.quad 0xbf803f80bf803f80,0xbf803f80bf803f80,0xbd8fbdacbdc9bde5,0xbc66bce6bd2cbd66,0x3e0f3e2c3e483e64,0x3ce63d663dac3de5,0xbe56be80be95bea9,0xbd2cbdacbe01be2c
.quad 0x3e8e3ea93ec43ede,0x3d663de53e2c3e64,0xbeb0bed1bef1bf08,0xbd8fbe0fbe56be8e,0x3ed13ef83f0e3f20,0x3dac3e2c3e803ea9,0xbef1bf0ebf22bf35,0xbdc9be48be95bec4
.quad 0x3f803f803f803f80,0x3f803f803f803f80,0xbf80bf80bf80bf80,0xbf7fbf7fbf7fbf80,0x3f7f3f803f803f80,0x3f7b3f7c3f7d3f7e,0xbf7ebf7fbf80bf80,0xbf75bf78bf7abf7c
.quad 0x3f7c3f7e3f803f80,0x3f6d3f723f763f7a,0xbf7abf7dbf7fbf80,0xbf62bf6abf70bf76,0x3f783f7c3f7f3f80,0x3f553f603f6a3f72,0xbf75bf7bbf7fbf80,0xbf46bf55bf62bf6d
.quad 0xbf803f80bf803f80,0xbf803f80bf803f80,0x3d2c3ce63c660000,0x3dc93dac3d8f3d66,0xbdacbd66bce60000,0xbe48be2cbe0fbde5,0x3e013dac3d2c0000,0x3e953e803e563e2c
.quad 0xbe2cbde5bd660000,0xbec4bea9be8ebe64,0x3e563e0f3d8f0000,0x3ef13ed13eb03e8e,0xbe80be2cbdac0000,0xbf0ebef8bed1bea9,0x3e953e483dc90000,0x3f223f0e3ef13ec4
.quad 0x3f803f803f803f80,0x3f803f803f803f80,0xbf7dbf7dbf7ebf7e,0xbf7abf7bbf7cbf7c,0x3f743f763f783f7a,0x3f6a3f6d3f6f3f72,0xbf65bf6abf6ebf72,0xbf4fbf55bf5bbf60
.quad 0x3f513f593f603f67,0x3f2b3f353f3f3f48,0xbf38bf44bf4fbf59,0xbefebf0ebf1dbf2b,0x3f1a3f2b3f3a3f48,0x3e9b3ec43eeb3f08,0xbef1bf0ebf22bf35,0xbdc9be48be95bec4
.quad 0xbf803f80bf803f80,0xbf803f80bf803f80,0x3e1d3e0f3e013de5,0x3e563e483e3a3e2c,0xbe9bbe8ebe80be64,0xbed1bec4beb7bea9,0x3ee53ed13ebd3ea9,0x3f173f0e3f053ef8
.quad 0xbf14bf08bef8bede,0xbf3fbf35bf2bbf20,0x3f323f253f173f08,0x3f5e3f553f4a3f3f,0xbf4dbf3fbf30bf20,0xbf74bf6dbf63bf59,0x3f623f553f463f35,0x3f7f3f7b3f753f6d
.quad 0x3f803f803f803f80,0x3f803f803f803f80,0xbf77bf78bf79bf7a,0xbf73bf74bf75bf76,0x3f5c3f603f633f67,0x3f4d3f513f553f59,0xbf32bf3abf41bf48,0xbf11bf1abf22bf2b
.quad 0x3ef83f083f143f20,0x3e8e3ea93ec43ede,0xbe72be9bbebdbede,0x3d2cbce6bdc9be2c,0xbce63d663e0f3e64,0xbeb7be8ebe48bde5,0x3e953e483dc90000,0x3f223f0e3ef13ec4
.quad 0xbf803f80bf803f80,0xbf803f80bf803f80,0x3e873e803e723e64,0x3ea23e9b3e953e8e,0xbf02bef8beebbede,0xbf1abf14bf0ebf08,0x3f383f303f283f20,0x3f533f4d3f463f3f
.quad 0xbf60bf59bf51bf48,0xbf76bf72bf6dbf67,0x3f793f743f6e3f67,0x3f803f803f7f3f7c,0xbf80bf80bf7dbf7a,0xbf6fbf76bf7bbf7e,0x3f753f7b3f7f3f80,0x3f463f553f623f6d
.quad 0x3f803f803f803f80,0x3f803f803f803f80,0xbf6ebf6fbf70bf72,0xbf68bf6abf6bbf6d,0x3f3a3f3f3f443f48,0x3f253f2b3f303f35,0xbed8beebbefebf08,0xbe87be9bbeb0bec4
.quad 0x3d663de53e2c3e64,0xbe2cbde5bd660000,0x3ea23e803e3a3de5,0x3f113f023ee53ec4,0xbf25bf14bf02bede,0xbf5cbf51bf44bf35,0x3f623f553f463f35,0x3f7f3f7b3f753f6d
.quad 0xbf803f80bf803f80,0xbf803f80bf803f80,0x3ebd3eb73eb03ea9,0x3ed83ed13ecb3ec4,0xbf30bf2bbf25bf20,0xbf44bf3fbf3abf35,0x3f683f633f5e3f59,0x3f773f743f703f6d
.quad 0xbf80bf7ebf7cbf7a,0xbf7cbf7ebf80bf80,0x3f733f783f7c3f7e,0x3f533f5c3f653f6d,0xbf44bf51bf5cbf67,0xbf02bf14bf25bf35,0x3ef13f0e3f223f35,0x3dc93e483e953ec4
.quad 0x3f803f803f803f80,0x3f803f803f803f80,0xbf62bf63bf65bf67,0xbf5bbf5cbf5ebf60,0x3f0e3f143f1a3f20,0x3eeb3ef83f023f08,0xbdc9be0fbe3abe64,0x3d8f3ce6bc66bd66
.quad 0xbec4bea9be8ebe64,0xbf14bf08bef8bede,0x3f463f3a3f2d3f20,0x3f6b3f633f5b3f51,0xbf7bbf76bf6fbf67,0xbf7dbf80bf80bf7e,0x3f753f7b3f7f3f80,0x3f463f553f623f6d
.quad 0xbf803f80bf803f80,0xbf803f80bf803f80,0x3ef13eeb3ee53ede,0x3f053f023efe3ef8,0xbf55bf51bf4dbf48,0xbf63bf60bf5cbf59,0x3f7f3f7d3f7c3f7a,0x3f7f3f803f803f80
.quad 0xbf6dbf72bf76bf7a,0xbf51bf59bf60bf67,0x3f223f303f3c3f48,0x3ecb3eeb3f053f14,0xbe48be8ebeb7bede,0x3e0f3d66bce6bde5,0xbe95be48bdc90000,0xbf22bf0ebef1bec4
.quad 0x3f803f803f803f80,0x3f803f803f803f80,0xbf53bf55bf57bf59,0xbf4abf4dbf4fbf51,0x3eb73ec43ed13ede,0x3e803e8e3e9b3ea9,0x3e723e483e1d3de5,0x3ecb3eb73ea23e8e
.quad 0xbf3fbf35bf2bbf20,0xbf60bf59bf51bf48,0x3f7e3f7b3f773f72,0x3f7d3f7f3f803f80,0xbf63bf6dbf74bf7a,0xbf30bf3fbf4dbf59,0x3ef13f0e3f223f35,0x3dc93e483e953ec4
.quad 0xbf803f80bf803f80,0xbf803f80bf803f80,0x3f113f0e3f0b3f08,0x3f1d3f1a3f173f14,0xbf6fbf6dbf6abf67,0xbf78bf76bf74bf72,0x3f793f7b3f7d3f7e,0x3f6b3f6f3f733f76
.quad 0xbf2bbf35bf3fbf48,0xbef8bf08bf14bf20,0x3e013e483e873ea9,0xbe1dbdacbc663d66,0x3eeb3ec43e9b3e64,0x3f3a3f2b3f1a3f08,0xbf62bf55bf46bf35,0xbf7fbf7bbf75bf6d
.quad 0x3f803f803f803f80,0x3f803f803f803f80,0xbf41bf44bf46bf48,0xbf38bf3abf3cbf3f,0x3e0f3e2c3e483e64,0x3ce63d663dac3de5,0x3f0b3f023ef13ede,0x3f2d3f253f1d3f14
.quad 0xbf76bf72bf6dbf67,0xbf80bf7ebf7cbf7a,0x3f683f6f3f753f7a,0x3f413f4d3f573f60,0xbed1bef8bf0ebf20,0xbdacbe2cbe80bea9,0xbe95be48bdc90000,0xbf22bf0ebef1bec4
.quad 0xbf803f80bf803f80,0xbf803f80bf803f80,0x3f283f253f223f20,0x3f323f303f2d3f2b,0xbf7dbf7cbf7bbf7a,0xbf80bf80bf7fbf7e,0x3f573f5c3f623f67,0x3f3c3f443f4a3f51
.quad 0xbe8ebea9bec4bede,0xbd66bde5be2cbe64,0xbed8beb7be95be64,0xbf28bf1abf0bbef8,0x3f6a3f603f553f48,0x3f7f3f7c3f783f72,0xbf75bf7bbf7fbf80,0xbf46bf55bf62bf6d
.quad 0x3f803f803f803f80,0x3f803f803f803f80,0xbf2dbf30bf32bf35,0xbf22bf25bf28bf2b,0xbdacbd66bce60000,0xbe48be2cbe0fbde5,0x3f4a3f443f3c3f35,0x3f623f5c3f573f51
.quad 0xbf7cbf7ebf80bf80,0xbf6dbf72bf76bf7a,0x3f0b3f1a3f283f35,0x3e953eb73ed83ef8,0x3e803e2c3dac0000,0x3f0e3ef83ed13ea9,0xbf62bf55bf46bf35,0xbf7fbf7bbf75bf6d
.quad 0xbf803f80bf803f80,0xbf803f80bf803f80,0x3f3c3f3a3f383f35,0x3f463f443f413f3f,0xbf7fbf80bf80bf80,0xbf7bbf7cbf7dbf7e,0x3f1d3f253f2d3f35,0x3ef13f023f0b3f14
.quad 0x3e2c3de53d660000,0x3ec43ea93e8e3e64,0xbf57bf4dbf41bf35,0xbf75bf6fbf68bf60,0x3f783f7c3f7f3f80,0x3f553f603f6a3f72,0xbef1bf0ebf22bf35,0xbdc9be48be95bec4
.quad 0x3f803f803f803f80,0x3f803f803f803f80,0xbf17bf1abf1dbf20,0xbf0bbf0ebf11bf14,0xbe9bbe8ebe80be64,0xbed1bec4beb7bea9,0x3f733f6f3f6b3f67,0x3f7d3f7b3f793f76
.quad 0xbf51bf59bf60bf67,0xbf2bbf35bf3fbf48,0x3c663dac3e1d3e64,0xbe87be48be01bd66,0x3f4d3f3f3f303f20,0x3f743f6d3f633f59,0xbf75bf7bbf7fbf80,0xbf46bf55bf62bf6d
.quad 0xbf803f80bf803f80,0xbf803f80bf803f80,0x3f4f3f4d3f4a3f48,0x3f573f553f533f51,0xbf74bf76bf78bf7a,0xbf6abf6dbf6fbf72,0x3ea23eb73ecb3ede,0x3e1d3e483e723e8e
.quad 0x3f143f083ef83ede,0x3f3f3f353f2b3f20,0xbf80bf7fbf7dbf7a,0xbf77bf7bbf7ebf80,0x3f1a3f2b3f3a3f48,0x3e9b3ec43eeb3f08,0x3e953e483dc90000,0x3f223f0e3ef13ec4
.quad 0x3f803f803f803f80,0x3f803f803f803f80,0xbefebf02bf05bf08,0xbee5beebbef1bef8,0xbf02bef8beebbede,0xbf1abf14bf0ebf08,0x3f803f803f7f3f7e,0x3f7c3f7d3f7f3f80
.quad 0xbef8bf08bf14bf20,0xbe8ebea9bec4bede,0xbf05beebbecbbea9,0xbf3cbf30bf22bf14,0x3f803f803f7d3f7a,0x3f6f3f763f7b3f7e,0xbef1bf0ebf22bf35,0xbdc9be48be95bec4
.quad 0xbf803f80bf803f80,0xbf803f80bf803f80,0x3f5e3f5c3f5b3f59,0x3f653f633f623f60,0xbf5cbf60bf63bf67,0xbf4dbf51bf55bf59,0xbc663ce63d8f3de5,0xbe3abe0fbdc9bd66
.quad 0x3f603f593f513f48,0x3f763f723f6d3f67,0xbf5bbf63bf6bbf72,0xbf2dbf3abf46bf51,0xbce63d663e0f3e64,0xbeb7be8ebe48bde5,0x3f623f553f463f35,0x3f7f3f7b3f753f6d
.quad 0x3f803f803f803f80,0x3f803f803f803f80,0xbecbbed1bed8bede,0xbeb0beb7bebdbec4,0xbf30bf2bbf25bf20,0xbf44bf3fbf3abf35,0x3f703f743f773f7a,0x3f5e3f633f683f6d
.quad 0xbd66bde5be2cbe64,0x3e2c3de53d660000,0xbf65bf5cbf53bf48,0xbf7cbf78bf73bf6d,0x3f443f513f5c3f67,0x3f023f143f253f35,0x3e953e483dc90000,0x3f223f0e3ef13ec4
.quad 0xbf803f80bf803f80,0xbf803f80bf803f80,0x3f6b3f6a3f683f67,0x3f703f6f3f6e3f6d,0xbf3abf3fbf44bf48,0xbf25bf2bbf30bf35,0xbeb0be9bbe87be64,0xbefebeebbed8bec4
.quad 0x3f803f7e3f7c3f7a,0x3f7c3f7e3f803f80,0xbee5bf02bf11bf20,0xbe3abe80bea2bec4,0xbf25bf14bf02bede,0xbf5cbf51bf44bf35,0x3f753f7b3f7f3f80,0x3f463f553f623f6d
.quad 0x3f803f803f803f80,0x3f803f803f803f80,0xbe95be9bbea2bea9,0xbe72be80be87be8e,0xbf55bf51bf4dbf48,0xbf63bf60bf5cbf59,0x3f463f4d3f533f59,0x3f283f303f383f3f
.quad 0x3ec43ea93e8e3e64,0x3f143f083ef83ede,0xbf7fbf80bf80bf7e,0xbf6ebf74bf79bf7c,0x3e483e8e3eb73ede,0xbe0fbd663ce63de5,0x3f623f553f463f35,0x3f7f3f7b3f753f6d
.quad 0xbf803f80bf803f80,0xbf803f80bf803f80,0x3f753f743f733f72,0x3f793f783f773f76,0xbf0ebf14bf1abf20,0xbeebbef8bf02bf08,0xbf22bf1abf11bf08,0xbf41bf3abf32bf2b
.quad 0x3f6d3f723f763f7a,0x3f513f593f603f67,0x3dc93ce6bd2cbde5,0x3ebd3e9b3e723e2c,0xbf7bbf76bf6fbf67,0xbf7dbf80bf80bf7e,0x3ef13f0e3f223f35,0x3dc93e483e953ec4
.quad 0x3f803f803f803f80,0x3f803f803f803f80,0xbe3abe48be56be64,0xbe01be0fbe1dbe2c,0xbf6fbf6dbf6abf67,0xbf78bf76bf74bf72,0x3f053f0e3f173f20,0x3ebd3ed13ee53ef8
.quad 0x3f3f3f353f2b3f20,0x3f603f593f513f48,0xbf4abf55bf5ebf67,0xbf17bf25bf32bf3f,0xbeebbec4be9bbe64,0xbf3abf2bbf1abf08,0x3f753f7b3f7f3f80,0x3f463f553f623f6d
.quad 0xbf803f80bf803f80,0xbf803f80bf803f80,0x3f7c3f7b3f7a3f7a,0x3f7e3f7d3f7d3f7c,0xbeb7bec4bed1bede,0xbe80be8ebe9bbea9,0xbf5bbf55bf4fbf48,0xbf6ebf6abf65bf60
.quad 0x3f2b3f353f3f3f48,0x3ef83f083f143f20,0x3f1d3f0e3efe3ede,0x3f4f3f443f383f2b,0xbf63bf6dbf74bf7a,0xbf30bf3fbf4dbf59,0xbe95be48bdc90000,0xbf22bf0ebef1bec4
.quad 0x3f803f803f803f80,0x3f803f803f803f80,0xbd8fbdacbdc9bde5,0xbc66bce6bd2cbd66,0xbf7dbf7cbf7bbf7a,0xbf80bf80bf7fbf7e,0x3e563e803e953ea9,0x3d2c3dac3e013e2c
.quad 0x3f763f723f6d3f67,0x3f803f7e3f7c3f7a,0xbeb0bed1bef1bf08,0xbd8fbe0fbe56be8e,0xbf6abf60bf55bf48,0xbf7fbf7cbf78bf72,0x3ef13f0e3f223f35,0x3dc93e483e953ec4
.quad 0xbf803f80bf803f80,0xbf803f80bf803f80,0x3f7f3f7f3f7f3f7e,0x3f803f803f803f80,0xbe0fbe2cbe48be64,0xbce6bd66bdacbde5,0xbf7abf78bf75bf72,0xbf80bf7fbf7ebf7c
.quad 0x3e8e3ea93ec43ede,0x3d663de53e2c3e64,0x3f703f6a3f623f59,0x3f7f3f7d3f7a3f76,0xbed1bef8bf0ebf20,0xbdacbe2cbe80bea9,0xbf62bf55bf46bf35,0xbf7fbf7bbf75bf6d
.quad 0x3f803f803f803f80,0x3f803f803f803f80,0x3d2c3ce63c660000,0x3dc93dac3d8f3d66,0xbf7fbf80bf80bf80,0xbf7bbf7cbf7dbf7e,0xbe01bdacbd2c0000,0xbe95be80be56be2c
.quad 0x3f7c3f7e3f803f80,0x3f6d3f723f763f7a,0x3e563e0f3d8f0000,0x3ef13ed13eb03e8e,0xbf78bf7cbf7fbf80,0xbf55bf60bf6abf72,0xbe95be48bdc90000,0xbf22bf0ebef1bec4
.quad 0xbf803f80bf803f80,0xbf803f80bf803f80,0x3f803f803f803f80,0x3f7f3f7f3f7f3f80,0x3dac3d663ce60000,0x3e483e2c3e0f3de5,0xbf7ebf7fbf80bf80,0xbf75bf78bf7abf7c
.quad 0xbe2cbde5bd660000,0xbec4bea9be8ebe64,0x3f7a3f7d3f7f3f80,0x3f623f6a3f703f76,0x3e803e2c3dac0000,0x3f0e3ef83ed13ea9,0xbf75bf7bbf7fbf80,0xbf46bf55bf62bf6d
.quad 0x3f803f803f803f80,0x3f803f803f803f80,0x3e1d3e0f3e013de5,0x3e563e483e3a3e2c,0xbf74bf76bf78bf7a,0xbf6abf6dbf6fbf72,0xbee5bed1bebdbea9,0xbf17bf0ebf05bef8
.quad 0x3f513f593f603f67,0x3f2b3f353f3f3f48,0x3f323f253f173f08,0x3f5e3f553f4a3f3f,0xbf1abf2bbf3abf48,0xbe9bbec4beebbf08,0xbf62bf55bf46bf35,0xbf7fbf7bbf75bf6d
.quad 0xbf803f80bf803f80,0xbf803f80bf803f80,0x3f7d3f7d3f7e3f7e,0x3f7a3f7b3f7c3f7c,0x3e9b3e8e3e803e64,0x3ed13ec43eb73ea9,0xbf65bf6abf6ebf72,0xbf4fbf55bf5bbf60
.quad 0xbf14bf08bef8bede,0xbf3fbf35bf2bbf20,0x3f383f443f4f3f59,0x3efe3f0e3f1d3f2b,0x3f4d3f3f3f303f20,0x3f743f6d3f633f59,0xbef1bf0ebf22bf35,0xbdc9be48be95bec4
.quad 0x3f803f803f803f80,0x3f803f803f803f80,0x3e873e803e723e64,0x3ea23e9b3e953e8e,0xbf5cbf60bf63bf67,0xbf4dbf51bf55bf59,0xbf38bf30bf28bf20,0xbf53bf4dbf46bf3f
.quad 0x3ef83f083f143f20,0x3e8e3ea93ec43ede,0x3f793f743f6e3f67,0x3f803f803f7f3f7c,0x3ce6bd66be0fbe64,0x3eb73e8e3e483de5,0xbf75bf7bbf7fbf80,0xbf46bf55bf62bf6d
.quad 0xbf803f80bf803f80,0xbf803f80bf803f80,0x3f773f783f793f7a,0x3f733f743f753f76,0x3f023ef83eeb3ede,0x3f1a3f143f0e3f08,0xbf32bf3abf41bf48,0xbf11bf1abf22bf2b
.quad 0xbf60bf59bf51bf48,0xbf76bf72bf6dbf67,0x3e723e9b3ebd3ede,0xbd2c3ce63dc93e2c,0x3f803f803f7d3f7a,0x3f6f3f763f7b3f7e,0x3e953e483dc90000,0x3f223f0e3ef13ec4
.quad 0x3f803f803f803f80,0x3f803f803f803f80,0x3ebd3eb73eb03ea9,0x3ed83ed13ecb3ec4,0xbf3abf3fbf44bf48,0xbf25bf2bbf30bf35,0xbf68bf63bf5ebf59,0xbf77bf74bf70bf6d
.quad 0x3d663de53e2c3e64,0xbe2cbde5bd660000,0x3f733f783f7c3f7e,0x3f533f5c3f653f6d,0x3f253f143f023ede,0x3f5c3f513f443f35,0xbef1bf0ebf22bf35,0xbdc9be48be95bec4
.quad 0xbf803f80bf803f80,0xbf803f80bf803f80,0x3f6e3f6f3f703f72,0x3f683f6a3f6b3f6d,0x3f303f2b3f253f20,0x3f443f3f3f3a3f35,0xbed8beebbefebf08,0xbe87be9bbeb0bec4
.quad 0xbf80bf7ebf7cbf7a,0xbf7cbf7ebf80bf80,0xbea2be80be3abde5,0xbf11bf02bee5bec4,0x3f443f513f5c3f67,0x3f023f143f253f35,0x3f623f553f463f35,0x3f7f3f7b3f753f6d
.quad 0x3f803f803f803f80,0x3f803f803f803f80,0x3ef13eeb3ee53ede,0x3f053f023efe3ef8,0xbf0ebf14bf1abf20,0xbeebbef8bf02bf08,0xbf7fbf7dbf7cbf7a,0xbf7fbf80bf80bf80
.quad 0xbec4bea9be8ebe64,0xbf14bf08bef8bede,0x3f223f303f3c3f48,0x3ecb3eeb3f053f14,0x3f7b3f763f6f3f67,0x3f7d3f803f803f7e,0x3e953e483dc90000,0x3f223f0e3ef13ec4
.quad 0xbf803f80bf803f80,0xbf803f80bf803f80,0x3f623f633f653f67,0x3f5b3f5c3f5e3f60,0x3f553f513f4d3f48,0x3f633f603f5c3f59,0xbdc9be0fbe3abe64,0x3d8f3ce6bc66bd66
.quad 0xbf6dbf72bf76bf7a,0xbf51bf59bf60bf67,0xbf46bf3abf2dbf20,0xbf6bbf63bf5bbf51,0x3e483e8e3eb73ede,0xbe0fbd663ce63de5,0x3f753f7b3f7f3f80,0x3f463f553f623f6d
.quad 0x3f803f803f803f80,0x3f803f803f803f80,0x3f113f0e3f0b3f08,0x3f1d3f1a3f173f14,0xbeb7bec4bed1bede,0xbe80be8ebe9bbea9,0xbf79bf7bbf7dbf7e,0xbf6bbf6fbf73bf76
.quad 0xbf3fbf35bf2bbf20,0xbf60bf59bf51bf48,0x3e013e483e873ea9,0xbe1dbdacbc663d66,0x3f633f6d3f743f7a,0x3f303f3f3f4d3f59,0x3f623f553f463f35,0x3f7f3f7b3f753f6d
.quad 0xbf803f80bf803f80,0xbf803f80bf803f80,0x3f533f553f573f59,0x3f4a3f4d3f4f3f51,0x3f6f3f6d3f6a3f67,0x3f783f763f743f72,0x3e723e483e1d3de5,0x3ecb3eb73ea23e8e
.quad 0xbf2bbf35bf3fbf48,0xbef8bf08bf14bf20,0xbf7ebf7bbf77bf72,0xbf7dbf7fbf80bf80,0xbeebbec4be9bbe64,0xbf3abf2bbf1abf08,0x3ef13f0e3f223f35,0x3dc93e483e953ec4
.quad 0x3f803f803f803f80,0x3f803f803f803f80,0x3f283f253f223f20,0x3f323f303f2d3f2b,0xbe0fbe2cbe48be64,0xbce6bd66bdacbde5,0xbf57bf5cbf62bf67,0xbf3cbf44bf4abf51
.quad 0xbf76bf72bf6dbf67,0xbf80bf7ebf7cbf7a,0xbed8beb7be95be64,0xbf28bf1abf0bbef8,0x3ed13ef83f0e3f20,0x3dac3e2c3e803ea9,0x3f753f7b3f7f3f80,0x3f463f553f623f6d
.quad 0xbf803f80bf803f80,0xbf803f80bf803f80,0x3f413f443f463f48,0x3f383f3a3f3c3f3f,0x3f7d3f7c3f7b3f7a,0x3f803f803f7f3f7e,0x3f0b3f023ef13ede,0x3f2d3f253f1d3f14
.quad 0xbe8ebea9bec4bede,0xbd66bde5be2cbe64,0xbf68bf6fbf75bf7a,0xbf41bf4dbf57bf60,0xbf6abf60bf55bf48,0xbf7fbf7cbf78bf72,0xbe95be48bdc90000,0xbf22bf0ebef1bec4
.quad 0x3f803f803f803f80,0x3f803f803f803f80,0x3f3c3f3a3f383f35,0x3f463f443f413f3f,0x3dac3d663ce60000,0x3e483e2c3e0f3de5,0xbf1dbf25bf2dbf35,0xbef1bf02bf0bbf14
.quad 0xbf7cbf7ebf80bf80,0xbf6dbf72bf76bf7a,0xbf57bf4dbf41bf35,0xbf75bf6fbf68bf60,0xbe80be2cbdac0000,0xbf0ebef8bed1bea9,0x3ef13f0e3f223f35,0x3dc93e483e953ec4
.quad 0xbf803f80bf803f80,0xbf803f80bf803f80,0x3f2d3f303f323f35,0x3f223f253f283f2b,0x3f7f3f803f803f80,0x3f7b3f7c3f7d3f7e,0x3f4a3f443f3c3f35,0x3f623f5c3f573f51
.quad 0x3e2c3de53d660000,0x3ec43ea93e8e3e64,0xbf0bbf1abf28bf35,0xbe95beb7bed8bef8,0xbf78bf7cbf7fbf80,0xbf55bf60bf6abf72,0xbf62bf55bf46bf35,0xbf7fbf7bbf75bf6d
.quad 0x3f803f803f803f80,0x3f803f803f803f80,0x3f4f3f4d3f4a3f48,0x3f573f553f533f51,0x3e9b3e8e3e803e64,0x3ed13ec43eb73ea9,0xbea2beb7becbbede,0xbe1dbe48be72be8e
.quad 0xbf51bf59bf60bf67,0xbf2bbf35bf3fbf48,0xbf80bf7fbf7dbf7a,0xbf77bf7bbf7ebf80,0xbf4dbf3fbf30bf20,0xbf74bf6dbf63bf59,0xbe95be48bdc90000,0xbf22bf0ebef1bec4
.quad 0xbf803f80bf803f80,0xbf803f80bf803f80,0x3f173f1a3f1d3f20,0x3f0b3f0e3f113f14,0x3f743f763f783f7a,0x3f6a3f6d3f6f3f72,0x3f733f6f3f6b3f67,0x3f7d3f7b3f793f76
.quad 0x3f143f083ef83ede,0x3f3f3f353f2b3f20,0xbc66bdacbe1dbe64,0x3e873e483e013d66,0xbf1abf2bbf3abf48,0xbe9bbec4beebbf08,0xbf75bf7bbf7fbf80,0xbf46bf55bf62bf6d
.quad 0x3f803f803f803f80,0x3f803f803f803f80,0x3f5e3f5c3f5b3f59,0x3f653f633f623f60,0x3f023ef83eeb3ede,0x3f1a3f143f0e3f08,0x3c66bce6bd8fbde5,0x3e3a3e0f3dc93d66
.quad 0xbef8bf08bf14bf20,0xbe8ebea9bec4bede,0xbf5bbf63bf6bbf72,0xbf2dbf3abf46bf51,0xbf80bf80bf7dbf7a,0xbf6fbf76bf7bbf7e,0xbf62bf55bf46bf35,0xbf7fbf7bbf75bf6d
.quad 0xbf803f80bf803f80,0xbf803f80bf803f80,0x3efe3f023f053f08,0x3ee53eeb3ef13ef8,0x3f5c3f603f633f67,0x3f4d3f513f553f59,0x3f803f803f7f3f7e,0x3f7c3f7d3f7f3f80
.quad 0x3f603f593f513f48,0x3f763f723f6d3f67,0x3f053eeb3ecb3ea9,0x3f3c3f303f223f14,0x3ce6bd66be0fbe64,0x3eb73e8e3e483de5,0xbef1bf0ebf22bf35,0xbdc9be48be95bec4
.quad 0x3f803f803f803f80,0x3f803f803f803f80,0x3f6b3f6a3f683f67,0x3f703f6f3f6e3f6d,0x3f303f2b3f253f20,0x3f443f3f3f3a3f35,0x3eb03e9b3e873e64,0x3efe3eeb3ed83ec4
.quad 0xbd66bde5be2cbe64,0x3e2c3de53d660000,0xbee5bf02bf11bf20,0xbe3abe80bea2bec4,0xbf44bf51bf5cbf67,0xbf02bf14bf25bf35,0xbf75bf7bbf7fbf80,0xbf46bf55bf62bf6d
.quad 0xbf803f80bf803f80,0xbf803f80bf803f80,0x3ecb3ed13ed83ede,0x3eb03eb73ebd3ec4,0x3f3a3f3f3f443f48,0x3f253f2b3f303f35,0x3f703f743f773f7a,0x3f5e3f633f683f6d
.quad 0x3f803f7e3f7c3f7a,0x3f7c3f7e3f803f80,0x3f653f5c3f533f48,0x3f7c3f783f733f6d,0x3f253f143f023ede,0x3f5c3f513f443f35,0x3e953e483dc90000,0x3f223f0e3ef13ec4
.quad 0x3f803f803f803f80,0x3f803f803f803f80,0x3f753f743f733f72,0x3f793f783f773f76,0x3f553f513f4d3f48,0x3f633f603f5c3f59,0x3f223f1a3f113f08,0x3f413f3a3f323f2b
.quad 0x3ec43ea93e8e3e64,0x3f143f083ef83ede,0x3dc93ce6bd2cbde5,0x3ebd3e9b3e723e2c,0xbe48be8ebeb7bede,0x3e0f3d66bce6bde5,0xbef1bf0ebf22bf35,0xbdc9be48be95bec4
.quad 0xbf803f80bf803f80,0xbf803f80bf803f80,0x3e953e9b3ea23ea9,0x3e723e803e873e8e,0x3f0e3f143f1a3f20,0x3eeb3ef83f023f08,0x3f463f4d3f533f59,0x3f283f303f383f3f
.quad 0x3f6d3f723f763f7a,0x3f513f593f603f67,0x3f7f3f803f803f7e,0x3f6e3f743f793f7c,0x3f7b3f763f6f3f67,0x3f7d3f803f803f7e,0x3f623f553f463f35,0x3f7f3f7b3f753f6d
.quad 0x3f803f803f803f80,0x3f803f803f803f80,0x3f7c3f7b3f7a3f7a,0x3f7e3f7d3f7d3f7c,0x3f6f3f6d3f6a3f67,0x3f783f763f743f72,0x3f5b3f553f4f3f48,0x3f6e3f6a3f653f60
.quad 0x3f3f3f353f2b3f20,0x3f603f593f513f48,0x3f1d3f0e3efe3ede,0x3f4f3f443f383f2b,0x3eeb3ec43e9b3e64,0x3f3a3f2b3f1a3f08,0x3e953e483dc90000,0x3f223f0e3ef13ec4
.quad 0xbf803f80bf803f80,0xbf803f80bf803f80,0x3e3a3e483e563e64,0x3e013e0f3e1d3e2c,0x3eb73ec43ed13ede,0x3e803e8e3e9b3ea9,0x3f053f0e3f173f20,0x3ebd3ed13ee53ef8
.quad 0x3f2b3f353f3f3f48,0x3ef83f083f143f20,0x3f4a3f553f5e3f67,0x3f173f253f323f3f,0x3f633f6d3f743f7a,0x3f303f3f3f4d3f59,0x3f753f7b3f7f3f80,0x3f463f553f623f6d
.quad 0x3f803f803f803f80,0x3f803f803f803f80,0x3f7f3f7f3f7f3f7e,0x3f803f803f803f80,0x3f7d3f7c3f7b3f7a,0x3f803f803f7f3f7e,0x3f7a3f783f753f72,0x3f803f7f3f7e3f7c
.quad 0x3f763f723f6d3f67,0x3f803f7e3f7c3f7a,0x3f703f6a3f623f59,0x3f7f3f7d3f7a3f76,0x3f6a3f603f553f48,0x3f7f3f7c3f783f72,0x3f623f553f463f35,0x3f7f3f7b3f753f6d
.quad 0xbf803f80bf803f80,0xbf803f80bf803f80,0x3d8f3dac3dc93de5,0x3c663ce63d2c3d66,0x3e0f3e2c3e483e64,0x3ce63d663dac3de5,0x3e563e803e953ea9,0x3d2c3dac3e013e2c
.quad 0x3e8e3ea93ec43ede,0x3d663de53e2c3e64,0x3eb03ed13ef13f08,0x3d8f3e0f3e563e8e,0x3ed13ef83f0e3f20,0x3dac3e2c3e803ea9,0x3ef13f0e3f223f35,0x3dc93e483e953ec4
fblk 1
fblk 2
fblk 3
fblk 4
fblk 5
fblk 6
fblk 7
fblk 8
fblk 9
fblk 10
fblk 11
fblk 12
fblk 13
fblk 14
fblk 15
fblk 16
fblk 17
fblk 18
fblk 19
fblk 20
fblk 21
fblk 22
fblk 23
fblk 24
fblk 25
fblk 26
fblk 27
.quad 0x361235923592,0x361200003612,0xb3033612b5923592,0xb3c53612b3833612,0xb383361235923592,0xb4453612b4033612,0xb3c53612b5923592,0xb4933611b4453612
.quad 0xb403361235923592,0xb4c43610b4833611,0xb4243612b5923592,0xb4f4360fb4a43611,0xb445361235923592,0xb512360eb4c43610,0xb4653612b5923592,0xb52a360cb4e4360f
.quad 0xb483361135923592,0xb541360ab502360f,0xb4933611b5923592,0xb5583608b512360e,0xb4a4361135923592,0xb56f3606b522360d,0xb4b43611b5923592,0xb5833603b532360b
.quad 0xb4c4361035923592,0xb58e3600b541360a,0xb4d43610b5923592,0xb59835fab5513609,0xb4e4360f35923592,0xb5a335f3b5603607,0xb4f4360fb5923592,0xb5ad35ecb56f3606
.quad 0xb502360f35923592,0xb5b635e5b57e3604,0xb50a360eb5923592,0xb5c035ddb5863602,0xb512360e35923592,0xb5c935d5b58e3600,0xb51a360db5923592,0xb5d235ccb59535fc
.quad 0xb522360d35923592,0xb5da35c3b59c35f8,0xb52a360cb5923592,0xb5e235bab5a335f3,0xb532360b35923592,0xb5ea35b0b5a935ef,0xb539360bb5923592,0xb5f135a6b5b035ea
.quad 0xb541360a35923592,0xb5f8359cb5b635e5,0xb5493609b5923592,0xb5fe3591b5bd35e0,0xb551360935923592,0xb6023586b5c335da,0xb5583608b5923592,0xb6053576b5c935d5
.quad 0xb560360735923592,0xb6073560b5cf35cf,0xb5673606b5923592,0xb6093549b5d535c9,0xb56f360635923592,0xb60b3532b5da35c3,0xb5763605b5923592,0xb60d351ab5e035bd
.quad 0x361200003612,0x361200003612,0xb4243612b4033612,0xb4653612b4453612,0xb4a43611b4833611,0xb4e4360fb4c43610,0xb4f4360fb4c43610,0xb52a360cb512360e
.quad 0xb522360db502360f,0xb5603607b541360a,0xb5493609b522360d,0xb58a3601b56f3606,0xb56f3606b541360a,0xb5a335f3b58e3600,0xb58a3601b5603607,0xb5ba35e2b5a335f3
.quad 0xb59c35f8b57e3604,0xb5cf35cfb5b635e5,0xb5ad35ecb58e3600,0xb5e235bab5c935d5,0xb5bd35e0b59c35f8,0xb5f335a3b5da35c3,0xb5cc35d2b5a935ef,0xb601358ab5ea35b0
.quad 0xb5da35c3b5b635e5,0xb6073560b5f8359c,0xb5e735b3b5c335da,0xb60c352ab6023586,0xb5f335a3b5cf35cf,0xb60f34e4b6073560,0xb5fe3591b5da35c3,0xb6123465b60b3532
.quad 0xb604357eb5e535b6,0xb6120000b60f3502,0xb6083558b5ef35a9,0xb612b465b61134a4,0xb60b3532b5f8359c,0xb60fb4e4b6123403,0xb60e350ab600358e,0xb60cb52ab612b383
.quad 0xb61034c4b604357e,0xb607b560b611b483,0xb6123465b6073560,0xb601b58ab60fb4e4,0xb6123383b60a3541,0xb5f3b5a3b60db522,0xb612b3c5b60d3522,0xb5e2b5bab609b551
.quad 0xb611b483b60f3502,0xb5cfb5cfb604b57e,0xb610b4d4b61034c4,0xb5bab5e2b5fcb595,0xb60eb512b6113483,0xb5a3b5f3b5efb5a9,0xb60bb539b6123403,0xb58ab601b5e0b5bd
.quad 0xb607b560b6120000,0xb560b607b5cfb5cf,0xb603b583b612b403,0xb52ab60cb5bdb5e0,0xb5fcb595b611b483,0xb4e4b60fb5a9b5ef,0xb5f1b5a6b610b4c4,0xb465b612b595b5fc
.quad 0xb57e360435923592,0xb60f3502b5e535b6,0xb5833603b5923592,0xb61034d4b5ea35b0,0xb586360235923592,0xb61134a4b5ef35a9,0xb58a3601b5923592,0xb6123465b5f335a3
.quad 0xb58e360035923592,0xb6123403b5f8359c,0xb59135feb5923592,0xb6123303b5fc3595,0xb59535fc35923592,0xb612b383b600358e,0xb59835fab5923592,0xb612b424b6023586
.quad 0xb59c35f835923592,0xb611b483b604357e,0xb59f35f6b5923592,0xb611b4b4b606356f,0xb5a335f335923592,0xb60fb4e4b6073560,0xb5a635f1b5923592,0xb60eb50ab6093551
.quad 0xb5a935ef35923592,0xb60db522b60a3541,0xb5ad35ecb5923592,0xb60bb539b60b3532,0xb5b035ea35923592,0xb609b551b60d3522,0xb5b335e7b5923592,0xb606b567b60e3512
.quad 0xb5b635e535923592,0xb604b57eb60f3502,0xb5ba35e2b5923592,0xb601b58ab60f34e4,0xb5bd35e035923592,0xb5fcb595b61034c4,0xb5c035ddb5923592,0xb5f6b59fb61134a4
.quad 0xb5c335da35923592,0xb5efb5a9b6113483,0xb5c635d7b5923592,0xb5e7b5b3b6123445,0xb5c935d535923592,0xb5e0b5bdb6123403,0xb5cc35d2b5923592,0xb5d7b5c6b6123383
.quad 0xb5cf35cf35923592,0xb5cfb5cfb6120000,0xb5d235ccb5923592,0xb5c6b5d7b612b383,0xb5d535c935923592,0xb5bdb5e0b612b403,0xb5d735c6b5923592,0xb5b3b5e7b612b445
.quad 0xb5da35c335923592,0xb5a9b5efb611b483,0xb5dd35c0b5923592,0xb59fb5f6b611b4a4,0xb5e035bd35923592,0xb595b5fcb610b4c4,0xb5e235bab5923592,0xb58ab601b60fb4e4
.quad 0xb5e5b5b6b60fb502,0xb612b57eb604,0xb5d7b5c6b60db522,0x3465b612b551b609,0xb5c9b5d5b60ab541,0x34e4b60fb522b60d,0xb5bab5e2b607b560,0x352ab60cb4e4b60f
.quad 0xb5a9b5efb604b57e,0x3560b607b483b611,0xb598b5fab600b58e,0x358ab601b383b612,0xb586b602b5f8b59c,0x35a3b5f33403b612,0xb567b606b5efb5a9,0x35bab5e234a4b611
.quad 0xb541b60ab5e5b5b6,0x35cfb5cf3502b60f,0xb51ab60db5dab5c3,0x35e2b5ba3532b60b,0xb4e4b60fb5cfb5cf,0x35f3b5a33560b607,0xb493b611b5c3b5da,0x3601b58a3586b602
.quad 0xb403b612b5b6b5e5,0x3607b560359cb5f8,0x3303b612b5a9b5ef,0x360cb52a35b0b5ea,0x3445b612b59cb5f8,0x360fb4e435c3b5da,0x34b4b611b58eb600,0x3612b46535d5b5c9
.quad 0x3502b60fb57eb604,0x3612000035e5b5b6,0x352ab60cb560b607,0x3612346535f3b5a3,0x3551b609b541b60a,0x360f34e43600b58e,0x3576b605b522b60d,0x360c352a3606b56f
.quad 0x358eb600b502b60f,0x36073560360ab541,0x359fb5f6b4c4b610,0x3601358a360eb512,0x35b0b5eab483b611,0x35f335a33610b4c4,0x35c0b5ddb403b612,0x35e235ba3612b445
.quad 0x35cfb5cf0000b612,0x35cf35cf36120000,0x35ddb5c03403b612,0x35ba35e236123445,0x35eab5b03483b611,0x35a335f3361034c4,0x35f6b59f34c4b610,0x358a3601360e3512
.quad 0x3600b58e3502b60f,0x35603607360a3541,0x3605b5763522b60d,0x352a360c3606356f,0x3609b5513541b60a,0x34e4360f3600358e,0x360cb52a3560b607,0x3465361235f335a3
.quad 0xb5e535b635923592,0xb57eb604b60fb502,0xb5e735b3b5923592,0xb567b606b60eb512,0xb5ea35b035923592,0xb551b609b60db522,0xb5ec35adb5923592,0xb539b60bb60bb532
.quad 0xb5ef35a935923592,0xb522b60db60ab541,0xb5f135a6b5923592,0xb50ab60eb609b551,0xb5f335a335923592,0xb4e4b60fb607b560,0xb5f6359fb5923592,0xb4b4b611b606b56f
.quad 0xb5f8359c35923592,0xb483b611b604b57e,0xb5fa3598b5923592,0xb424b612b602b586,0xb5fc359535923592,0xb383b612b600b58e,0xb5fe3591b5923592,0x3303b612b5fcb595
.quad 0xb600358e35923592,0x3403b612b5f8b59c,0xb601358ab5923592,0x3465b612b5f3b5a3,0xb602358635923592,0x34a4b611b5efb5a9,0xb6033583b5923592,0x34d4b610b5eab5b0
.quad 0xb604357e35923592,0x3502b60fb5e5b5b6,0xb6053576b5923592,0x351ab60db5e0b5bd,0xb606356f35923592,0x3532b60bb5dab5c3,0xb6063567b5923592,0x3549b609b5d5b5c9
.quad 0xb607356035923592,0x3560b607b5cfb5cf,0xb6083558b5923592,0x3576b605b5c9b5d5,0xb609355135923592,0x3586b602b5c3b5da,0xb6093549b5923592,0x3591b5feb5bdb5e0
.quad 0xb60a354135923592,0x359cb5f8b5b6b5e5,0xb60b3539b5923592,0x35a6b5f1b5b0b5ea,0xb60b353235923592,0x35b0b5eab5a9b5ef,0xb60c352ab5923592,0x35bab5e2b5a3b5f3
.quad 0xb60d352235923592,0x35c3b5dab59cb5f8,0xb60d351ab5923592,0x35ccb5d2b595b5fc,0xb60e351235923592,0x35d5b5c9b58eb600,0xb60e350ab5923592,0x35ddb5c0b586b602
.quad 0x360fb502357eb604,0x361235e535b6,0x3611b4b4358eb600,0xb465361235d535c9,0x3612b445359cb5f8,0xb4e4360f35c335da,0x3612b30335a9b5ef,0xb52a360c35b035ea
.quad 0x3612340335b6b5e5,0xb5603607359c35f8,0x3611349335c3b5da,0xb58a360135863602,0x360f34e435cfb5cf,0xb5a335f335603607,0x360d351a35dab5c3,0xb5ba35e23532360b
.quad 0x360a354135e5b5b6,0xb5cf35cf3502360f,0x3606356735efb5a9,0xb5e235ba34a43611,0x3602358635f8b59c,0xb5f335a334033612,0x35fa35983600b58e,0xb601358ab3833612
.quad 0x35ef35a93604b57e,0xb6073560b4833611,0x35e235ba3607b560,0xb60c352ab4e4360f,0x35d535c9360ab541,0xb60f34e4b522360d,0x35c635d7360db522,0xb6123465b5513609
.quad 0x35b635e5360fb502,0xb6120000b57e3604,0x35a635f13610b4c4,0xb612b465b59535fc,0x359535fc3611b483,0xb60fb4e4b5a935ef,0x358336033612b403,0xb60cb52ab5bd35e0
.quad 0x3560360736120000,0xb607b560b5cf35cf,0x3539360b36123403,0xb601b58ab5e035bd,0x3512360e36113483,0xb5f3b5a3b5ef35a9,0x34d43610361034c4,0xb5e2b5bab5fc3595
.quad 0x34833611360f3502,0xb5cfb5cfb604357e,0x33c53612360d3522,0xb5bab5e2b6093551,0xb3833612360a3541,0xb5a3b5f3b60d3522,0xb465361236073560,0xb58ab601b60f34e4
.quad 0xb4c436103604357e,0xb560b607b6113483,0xb50a360e3600358e,0xb52ab60cb6123383,0xb532360b35f8359c,0xb4e4b60fb612b403,0xb558360835ef35a9,0xb465b612b611b4a4
.quad 0xb60f350235923592,0x35e5b5b6b57eb604,0xb60f34f4b5923592,0x35ecb5adb56fb606,0xb60f34e435923592,0x35f3b5a3b560b607,0xb61034d4b5923592,0x35fab598b551b609
.quad 0xb61034c435923592,0x3600b58eb541b60a,0xb61134b4b5923592,0x3603b583b532b60b,0xb61134a435923592,0x3606b56fb522b60d,0xb6113493b5923592,0x3608b558b512b60e
.quad 0xb611348335923592,0x360ab541b502b60f,0xb6123465b5923592,0x360cb52ab4e4b60f,0xb612344535923592,0x360eb512b4c4b610,0xb6123424b5923592,0x360fb4f4b4a4b611
.quad 0xb612340335923592,0x3610b4c4b483b611,0xb61233c5b5923592,0x3611b493b445b612,0xb612338335923592,0x3612b445b403b612,0xb6123303b5923592,0x3612b3c5b383b612
.quad 0xb612000035923592,0x361200000000b612,0xb612b303b5923592,0x361233c53383b612,0xb612b38335923592,0x361234453403b612,0xb612b3c5b5923592,0x361134933445b612
.quad 0xb612b40335923592,0x361034c43483b611,0xb612b424b5923592,0x360f34f434a4b611,0xb612b44535923592,0x360e351234c4b610,0xb612b465b5923592,0x360c352a34e4b60f
.quad 0xb611b48335923592,0x360a35413502b60f,0xb611b493b5923592,0x360835583512b60e,0xb611b4a435923592,0x3606356f3522b60d,0xb611b4b4b5923592,0x360335833532b60b
.quad 0xb610b4c435923592,0x3600358e3541b60a,0xb610b4d4b5923592,0x35fa35983551b609,0xb60fb4e435923592,0x35f335a33560b607,0xb60fb4f4b5923592,0x35ec35ad356fb606
.quad 0xb57e360435e535b6,0xb612b60fb502,0xb59135fe35da35c3,0x3465b612b60bb532,0xb5a335f335cf35cf,0x34e4b60fb607b560,0xb5b335e735c335da,0x352ab60cb602b586
.quad 0xb5c335da35b635e5,0x3560b607b5f8b59c,0xb5d235cc35a935ef,0x358ab601b5eab5b0,0xb5e035bd359c35f8,0x35a3b5f3b5dab5c3,0xb5ec35ad358e3600,0x35bab5e2b5c9b5d5
.quad 0xb5f8359c357e3604,0x35cfb5cfb5b6b5e5,0xb601358a35603607,0x35e2b5bab5a3b5f3,0xb606356f3541360a,0x35f3b5a3b58eb600,0xb60935493522360d,0x3601b58ab56fb606
.quad 0xb60d35223502360f,0x3607b560b541b60a,0xb60f34f434c43610,0x360cb52ab512b60e,0xb61134a434833611,0x360fb4e4b4c4b610,0xb612342434033612,0x3612b465b445b612
.quad 0xb612000000003612,0x361200000000b612,0xb612b424b4033612,0x361234653445b612,0xb611b4a4b4833611,0x360f34e434c4b610,0xb60fb4f4b4c43610,0x360c352a3512b60e
.quad 0xb60db522b502360f,0x360735603541b60a,0xb609b549b522360d,0x3601358a356fb606,0xb606b56fb541360a,0x35f335a3358eb600,0xb601b58ab5603607,0x35e235ba35a3b5f3
.quad 0xb5f8b59cb57e3604,0x35cf35cf35b6b5e5,0xb5ecb5adb58e3600,0x35ba35e235c9b5d5,0xb5e0b5bdb59c35f8,0x35a335f335dab5c3,0xb5d2b5ccb5a935ef,0x358a360135eab5b0
.quad 0xb5c3b5dab5b635e5,0x3560360735f8b59c,0xb5b3b5e7b5c335da,0x352a360c3602b586,0xb5a3b5f3b5cf35cf,0x34e4360f3607b560,0xb591b5feb5da35c3,0x34653612360bb532
.quad 0xb60fb50235923592,0x35e535b6357eb604,0xb60eb50ab5923592,0x35dd35c03586b602,0xb60eb51235923592,0x35d535c9358eb600,0xb60db51ab5923592,0x35cc35d23595b5fc
.quad 0xb60db52235923592,0x35c335da359cb5f8,0xb60cb52ab5923592,0x35ba35e235a3b5f3,0xb60bb53235923592,0x35b035ea35a9b5ef,0xb60bb539b5923592,0x35a635f135b0b5ea
.quad 0xb60ab54135923592,0x359c35f835b6b5e5,0xb609b549b5923592,0x359135fe35bdb5e0,0xb609b55135923592,0x3586360235c3b5da,0xb608b558b5923592,0x3576360535c9b5d5
.quad 0xb607b56035923592,0x3560360735cfb5cf,0xb606b567b5923592,0x3549360935d5b5c9,0xb606b56f35923592,0x3532360b35dab5c3,0xb605b576b5923592,0x351a360d35e0b5bd
.quad 0xb604b57e35923592,0x3502360f35e5b5b6,0xb603b583b5923592,0x34d4361035eab5b0,0xb602b58635923592,0x34a4361135efb5a9,0xb601b58ab5923592,0x3465361235f3b5a3
.quad 0xb600b58e35923592,0x3403361235f8b59c,0xb5feb591b5923592,0x3303361235fcb595,0xb5fcb59535923592,0xb38336123600b58e,0xb5fab598b5923592,0xb42436123602b586
.quad 0xb5f8b59c35923592,0xb48336113604b57e,0xb5f6b59fb5923592,0xb4b436113606b56f,0xb5f3b5a335923592,0xb4e4360f3607b560,0xb5f1b5a6b5923592,0xb50a360e3609b551
.quad 0xb5efb5a935923592,0xb522360d360ab541,0xb5ecb5adb5923592,0xb539360b360bb532,0xb5eab5b035923592,0xb5513609360db522,0xb5e7b5b3b5923592,0xb5673606360eb512
.quad 0xb57eb604b5e535b6,0x3612360fb502,0xb558b608b5ef35a9,0xb46536123611b4a4,0xb532b60bb5f8359c,0xb4e4360f3612b403,0xb50ab60eb600358e,0xb52a360c36123383
.quad 0xb4c4b610b604357e,0xb560360736113483,0xb465b612b6073560,0xb58a3601360f34e4,0xb383b612b60a3541,0xb5a335f3360d3522,0x33c5b612b60d3522,0xb5ba35e236093551
.quad 0x3483b611b60f3502,0xb5cf35cf3604357e,0x34d4b610b61034c4,0xb5e235ba35fc3595,0x3512b60eb6113483,0xb5f335a335ef35a9,0x3539b60bb6123403,0xb601358a35e035bd
.quad 0x3560b607b6120000,0xb607356035cf35cf,0x3583b603b612b403,0xb60c352a35bd35e0,0x3595b5fcb611b483,0xb60f34e435a935ef,0x35a6b5f1b610b4c4,0xb6123465359535fc
.quad 0x35b6b5e5b60fb502,0xb6120000357e3604,0x35c6b5d7b60db522,0xb612b46535513609,0x35d5b5c9b60ab541,0xb60fb4e43522360d,0x35e2b5bab607b560,0xb60cb52a34e4360f
.quad 0x35efb5a9b604b57e,0xb607b56034833611,0x35fab598b600b58e,0xb601b58a33833612,0x3602b586b5f8b59c,0xb5f3b5a3b4033612,0x3606b567b5efb5a9,0xb5e2b5bab4a43611
.quad 0x360ab541b5e5b5b6,0xb5cfb5cfb502360f,0x360db51ab5dab5c3,0xb5bab5e2b532360b,0x360fb4e4b5cfb5cf,0xb5a3b5f3b5603607,0x3611b493b5c3b5da,0xb58ab601b5863602
.quad 0x3612b403b5b6b5e5,0xb560b607b59c35f8,0x36123303b5a9b5ef,0xb52ab60cb5b035ea,0x36123445b59cb5f8,0xb4e4b60fb5c335da,0x361134b4b58eb600,0xb465b612b5d535c9
.quad 0xb5e5b5b635923592,0xb57e3604360fb502,0xb5e2b5bab5923592,0xb58a3601360fb4e4,0xb5e0b5bd35923592,0xb59535fc3610b4c4,0xb5ddb5c0b5923592,0xb59f35f63611b4a4
.quad 0xb5dab5c335923592,0xb5a935ef3611b483,0xb5d7b5c6b5923592,0xb5b335e73612b445,0xb5d5b5c935923592,0xb5bd35e03612b403,0xb5d2b5ccb5923592,0xb5c635d73612b383
.quad 0xb5cfb5cf35923592,0xb5cf35cf36120000,0xb5ccb5d2b5923592,0xb5d735c636123383,0xb5c9b5d535923592,0xb5e035bd36123403,0xb5c6b5d7b5923592,0xb5e735b336123445
.quad 0xb5c3b5da35923592,0xb5ef35a936113483,0xb5c0b5ddb5923592,0xb5f6359f361134a4,0xb5bdb5e035923592,0xb5fc3595361034c4,0xb5bab5e2b5923592,0xb601358a360f34e4
.quad 0xb5b6b5e535923592,0xb604357e360f3502,0xb5b3b5e7b5923592,0xb6063567360e3512,0xb5b0b5ea35923592,0xb6093551360d3522,0xb5adb5ecb5923592,0xb60b3539360b3532
.quad 0xb5a9b5ef35923592,0xb60d3522360a3541,0xb5a6b5f1b5923592,0xb60e350a36093551,0xb5a3b5f335923592,0xb60f34e436073560,0xb59fb5f6b5923592,0xb61134b43606356f
.quad 0xb59cb5f835923592,0xb61134833604357e,0xb598b5fab5923592,0xb612342436023586,0xb595b5fc35923592,0xb61233833600358e,0xb591b5feb5923592,0xb612b30335fc3595
.quad 0xb58eb60035923592,0xb612b40335f8359c,0xb58ab601b5923592,0xb612b46535f335a3,0xb586b60235923592,0xb611b4a435ef35a9,0xb583b603b5923592,0xb610b4d435ea35b0
.quad 0x360f3502b57eb604,0xb612b5e535b6,0x360c352ab560b607,0x3465b612b5f335a3,0x36093551b541b60a,0x34e4b60fb600358e,0x36053576b522b60d,0x352ab60cb606356f
.quad 0x3600358eb502b60f,0x3560b607b60a3541,0x35f6359fb4c4b610,0x358ab601b60e3512,0x35ea35b0b483b611,0x35a3b5f3b61034c4,0x35dd35c0b403b612,0x35bab5e2b6123445
.quad 0x35cf35cf0000b612,0x35cfb5cfb6120000,0x35c035dd3403b612,0x35e2b5bab612b445,0x35b035ea3483b611,0x35f3b5a3b610b4c4,0x359f35f634c4b610,0x3601b58ab60eb512
.quad 0x358e36003502b60f,0x3607b560b60ab541,0x357636053522b60d,0x360cb52ab606b56f,0x355136093541b60a,0x360fb4e4b600b58e,0x352a360c3560b607,0x3612b465b5f3b5a3
.quad 0x3502360f357eb604,0x36120000b5e5b5b6,0x34b43611358eb600,0x36123465b5d5b5c9,0x34453612359cb5f8,0x360f34e4b5c3b5da,0x3303361235a9b5ef,0x360c352ab5b0b5ea
.quad 0xb403361235b6b5e5,0x36073560b59cb5f8,0xb493361135c3b5da,0x3601358ab586b602,0xb4e4360f35cfb5cf,0x35f335a3b560b607,0xb51a360d35dab5c3,0x35e235bab532b60b
.quad 0xb541360a35e5b5b6,0x35cf35cfb502b60f,0xb567360635efb5a9,0x35ba35e2b4a4b611,0xb586360235f8b59c,0x35a335f3b403b612,0xb59835fa3600b58e,0x358a36013383b612
.quad 0xb5a935ef3604b57e,0x356036073483b611,0xb5ba35e23607b560,0x352a360c34e4b60f,0xb5c935d5360ab541,0x34e4360f3522b60d,0xb5d735c6360db522,0x346536123551b609
.quad 0xb57eb60435923592,0xb60fb50235e535b6,0xb576b605b5923592,0xb60db51a35e035bd,0xb56fb60635923592,0xb60bb53235da35c3,0xb567b606b5923592,0xb609b54935d535c9
.quad 0xb560b60735923592,0xb607b56035cf35cf,0xb558b608b5923592,0xb605b57635c935d5,0xb551b60935923592,0xb602b58635c335da,0xb549b609b5923592,0xb5feb59135bd35e0
.quad 0xb541b60a35923592,0xb5f8b59c35b635e5,0xb539b60bb5923592,0xb5f1b5a635b035ea,0xb532b60b35923592,0xb5eab5b035a935ef,0xb52ab60cb5923592,0xb5e2b5ba35a335f3
.quad 0xb522b60d35923592,0xb5dab5c3359c35f8,0xb51ab60db5923592,0xb5d2b5cc359535fc,0xb512b60e35923592,0xb5c9b5d5358e3600,0xb50ab60eb5923592,0xb5c0b5dd35863602
.quad 0xb502b60f35923592,0xb5b6b5e5357e3604,0xb4f4b60fb5923592,0xb5adb5ec356f3606,0xb4e4b60f35923592,0xb5a3b5f335603607,0xb4d4b610b5923592,0xb598b5fa35513609
.quad 0xb4c4b61035923592,0xb58eb6003541360a,0xb4b4b611b5923592,0xb583b6033532360b,0xb4a4b61135923592,0xb56fb6063522360d,0xb493b611b5923592,0xb558b6083512360e
.quad 0xb483b61135923592,0xb541b60a3502360f,0xb465b612b5923592,0xb52ab60c34e4360f,0xb445b61235923592,0xb512b60e34c43610,0xb424b612b5923592,0xb4f4b60f34a43611
.quad 0xb403b61235923592,0xb4c4b61034833611,0xb3c5b612b5923592,0xb493b61134453612,0xb383b61235923592,0xb445b61234033612,0xb303b612b5923592,0xb3c5b61233833612
.quad 0xb5e535b6360fb502,0x3612357eb604,0xb5f135a63610b4c4,0xb46536123595b5fc,0xb5fc35953611b483,0xb4e4360f35a9b5ef,0xb60335833612b403,0xb52a360c35bdb5e0
.quad 0xb607356036120000,0xb560360735cfb5cf,0xb60b353936123403,0xb58a360135e0b5bd,0xb60e351236113483,0xb5a335f335efb5a9,0xb61034d4361034c4,0xb5ba35e235fcb595
.quad 0xb6113483360f3502,0xb5cf35cf3604b57e,0xb61233c5360d3522,0xb5e235ba3609b551,0xb612b383360a3541,0xb5f335a3360db522,0xb612b46536073560,0xb601358a360fb4e4
.quad 0xb610b4c43604357e,0xb60735603611b483,0xb60eb50a3600358e,0xb60c352a3612b383,0xb60bb53235f8359c,0xb60f34e436123403,0xb608b55835ef35a9,0xb6123465361134a4
.quad 0xb604b57e35e535b6,0xb6120000360f3502,0xb5feb59135da35c3,0xb612b465360b3532,0xb5f3b5a335cf35cf,0xb60fb4e436073560,0xb5e7b5b335c335da,0xb60cb52a36023586
.quad 0xb5dab5c335b635e5,0xb607b56035f8359c,0xb5ccb5d235a935ef,0xb601b58a35ea35b0,0xb5bdb5e0359c35f8,0xb5f3b5a335da35c3,0xb5adb5ec358e3600,0xb5e2b5ba35c935d5
.quad 0xb59cb5f8357e3604,0xb5cfb5cf35b635e5,0xb58ab60135603607,0xb5bab5e235a335f3,0xb56fb6063541360a,0xb5a3b5f3358e3600,0xb549b6093522360d,0xb58ab601356f3606
.quad 0xb522b60d3502360f,0xb560b6073541360a,0xb4f4b60f34c43610,0xb52ab60c3512360e,0xb4a4b61134833611,0xb4e4b60f34c43610,0xb424b61234033612,0xb465b61234453612
.quad 0xb61235923592,0xb61200003612,0x3303b612b5923592,0x33c5b612b3833612,0x3383b61235923592,0x3445b612b4033612,0x33c5b612b5923592,0x3493b611b4453612
.quad 0x3403b61235923592,0x34c4b610b4833611,0x3424b612b5923592,0x34f4b60fb4a43611,0x3445b61235923592,0x3512b60eb4c43610,0x3465b612b5923592,0x352ab60cb4e4360f
.quad 0x3483b61135923592,0x3541b60ab502360f,0x3493b611b5923592,0x3558b608b512360e,0x34a4b61135923592,0x356fb606b522360d,0x34b4b611b5923592,0x3583b603b532360b
.quad 0x34c4b61035923592,0x358eb600b541360a,0x34d4b610b5923592,0x3598b5fab5513609,0x34e4b60f35923592,0x35a3b5f3b5603607,0x34f4b60fb5923592,0x35adb5ecb56f3606
.quad 0x3502b60f35923592,0x35b6b5e5b57e3604,0x350ab60eb5923592,0x35c0b5ddb5863602,0x3512b60e35923592,0x35c9b5d5b58e3600,0x351ab60db5923592,0x35d2b5ccb59535fc
.quad 0x3522b60d35923592,0x35dab5c3b59c35f8,0x352ab60cb5923592,0x35e2b5bab5a335f3,0x3532b60b35923592,0x35eab5b0b5a935ef,0x3539b60bb5923592,0x35f1b5a6b5b035ea
.quad 0x3541b60a35923592,0x35f8b59cb5b635e5,0x3549b609b5923592,0x35feb591b5bd35e0,0x3551b60935923592,0x3602b586b5c335da,0x3558b608b5923592,0x3605b576b5c935d5
.quad 0x3560b60735923592,0x3607b560b5cf35cf,0x3567b606b5923592,0x3609b549b5d535c9,0x356fb60635923592,0x360bb532b5da35c3,0x3576b605b5923592,0x360db51ab5e035bd
.quad 0xb61200003612,0xb61200003612,0x3424b612b4033612,0x3465b612b4453612,0x34a4b611b4833611,0x34e4b60fb4c43610,0x34f4b60fb4c43610,0x352ab60cb512360e
.quad 0x3522b60db502360f,0x3560b607b541360a,0x3549b609b522360d,0x358ab601b56f3606,0x356fb606b541360a,0x35a3b5f3b58e3600,0x358ab601b5603607,0x35bab5e2b5a335f3
.quad 0x359cb5f8b57e3604,0x35cfb5cfb5b635e5,0x35adb5ecb58e3600,0x35e2b5bab5c935d5,0x35bdb5e0b59c35f8,0x35f3b5a3b5da35c3,0x35ccb5d2b5a935ef,0x3601b58ab5ea35b0
.quad 0x35dab5c3b5b635e5,0x3607b560b5f8359c,0x35e7b5b3b5c335da,0x360cb52ab6023586,0x35f3b5a3b5cf35cf,0x360fb4e4b6073560,0x35feb591b5da35c3,0x3612b465b60b3532
.quad 0x3604b57eb5e535b6,0x36120000b60f3502,0x3608b558b5ef35a9,0x36123465b61134a4,0x360bb532b5f8359c,0x360f34e4b6123403,0x360eb50ab600358e,0x360c352ab612b383
.quad 0x3610b4c4b604357e,0x36073560b611b483,0x3612b465b6073560,0x3601358ab60fb4e4,0x3612b383b60a3541,0x35f335a3b60db522,0x361233c5b60d3522,0x35e235bab609b551
.quad 0x36113483b60f3502,0x35cf35cfb604b57e,0x361034d4b61034c4,0x35ba35e2b5fcb595,0x360e3512b6113483,0x35a335f3b5efb5a9,0x360b3539b6123403,0x358a3601b5e0b5bd
.quad 0x36073560b6120000,0x35603607b5cfb5cf,0x36033583b612b403,0x352a360cb5bdb5e0,0x35fc3595b611b483,0x34e4360fb5a9b5ef,0x35f135a6b610b4c4,0x34653612b595b5fc
.quad 0x357eb60435923592,0x360fb502b5e535b6,0x3583b603b5923592,0x3610b4d4b5ea35b0,0x3586b60235923592,0x3611b4a4b5ef35a9,0x358ab601b5923592,0x3612b465b5f335a3
.quad 0x358eb60035923592,0x3612b403b5f8359c,0x3591b5feb5923592,0x3612b303b5fc3595,0x3595b5fc35923592,0x36123383b600358e,0x3598b5fab5923592,0x36123424b6023586
.quad 0x359cb5f835923592,0x36113483b604357e,0x359fb5f6b5923592,0x361134b4b606356f,0x35a3b5f335923592,0x360f34e4b6073560,0x35a6b5f1b5923592,0x360e350ab6093551
.quad 0x35a9b5ef35923592,0x360d3522b60a3541,0x35adb5ecb5923592,0x360b3539b60b3532,0x35b0b5ea35923592,0x36093551b60d3522,0x35b3b5e7b5923592,0x36063567b60e3512
.quad 0x35b6b5e535923592,0x3604357eb60f3502,0x35bab5e2b5923592,0x3601358ab60f34e4,0x35bdb5e035923592,0x35fc3595b61034c4,0x35c0b5ddb5923592,0x35f6359fb61134a4
.quad 0x35c3b5da35923592,0x35ef35a9b6113483,0x35c6b5d7b5923592,0x35e735b3b6123445,0x35c9b5d535923592,0x35e035bdb6123403,0x35ccb5d2b5923592,0x35d735c6b6123383
.quad 0x35cfb5cf35923592,0x35cf35cfb6120000,0x35d2b5ccb5923592,0x35c635d7b612b383,0x35d5b5c935923592,0x35bd35e0b612b403,0x35d7b5c6b5923592,0x35b335e7b612b445
.quad 0x35dab5c335923592,0x35a935efb611b483,0x35ddb5c0b5923592,0x359f35f6b611b4a4,0x35e0b5bd35923592,0x359535fcb610b4c4,0x35e2b5bab5923592,0x358a3601b60fb4e4
.quad 0x35e535b6b60fb502,0x3612b57eb604,0x35d735c6b60db522,0xb4653612b551b609,0x35c935d5b60ab541,0xb4e4360fb522b60d,0x35ba35e2b607b560,0xb52a360cb4e4b60f
.quad 0x35a935efb604b57e,0xb5603607b483b611,0x359835fab600b58e,0xb58a3601b383b612,0x35863602b5f8b59c,0xb5a335f33403b612,0x35673606b5efb5a9,0xb5ba35e234a4b611
.quad 0x3541360ab5e5b5b6,0xb5cf35cf3502b60f,0x351a360db5dab5c3,0xb5e235ba3532b60b,0x34e4360fb5cfb5cf,0xb5f335a33560b607,0x34933611b5c3b5da,0xb601358a3586b602
.quad 0x34033612b5b6b5e5,0xb6073560359cb5f8,0xb3033612b5a9b5ef,0xb60c352a35b0b5ea,0xb4453612b59cb5f8,0xb60f34e435c3b5da,0xb4b43611b58eb600,0xb612346535d5b5c9
.quad 0xb502360fb57eb604,0xb612000035e5b5b6,0xb52a360cb560b607,0xb612b46535f3b5a3,0xb5513609b541b60a,0xb60fb4e43600b58e,0xb5763605b522b60d,0xb60cb52a3606b56f
.quad 0xb58e3600b502b60f,0xb607b560360ab541,0xb59f35f6b4c4b610,0xb601b58a360eb512,0xb5b035eab483b611,0xb5f3b5a33610b4c4,0xb5c035ddb403b612,0xb5e2b5ba3612b445
.quad 0xb5cf35cf0000b612,0xb5cfb5cf36120000,0xb5dd35c03403b612,0xb5bab5e236123445,0xb5ea35b03483b611,0xb5a3b5f3361034c4,0xb5f6359f34c4b610,0xb58ab601360e3512
.quad 0xb600358e3502b60f,0xb560b607360a3541,0xb60535763522b60d,0xb52ab60c3606356f,0xb60935513541b60a,0xb4e4b60f3600358e,0xb60c352a3560b607,0xb465b61235f335a3
.quad 0x35e5b5b635923592,0x357e3604b60fb502,0x35e7b5b3b5923592,0x35673606b60eb512,0x35eab5b035923592,0x35513609b60db522,0x35ecb5adb5923592,0x3539360bb60bb532
.quad 0x35efb5a935923592,0x3522360db60ab541,0x35f1b5a6b5923592,0x350a360eb609b551,0x35f3b5a335923592,0x34e4360fb607b560,0x35f6b59fb5923592,0x34b43611b606b56f
.quad 0x35f8b59c35923592,0x34833611b604b57e,0x35fab598b5923592,0x34243612b602b586,0x35fcb59535923592,0x33833612b600b58e,0x35feb591b5923592,0xb3033612b5fcb595
.quad 0x3600b58e35923592,0xb4033612b5f8b59c,0x3601b58ab5923592,0xb4653612b5f3b5a3,0x3602b58635923592,0xb4a43611b5efb5a9,0x3603b583b5923592,0xb4d43610b5eab5b0
.quad 0x3604b57e35923592,0xb502360fb5e5b5b6,0x3605b576b5923592,0xb51a360db5e0b5bd,0x3606b56f35923592,0xb532360bb5dab5c3,0x3606b567b5923592,0xb5493609b5d5b5c9
.quad 0x3607b56035923592,0xb5603607b5cfb5cf,0x3608b558b5923592,0xb5763605b5c9b5d5,0x3609b55135923592,0xb5863602b5c3b5da,0x3609b549b5923592,0xb59135feb5bdb5e0
.quad 0x360ab54135923592,0xb59c35f8b5b6b5e5,0x360bb539b5923592,0xb5a635f1b5b0b5ea,0x360bb53235923592,0xb5b035eab5a9b5ef,0x360cb52ab5923592,0xb5ba35e2b5a3b5f3
.quad 0x360db52235923592,0xb5c335dab59cb5f8,0x360db51ab5923592,0xb5cc35d2b595b5fc,0x360eb51235923592,0xb5d535c9b58eb600,0x360eb50ab5923592,0xb5dd35c0b586b602
.quad 0xb60f3502357eb604,0xb61235e535b6,0xb61134b4358eb600,0x3465b61235d535c9,0xb6123445359cb5f8,0x34e4b60f35c335da,0xb612330335a9b5ef,0x352ab60c35b035ea
.quad 0xb612b40335b6b5e5,0x3560b607359c35f8,0xb611b49335c3b5da,0x358ab60135863602,0xb60fb4e435cfb5cf,0x35a3b5f335603607,0xb60db51a35dab5c3,0x35bab5e23532360b
.quad 0xb60ab54135e5b5b6,0x35cfb5cf3502360f,0xb606b56735efb5a9,0x35e2b5ba34a43611,0xb602b58635f8b59c,0x35f3b5a334033612,0xb5fab5983600b58e,0x3601b58ab3833612
.quad 0xb5efb5a93604b57e,0x3607b560b4833611,0xb5e2b5ba3607b560,0x360cb52ab4e4360f,0xb5d5b5c9360ab541,0x360fb4e4b522360d,0xb5c6b5d7360db522,0x3612b465b5513609
.quad 0xb5b6b5e5360fb502,0x36120000b57e3604,0xb5a6b5f13610b4c4,0x36123465b59535fc,0xb595b5fc3611b483,0x360f34e4b5a935ef,0xb583b6033612b403,0x360c352ab5bd35e0
.quad 0xb560b60736120000,0x36073560b5cf35cf,0xb539b60b36123403,0x3601358ab5e035bd,0xb512b60e36113483,0x35f335a3b5ef35a9,0xb4d4b610361034c4,0x35e235bab5fc3595
.quad 0xb483b611360f3502,0x35cf35cfb604357e,0xb3c5b612360d3522,0x35ba35e2b6093551,0x3383b612360a3541,0x35a335f3b60d3522,0x3465b61236073560,0x358a3601b60f34e4
.quad 0x34c4b6103604357e,0x35603607b6113483,0x350ab60e3600358e,0x352a360cb6123383,0x3532b60b35f8359c,0x34e4360fb612b403,0x3558b60835ef35a9,0x34653612b611b4a4
.quad 0x360fb50235923592,0xb5e535b6b57eb604,0x360fb4f4b5923592,0xb5ec35adb56fb606,0x360fb4e435923592,0xb5f335a3b560b607,0x3610b4d4b5923592,0xb5fa3598b551b609
.quad 0x3610b4c435923592,0xb600358eb541b60a,0x3611b4b4b5923592,0xb6033583b532b60b,0x3611b4a435923592,0xb606356fb522b60d,0x3611b493b5923592,0xb6083558b512b60e
.quad 0x3611b48335923592,0xb60a3541b502b60f,0x3612b465b5923592,0xb60c352ab4e4b60f,0x3612b44535923592,0xb60e3512b4c4b610,0x3612b424b5923592,0xb60f34f4b4a4b611
.quad 0x3612b40335923592,0xb61034c4b483b611,0x3612b3c5b5923592,0xb6113493b445b612,0x3612b38335923592,0xb6123445b403b612,0x3612b303b5923592,0xb61233c5b383b612
.quad 0x3612000035923592,0xb61200000000b612,0x36123303b5923592,0xb612b3c53383b612,0x3612338335923592,0xb612b4453403b612,0x361233c5b5923592,0xb611b4933445b612
.quad 0x3612340335923592,0xb610b4c43483b611,0x36123424b5923592,0xb60fb4f434a4b611,0x3612344535923592,0xb60eb51234c4b610,0x36123465b5923592,0xb60cb52a34e4b60f
.quad 0x3611348335923592,0xb60ab5413502b60f,0x36113493b5923592,0xb608b5583512b60e,0x361134a435923592,0xb606b56f3522b60d,0x361134b4b5923592,0xb603b5833532b60b
.quad 0x361034c435923592,0xb600b58e3541b60a,0x361034d4b5923592,0xb5fab5983551b609,0x360f34e435923592,0xb5f3b5a33560b607,0x360f34f4b5923592,0xb5ecb5ad356fb606
.quad 0x357eb60435e535b6,0x3612b60fb502,0x3591b5fe35da35c3,0xb4653612b60bb532,0x35a3b5f335cf35cf,0xb4e4360fb607b560,0x35b3b5e735c335da,0xb52a360cb602b586
.quad 0x35c3b5da35b635e5,0xb5603607b5f8b59c,0x35d2b5cc35a935ef,0xb58a3601b5eab5b0,0x35e0b5bd359c35f8,0xb5a335f3b5dab5c3,0x35ecb5ad358e3600,0xb5ba35e2b5c9b5d5
.quad 0x35f8b59c357e3604,0xb5cf35cfb5b6b5e5,0x3601b58a35603607,0xb5e235bab5a3b5f3,0x3606b56f3541360a,0xb5f335a3b58eb600,0x3609b5493522360d,0xb601358ab56fb606
.quad 0x360db5223502360f,0xb6073560b541b60a,0x360fb4f434c43610,0xb60c352ab512b60e,0x3611b4a434833611,0xb60f34e4b4c4b610,0x3612b42434033612,0xb6123465b445b612
.quad 0x3612000000003612,0xb61200000000b612,0x36123424b4033612,0xb612b4653445b612,0x361134a4b4833611,0xb60fb4e434c4b610,0x360f34f4b4c43610,0xb60cb52a3512b60e
.quad 0x360d3522b502360f,0xb607b5603541b60a,0x36093549b522360d,0xb601b58a356fb606,0x3606356fb541360a,0xb5f3b5a3358eb600,0x3601358ab5603607,0xb5e2b5ba35a3b5f3
.quad 0x35f8359cb57e3604,0xb5cfb5cf35b6b5e5,0x35ec35adb58e3600,0xb5bab5e235c9b5d5,0x35e035bdb59c35f8,0xb5a3b5f335dab5c3,0x35d235ccb5a935ef,0xb58ab60135eab5b0
.quad 0x35c335dab5b635e5,0xb560b60735f8b59c,0x35b335e7b5c335da,0xb52ab60c3602b586,0x35a335f3b5cf35cf,0xb4e4b60f3607b560,0x359135feb5da35c3,0xb465b612360bb532
.quad 0x360f350235923592,0xb5e5b5b6357eb604,0x360e350ab5923592,0xb5ddb5c03586b602,0x360e351235923592,0xb5d5b5c9358eb600,0x360d351ab5923592,0xb5ccb5d23595b5fc
.quad 0x360d352235923592,0xb5c3b5da359cb5f8,0x360c352ab5923592,0xb5bab5e235a3b5f3,0x360b353235923592,0xb5b0b5ea35a9b5ef,0x360b3539b5923592,0xb5a6b5f135b0b5ea
.quad 0x360a354135923592,0xb59cb5f835b6b5e5,0x36093549b5923592,0xb591b5fe35bdb5e0,0x3609355135923592,0xb586b60235c3b5da,0x36083558b5923592,0xb576b60535c9b5d5
.quad 0x3607356035923592,0xb560b60735cfb5cf,0x36063567b5923592,0xb549b60935d5b5c9,0x3606356f35923592,0xb532b60b35dab5c3,0x36053576b5923592,0xb51ab60d35e0b5bd
.quad 0x3604357e35923592,0xb502b60f35e5b5b6,0x36033583b5923592,0xb4d4b61035eab5b0,0x3602358635923592,0xb4a4b61135efb5a9,0x3601358ab5923592,0xb465b61235f3b5a3
.quad 0x3600358e35923592,0xb403b61235f8b59c,0x35fe3591b5923592,0xb303b61235fcb595,0x35fc359535923592,0x3383b6123600b58e,0x35fa3598b5923592,0x3424b6123602b586
.quad 0x35f8359c35923592,0x3483b6113604b57e,0x35f6359fb5923592,0x34b4b6113606b56f,0x35f335a335923592,0x34e4b60f3607b560,0x35f135a6b5923592,0x350ab60e3609b551
.quad 0x35ef35a935923592,0x3522b60d360ab541,0x35ec35adb5923592,0x3539b60b360bb532,0x35ea35b035923592,0x3551b609360db522,0x35e735b3b5923592,0x3567b606360eb512
.quad 0x357e3604b5e535b6,0xb612360fb502,0x35583608b5ef35a9,0x3465b6123611b4a4,0x3532360bb5f8359c,0x34e4b60f3612b403,0x350a360eb600358e,0x352ab60c36123383
.quad 0x34c43610b604357e,0x3560b60736113483,0x34653612b6073560,0x358ab601360f34e4,0x33833612b60a3541,0x35a3b5f3360d3522,0xb3c53612b60d3522,0x35bab5e236093551
.quad 0xb4833611b60f3502,0x35cfb5cf3604357e,0xb4d43610b61034c4,0x35e2b5ba35fc3595,0xb512360eb6113483,0x35f3b5a335ef35a9,0xb539360bb6123403,0x3601b58a35e035bd
.quad 0xb5603607b6120000,0x3607b56035cf35cf,0xb5833603b612b403,0x360cb52a35bd35e0,0xb59535fcb611b483,0x360fb4e435a935ef,0xb5a635f1b610b4c4,0x3612b465359535fc
.quad 0xb5b635e5b60fb502,0x36120000357e3604,0xb5c635d7b60db522,0x3612346535513609,0xb5d535c9b60ab541,0x360f34e43522360d,0xb5e235bab607b560,0x360c352a34e4360f
.quad 0xb5ef35a9b604b57e,0x3607356034833611,0xb5fa3598b600b58e,0x3601358a33833612,0xb6023586b5f8b59c,0x35f335a3b4033612,0xb6063567b5efb5a9,0x35e235bab4a43611
.quad 0xb60a3541b5e5b5b6,0x35cf35cfb502360f,0xb60d351ab5dab5c3,0x35ba35e2b532360b,0xb60f34e4b5cfb5cf,0x35a335f3b5603607,0xb6113493b5c3b5da,0x358a3601b5863602
.quad 0xb6123403b5b6b5e5,0x35603607b59c35f8,0xb612b303b5a9b5ef,0x352a360cb5b035ea,0xb612b445b59cb5f8,0x34e4360fb5c335da,0xb611b4b4b58eb600,0x34653612b5d535c9
.quad 0x35e535b635923592,0x357eb604360fb502,0x35e235bab5923592,0x358ab601360fb4e4,0x35e035bd35923592,0x3595b5fc3610b4c4,0x35dd35c0b5923592,0x359fb5f63611b4a4
.quad 0x35da35c335923592,0x35a9b5ef3611b483,0x35d735c6b5923592,0x35b3b5e73612b445,0x35d535c935923592,0x35bdb5e03612b403,0x35d235ccb5923592,0x35c6b5d73612b383
.quad 0x35cf35cf35923592,0x35cfb5cf36120000,0x35cc35d2b5923592,0x35d7b5c636123383,0x35c935d535923592,0x35e0b5bd36123403,0x35c635d7b5923592,0x35e7b5b336123445
.quad 0x35c335da35923592,0x35efb5a936113483,0x35c035ddb5923592,0x35f6b59f361134a4,0x35bd35e035923592,0x35fcb595361034c4,0x35ba35e2b5923592,0x3601b58a360f34e4
.quad 0x35b635e535923592,0x3604b57e360f3502,0x35b335e7b5923592,0x3606b567360e3512,0x35b035ea35923592,0x3609b551360d3522,0x35ad35ecb5923592,0x360bb539360b3532
.quad 0x35a935ef35923592,0x360db522360a3541,0x35a635f1b5923592,0x360eb50a36093551,0x35a335f335923592,0x360fb4e436073560,0x359f35f6b5923592,0x3611b4b43606356f
.quad 0x359c35f835923592,0x3611b4833604357e,0x359835fab5923592,0x3612b42436023586,0x359535fc35923592,0x3612b3833600358e,0x359135feb5923592,0x3612330335fc3595
.quad 0x358e360035923592,0x3612340335f8359c,0x358a3601b5923592,0x3612346535f335a3,0x3586360235923592,0x361134a435ef35a9,0x35833603b5923592,0x361034d435ea35b0
.quad 0xb60fb502b57eb604,0x3612b5e535b6,0xb60cb52ab560b607,0xb4653612b5f335a3,0xb609b551b541b60a,0xb4e4360fb600358e,0xb605b576b522b60d,0xb52a360cb606356f
.quad 0xb600b58eb502b60f,0xb5603607b60a3541,0xb5f6b59fb4c4b610,0xb58a3601b60e3512,0xb5eab5b0b483b611,0xb5a335f3b61034c4,0xb5ddb5c0b403b612,0xb5ba35e2b6123445
.quad 0xb5cfb5cf0000b612,0xb5cf35cfb6120000,0xb5c0b5dd3403b612,0xb5e235bab612b445,0xb5b0b5ea3483b611,0xb5f335a3b610b4c4,0xb59fb5f634c4b610,0xb601358ab60eb512
.quad 0xb58eb6003502b60f,0xb6073560b60ab541,0xb576b6053522b60d,0xb60c352ab606b56f,0xb551b6093541b60a,0xb60f34e4b600b58e,0xb52ab60c3560b607,0xb6123465b5f3b5a3
.quad 0xb502b60f357eb604,0xb6120000b5e5b5b6,0xb4b4b611358eb600,0xb612b465b5d5b5c9,0xb445b612359cb5f8,0xb60fb4e4b5c3b5da,0xb303b61235a9b5ef,0xb60cb52ab5b0b5ea
.quad 0x3403b61235b6b5e5,0xb607b560b59cb5f8,0x3493b61135c3b5da,0xb601b58ab586b602,0x34e4b60f35cfb5cf,0xb5f3b5a3b560b607,0x351ab60d35dab5c3,0xb5e2b5bab532b60b
.quad 0x3541b60a35e5b5b6,0xb5cfb5cfb502b60f,0x3567b60635efb5a9,0xb5bab5e2b4a4b611,0x3586b60235f8b59c,0xb5a3b5f3b403b612,0x3598b5fa3600b58e,0xb58ab6013383b612
.quad 0x35a9b5ef3604b57e,0xb560b6073483b611,0x35bab5e23607b560,0xb52ab60c34e4b60f,0x35c9b5d5360ab541,0xb4e4b60f3522b60d,0x35d7b5c6360db522,0xb465b6123551b609
.quad 0x357e360435923592,0x360f350235e535b6,0x35763605b5923592,0x360d351a35e035bd,0x356f360635923592,0x360b353235da35c3,0x35673606b5923592,0x3609354935d535c9
.quad 0x3560360735923592,0x3607356035cf35cf,0x35583608b5923592,0x3605357635c935d5,0x3551360935923592,0x3602358635c335da,0x35493609b5923592,0x35fe359135bd35e0
.quad 0x3541360a35923592,0x35f8359c35b635e5,0x3539360bb5923592,0x35f135a635b035ea,0x3532360b35923592,0x35ea35b035a935ef,0x352a360cb5923592,0x35e235ba35a335f3
.quad 0x3522360d35923592,0x35da35c3359c35f8,0x351a360db5923592,0x35d235cc359535fc,0x3512360e35923592,0x35c935d5358e3600,0x350a360eb5923592,0x35c035dd35863602
.quad 0x3502360f35923592,0x35b635e5357e3604,0x34f4360fb5923592,0x35ad35ec356f3606,0x34e4360f35923592,0x35a335f335603607,0x34d43610b5923592,0x359835fa35513609
.quad 0x34c4361035923592,0x358e36003541360a,0x34b43611b5923592,0x358336033532360b,0x34a4361135923592,0x356f36063522360d,0x34933611b5923592,0x355836083512360e
.quad 0x3483361135923592,0x3541360a3502360f,0x34653612b5923592,0x352a360c34e4360f,0x3445361235923592,0x3512360e34c43610,0x34243612b5923592,0x34f4360f34a43611
.quad 0x3403361235923592,0x34c4361034833611,0x33c53612b5923592,0x3493361134453612,0x3383361235923592,0x3445361234033612,0x33033612b5923592,0x33c5361233833612
.quad 0x35e5b5b6360fb502,0xb612357eb604,0x35f1b5a63610b4c4,0x3465b6123595b5fc,0x35fcb5953611b483,0x34e4b60f35a9b5ef,0x3603b5833612b403,0x352ab60c35bdb5e0
.quad 0x3607b56036120000,0x3560b60735cfb5cf,0x360bb53936123403,0x358ab60135e0b5bd,0x360eb51236113483,0x35a3b5f335efb5a9,0x3610b4d4361034c4,0x35bab5e235fcb595
.quad 0x3611b483360f3502,0x35cfb5cf3604b57e,0x3612b3c5360d3522,0x35e2b5ba3609b551,0x36123383360a3541,0x35f3b5a3360db522,0x3612346536073560,0x3601b58a360fb4e4
.quad 0x361034c43604357e,0x3607b5603611b483,0x360e350a3600358e,0x360cb52a3612b383,0x360b353235f8359c,0x360fb4e436123403,0x3608355835ef35a9,0x3612b465361134a4
.quad 0x3604357e35e535b6,0x36120000360f3502,0x35fe359135da35c3,0x36123465360b3532,0x35f335a335cf35cf,0x360f34e436073560,0x35e735b335c335da,0x360c352a36023586
.quad 0x35da35c335b635e5,0x3607356035f8359c,0x35cc35d235a935ef,0x3601358a35ea35b0,0x35bd35e0359c35f8,0x35f335a335da35c3,0x35ad35ec358e3600,0x35e235ba35c935d5
.quad 0x359c35f8357e3604,0x35cf35cf35b635e5,0x358a360135603607,0x35ba35e235a335f3,0x356f36063541360a,0x35a335f3358e3600,0x354936093522360d,0x358a3601356f3606
.quad 0x3522360d3502360f,0x356036073541360a,0x34f4360f34c43610,0x352a360c3512360e,0x34a4361134833611,0x34e4360f34c43610,0x3424361234033612,0x3465361234453612
iblk 1
iblk 2
iblk 3
iblk 4
iblk 5
iblk 6
iblk 7
iblk 8
iblk 9
iblk 10
iblk 11
iblk 12
iblk 13
iblk 14
iblk 15
iblk 16
iblk 17
iblk 18
iblk 19
iblk 20
iblk 21
iblk 22
iblk 23
iblk 24
iblk 25
iblk 26
iblk 27
.noaltmacro
.quad 0x3f803f803f803f80,0x0,0x3f553f6d3f7b3f80,0x3f0e3ec43e480000,0x3ec43f353f6d3f80,0x3f6d3f353ec40000,0xbe483ec43f553f80,0x3f7b3f6d3f0e0000
.quad 0xbf3500003f353f80,0x3f353f803f350000,0xbf7bbec43f0e3f80,0x3e483f6d3f550000,0xbf6dbf353ec43f80,0xbec43f353f6d0000,0xbf0ebf6d3e483f80,0xbf553ec43f7b0000
.quad 0xbf8000003f80,0xbf8000003f800000,0x3f0ebf6dbe483f80,0xbf55bec43f7b0000,0x3f6dbf35bec43f80,0xbec4bf353f6d0000,0x3f7bbec4bf0e3f80,0x3e48bf6d3f550000
.quad 0x3f350000bf353f80,0x3f35bf803f350000,0x3e483ec4bf553f80,0x3f7bbf6d3f0e0000,0xbec43f35bf6d3f80,0x3f6dbf353ec40000,0xbf553f6dbf7b3f80,0x3f0ebec43e480000
.quad 0x3f803f803f803f80,0x0,0x3e483ec43f0e3f35,0x3f7b3f6d3f553f35,0xbf6dbf35bec40000,0x3ec43f353f6d3f80,0xbf0ebf6dbf7bbf35,0xbf55bec43e483f35
.quad 0x3f350000bf35bf80,0xbf35bf80bf350000,0x3f553f6d3e48bf35,0x3f0ebec4bf7bbf35,0xbec43f353f6d0000,0x3f6d3f35bec4bf80,0xbf7bbec43f553f35,0xbe483f6d3f0ebf35
.quad 0xbf8000003f80,0xbf8000003f800000,0x3f7bbec4bf553f35,0xbe48bf6d3f0e3f35,0x3ec43f35bf6d0000,0x3f6dbf35bec43f80,0xbf553f6dbe48bf35,0x3f0e3ec4bf7b3f35
.quad 0xbf3500003f35bf80,0xbf353f80bf350000,0x3f0ebf6d3f7bbf35,0xbf553ec43e48bf35,0x3f6dbf353ec40000,0x3ec4bf353f6dbf80,0xbe483ec4bf0e3f35,0x3f7bbf6d3f55bf35
.quad 0x3f803f803f803f80,0x0,0xbf0ebec4be480000,0x3f553f6d3f7b3f80,0xbec4bf35bf6dbf80,0xbf6dbf35bec40000,0x3f7b3f6d3f0e0000,0x3e48bec4bf55bf80
.quad 0xbf3500003f353f80,0x3f353f803f350000,0xbe48bf6dbf550000,0xbf7bbec43f0e3f80,0x3f6d3f35bec4bf80,0x3ec4bf35bf6d0000,0xbf553ec43f7b0000,0x3f0e3f6dbe48bf80
.quad 0xbf8000003f80,0xbf8000003f800000,0x3f553ec4bf7b0000,0x3f0ebf6dbe483f80,0xbf6d3f353ec4bf80,0x3ec43f35bf6d0000,0x3e48bf6d3f550000,0xbf7b3ec43f0ebf80
.quad 0x3f350000bf353f80,0x3f35bf803f350000,0xbf7b3f6dbf0e0000,0x3e483ec4bf553f80,0x3ec4bf353f6dbf80,0xbf6d3f35bec40000,0x3f0ebec43e480000,0x3f55bf6d3f7bbf80
.quad 0x3f803f803f803f80,0x0,0xbf7bbf6dbf55bf35,0x3e483ec43f0e3f35,0x3f6d3f353ec40000,0xbec4bf35bf6dbf80,0xbf55bec43e483f35,0x3f0e3f6d3f7b3f35
.quad 0x3f350000bf35bf80,0xbf35bf80bf350000,0xbf0e3ec43f7b3f35,0x3f553f6d3e48bf35,0x3ec4bf35bf6d0000,0xbf6dbf353ec43f80,0xbe483f6d3f0ebf35,0x3f7b3ec4bf55bf35
.quad 0xbf8000003f80,0xbf8000003f800000,0x3e483f6dbf0ebf35,0x3f7bbec4bf553f35,0xbec4bf353f6d0000,0xbf6d3f353ec4bf80,0x3f0e3ec4bf7b3f35,0x3f55bf6d3e483f35
.quad 0xbf3500003f35bf80,0xbf353f80bf350000,0x3f55bec4be483f35,0x3f0ebf6d3f7bbf35,0xbf6d3f35bec40000,0xbec43f35bf6d3f80,0x3f7bbf6d3f55bf35,0x3e48bec43f0ebf35
.quad 0x3f803f803f803f80,0x0,0xbf55bf6dbf7bbf80,0xbf0ebec4be480000,0x3ec43f353f6d3f80,0x3f6d3f353ec40000,0x3e48bec4bf55bf80,0xbf7bbf6dbf0e0000
.quad 0xbf3500003f353f80,0x3f353f803f350000,0x3f7b3ec4bf0ebf80,0xbe48bf6dbf550000,0xbf6dbf353ec43f80,0xbec43f353f6d0000,0x3f0e3f6dbe48bf80,0x3f55bec4bf7b0000
.quad 0xbf8000003f80,0xbf8000003f800000,0xbf0e3f6d3e48bf80,0x3f553ec4bf7b0000,0x3f6dbf35bec43f80,0xbec4bf353f6d0000,0xbf7b3ec43f0ebf80,0xbe483f6dbf550000
.quad 0x3f350000bf353f80,0x3f35bf803f350000,0xbe48bec43f55bf80,0xbf7b3f6dbf0e0000,0xbec43f35bf6d3f80,0x3f6dbf353ec40000,0x3f55bf6d3f7bbf80,0xbf0e3ec4be480000
.quad 0x3f803f803f803f80,0x0,0xbe48bec4bf0ebf35,0xbf7bbf6dbf55bf35,0xbf6dbf35bec40000,0x3ec43f353f6d3f80,0x3f0e3f6d3f7b3f35,0x3f553ec4be48bf35
.quad 0x3f350000bf35bf80,0xbf35bf80bf350000,0xbf55bf6dbe483f35,0xbf0e3ec43f7b3f35,0xbec43f353f6d0000,0x3f6d3f35bec4bf80,0x3f7b3ec4bf55bf35,0x3e48bf6dbf0e3f35
.quad 0xbf8000003f80,0xbf8000003f800000,0xbf7b3ec43f55bf35,0x3e483f6dbf0ebf35,0x3ec43f35bf6d0000,0x3f6dbf35bec43f80,0x3f55bf6d3e483f35,0xbf0ebec43f7bbf35
.quad 0xbf3500003f35bf80,0xbf353f80bf350000,0xbf0e3f6dbf7b3f35,0x3f55bec4be483f35,0x3f6dbf353ec40000,0x3ec4bf353f6dbf80,0x3e48bec43f0ebf35,0xbf7b3f6dbf553f35
.quad 0x3f803f803f803f80,0x0,0x3f0e3ec43e480000,0xbf55bf6dbf7bbf80,0xbec4bf35bf6dbf80,0xbf6dbf35bec40000,0xbf7bbf6dbf0e0000,0xbe483ec43f553f80
.quad 0xbf3500003f353f80,0x3f353f803f350000,0x3e483f6d3f550000,0x3f7b3ec4bf0ebf80,0x3f6d3f35bec4bf80,0x3ec4bf35bf6d0000,0x3f55bec4bf7b0000,0xbf0ebf6d3e483f80
.quad 0xbf8000003f80,0xbf8000003f800000,0xbf55bec43f7b0000,0xbf0e3f6d3e48bf80,0xbf6d3f353ec4bf80,0x3ec43f35bf6d0000,0xbe483f6dbf550000,0x3f7bbec4bf0e3f80
.quad 0x3f350000bf353f80,0x3f35bf803f350000,0x3f7bbf6d3f0e0000,0xbe48bec43f55bf80,0x3ec4bf353f6dbf80,0xbf6d3f35bec40000,0xbf0e3ec4be480000,0xbf553f6dbf7b3f80
.quad 0x3f803f803f803f80,0x0,0x3f7b3f6d3f553f35,0xbe48bec4bf0ebf35,0x3f6d3f353ec40000,0xbec4bf35bf6dbf80,0x3f553ec4be48bf35,0xbf0ebf6dbf7bbf35
.quad 0x3f350000bf35bf80,0xbf35bf80bf350000,0x3f0ebec4bf7bbf35,0xbf55bf6dbe483f35,0x3ec4bf35bf6d0000,0xbf6dbf353ec43f80,0x3e48bf6dbf0e3f35,0xbf7bbec43f553f35
.quad 0xbf8000003f80,0xbf8000003f800000,0xbe48bf6d3f0e3f35,0xbf7b3ec43f55bf35,0xbec4bf353f6d0000,0xbf6d3f353ec4bf80,0xbf0ebec43f7bbf35,0xbf553f6dbe48bf35
.quad 0xbf3500003f35bf80,0xbf353f80bf350000,0xbf553ec43e48bf35,0xbf0e3f6dbf7b3f35,0xbf6d3f35bec40000,0xbec43f35bf6d3f80,0xbf7b3f6dbf553f35,0xbe483ec4bf0e3f35
.quad 0xbf803f80bf803f80,0x0,0xbf553f6dbf7b3f80,0xbf0e3ec4be480000,0xbec43f35bf6d3f80,0xbf6d3f35bec40000,0x3e483ec4bf553f80,0xbf7b3f6dbf0e0000
.quad 0x3f350000bf353f80,0xbf353f80bf350000,0x3f7bbec4bf0e3f80,0xbe483f6dbf550000,0x3f6dbf35bec43f80,0x3ec43f35bf6d0000,0x3f0ebf6dbe483f80,0x3f553ec4bf7b0000
.quad 0xbf8000003f80,0x3f800000bf800000,0xbf0ebf6d3e483f80,0x3f55bec4bf7b0000,0xbf6dbf353ec43f80,0x3ec4bf35bf6d0000,0xbf7bbec43f0e3f80,0xbe48bf6dbf550000
.quad 0xbf3500003f353f80,0xbf35bf80bf350000,0xbe483ec43f553f80,0xbf7bbf6dbf0e0000,0x3ec43f353f6d3f80,0xbf6dbf35bec40000,0x3f553f6d3f7b3f80,0xbf0ebec4be480000
.quad 0xbf803f80bf803f80,0x0,0xbe483ec4bf0e3f35,0xbf7b3f6dbf553f35,0x3f6dbf353ec40000,0xbec43f35bf6d3f80,0x3f0ebf6d3f7bbf35,0x3f55bec4be483f35
.quad 0xbf3500003f35bf80,0x3f35bf803f350000,0xbf553f6dbe48bf35,0xbf0ebec43f7bbf35,0x3ec43f35bf6d0000,0xbf6d3f353ec4bf80,0x3f7bbec4bf553f35,0x3e483f6dbf0ebf35
.quad 0xbf8000003f80,0x3f800000bf800000,0xbf7bbec43f553f35,0x3e48bf6dbf0e3f35,0xbec43f353f6d0000,0xbf6dbf353ec43f80,0x3f553f6d3e48bf35,0xbf0e3ec43f7b3f35
.quad 0x3f350000bf35bf80,0x3f353f803f350000,0xbf0ebf6dbf7bbf35,0x3f553ec4be48bf35,0xbf6dbf35bec40000,0xbec4bf35bf6dbf80,0x3e483ec43f0e3f35,0xbf7bbf6dbf55bf35
.quad 0xbf803f80bf803f80,0x0,0x3f0ebec43e480000,0xbf553f6dbf7b3f80,0x3ec4bf353f6dbf80,0x3f6dbf353ec40000,0xbf7b3f6dbf0e0000,0xbe48bec43f55bf80
.quad 0x3f350000bf353f80,0xbf353f80bf350000,0x3e48bf6d3f550000,0x3f7bbec4bf0e3f80,0xbf6d3f353ec4bf80,0xbec4bf353f6d0000,0x3f553ec4bf7b0000,0xbf0e3f6d3e48bf80
.quad 0xbf8000003f80,0x3f800000bf800000,0xbf553ec43f7b0000,0xbf0ebf6d3e483f80,0x3f6d3f35bec4bf80,0xbec43f353f6d0000,0xbe48bf6dbf550000,0x3f7b3ec4bf0ebf80
.quad 0xbf3500003f353f80,0xbf35bf80bf350000,0x3f7b3f6d3f0e0000,0xbe483ec43f553f80,0xbec4bf35bf6dbf80,0x3f6d3f353ec40000,0xbf0ebec4be480000,0xbf55bf6dbf7bbf80
.quad 0xbf803f80bf803f80,0x0,0x3f7bbf6d3f55bf35,0xbe483ec4bf0e3f35,0xbf6d3f35bec40000,0x3ec4bf353f6dbf80,0x3f55bec4be483f35,0xbf0e3f6dbf7b3f35
.quad 0xbf3500003f35bf80,0x3f35bf803f350000,0x3f0e3ec4bf7b3f35,0xbf553f6dbe48bf35,0xbec4bf353f6d0000,0x3f6dbf35bec43f80,0x3e483f6dbf0ebf35,0xbf7b3ec43f55bf35
.quad 0xbf8000003f80,0x3f800000bf800000,0xbe483f6d3f0ebf35,0xbf7bbec43f553f35,0x3ec4bf35bf6d0000,0x3f6d3f35bec4bf80,0xbf0e3ec43f7b3f35,0xbf55bf6dbe483f35
.quad 0x3f350000bf35bf80,0x3f353f803f350000,0xbf55bec43e483f35,0xbf0ebf6dbf7bbf35,0x3f6d3f353ec40000,0x3ec43f353f6d3f80,0xbf7bbf6dbf55bf35,0xbe48bec4bf0ebf35
.quad 0xbf803f80bf803f80,0x0,0x3f55bf6d3f7bbf80,0x3f0ebec43e480000,0xbec43f35bf6d3f80,0xbf6d3f35bec40000,0xbe48bec43f55bf80,0x3f7bbf6d3f0e0000
.quad 0x3f350000bf353f80,0xbf353f80bf350000,0xbf7b3ec43f0ebf80,0x3e48bf6d3f550000,0x3f6dbf35bec43f80,0x3ec43f35bf6d0000,0xbf0e3f6d3e48bf80,0xbf55bec43f7b0000
.quad 0xbf8000003f80,0x3f800000bf800000,0x3f0e3f6dbe48bf80,0xbf553ec43f7b0000,0xbf6dbf353ec43f80,0x3ec4bf35bf6d0000,0x3f7b3ec4bf0ebf80,0x3e483f6d3f550000
.quad 0xbf3500003f353f80,0xbf35bf80bf350000,0x3e48bec4bf55bf80,0x3f7b3f6d3f0e0000,0x3ec43f353f6d3f80,0xbf6dbf35bec40000,0xbf55bf6dbf7bbf80,0x3f0e3ec43e480000
.quad 0xbf803f80bf803f80,0x0,0x3e48bec43f0ebf35,0x3f7bbf6d3f55bf35,0x3f6dbf353ec40000,0xbec43f35bf6d3f80,0xbf0e3f6dbf7b3f35,0xbf553ec43e48bf35
.quad 0xbf3500003f35bf80,0x3f35bf803f350000,0x3f55bf6d3e483f35,0x3f0e3ec4bf7b3f35,0x3ec43f35bf6d0000,0xbf6d3f353ec4bf80,0xbf7b3ec43f55bf35,0xbe48bf6d3f0e3f35
.quad 0xbf8000003f80,0x3f800000bf800000,0x3f7b3ec4bf55bf35,0xbe483f6d3f0ebf35,0xbec43f353f6d0000,0xbf6dbf353ec43f80,0xbf55bf6dbe483f35,0x3f0ebec4bf7bbf35
.quad 0x3f350000bf35bf80,0x3f353f803f350000,0x3f0e3f6d3f7b3f35,0xbf55bec43e483f35,0xbf6dbf35bec40000,0xbec4bf35bf6dbf80,0xbe48bec4bf0ebf35,0x3f7b3f6d3f553f35
.quad 0xbf803f80bf803f80,0x0,0xbf0e3ec4be480000,0x3f55bf6d3f7bbf80,0x3ec4bf353f6dbf80,0x3f6dbf353ec40000,0x3f7bbf6d3f0e0000,0x3e483ec4bf553f80
.quad 0x3f350000bf353f80,0xbf353f80bf350000,0xbe483f6dbf550000,0xbf7b3ec43f0ebf80,0xbf6d3f353ec4bf80,0xbec4bf353f6d0000,0xbf55bec43f7b0000,0x3f0ebf6dbe483f80
.quad 0xbf8000003f80,0x3f800000bf800000,0x3f55bec4bf7b0000,0x3f0e3f6dbe48bf80,0x3f6d3f35bec4bf80,0xbec43f353f6d0000,0x3e483f6d3f550000,0xbf7bbec43f0e3f80
.quad 0xbf3500003f353f80,0xbf35bf80bf350000,0xbf7bbf6dbf0e0000,0x3e48bec4bf55bf80,0xbec4bf35bf6dbf80,0x3f6d3f353ec40000,0x3f0e3ec43e480000,0x3f553f6d3f7b3f80
.quad 0xbf803f80bf803f80,0x0,0xbf7b3f6dbf553f35,0x3e48bec43f0ebf35,0xbf6d3f35bec40000,0x3ec4bf353f6dbf80,0xbf553ec43e48bf35,0x3f0ebf6d3f7bbf35
.quad 0xbf3500003f35bf80,0x3f35bf803f350000,0xbf0ebec43f7bbf35,0x3f55bf6d3e483f35,0xbec4bf353f6d0000,0x3f6dbf35bec43f80,0xbe48bf6d3f0e3f35,0x3f7bbec4bf553f35
.quad 0xbf8000003f80,0x3f800000bf800000,0x3e48bf6dbf0e3f35,0x3f7b3ec4bf55bf35,0x3ec4bf35bf6d0000,0x3f6d3f35bec4bf80,0x3f0ebec4bf7bbf35,0x3f553f6d3e48bf35
.quad 0x3f350000bf35bf80,0x3f353f803f350000,0x3f553ec4be48bf35,0x3f0e3f6d3f7b3f35,0x3f6d3f353ec40000,0x3ec43f353f6d3f80,0x3f7b3f6d3f553f35,0x3e483ec43f0e3f35
.quad 0x3f803f803f803f80,0x0,0x3f753f7b3f7f3f80,0x3e953e483dc90000,0x3f553f6d3f7b3f80,0x3f0e3ec43e480000,0x3f223f553f753f80,0x3f463f0e3e950000
.quad 0x3ec43f353f6d3f80,0x3f6d3f353ec40000,0x3dc93f0e3f623f80,0x3f7f3f553ef10000,0xbe483ec43f553f80,0x3f7b3f6d3f0e0000,0xbef13e483f463f80,0x3f623f7b3f220000
.quad 0xbf3500003f353f80,0x3f353f803f350000,0xbf62be483f223f80,0x3ef13f7b3f460000,0xbf7bbec43f0e3f80,0x3e483f6d3f550000,0xbf7fbf0e3ef13f80,0xbdc93f553f620000
.quad 0xbf6dbf353ec43f80,0xbec43f353f6d0000,0xbf46bf553e953f80,0xbf223f0e3f750000,0xbf0ebf6d3e483f80,0xbf553ec43f7b0000,0xbe95bf7b3dc93f80,0xbf753e483f7f0000
.quad 0x3f803f803f803f80,0x0,0x3f463f553f623f6d,0x3f223f0e3ef13ec4,0x3e483ec43f0e3f35,0x3f7b3f6d3f553f35,0xbef1be483dc93ec4,0x3f623f7b3f7f3f6d
.quad 0xbf6dbf35bec40000,0x3ec43f353f6d3f80,0xbf75bf7bbf46bec4,0xbe953e483f223f6d,0xbf0ebf6dbf7bbf35,0xbf55bec43e483f35,0x3dc9bf0ebf75bf6d,0xbf7fbf55be953ec4
.quad 0x3f350000bf35bf80,0xbf35bf80bf350000,0x3f7f3f0ebe95bf6d,0xbdc9bf55bf75bec4,0x3f553f6d3e48bf35,0x3f0ebec4bf7bbf35,0x3e953f7b3f22bec4,0x3f753e48bf46bf6d
.quad 0xbec43f353f6d0000,0x3f6d3f35bec4bf80,0xbf623e483f7f3ec4,0x3ef13f7b3dc9bf6d,0xbf7bbec43f553f35,0xbe483f6d3f0ebf35,0xbf22bf553ef13f6d,0xbf463f0e3f62bec4
.quad 0x3f803f803f803f80,0x0,0x3ef13f0e3f223f35,0x3f623f553f463f35,0xbf0ebec4be480000,0x3f553f6d3f7b3f80,0xbf7fbf7bbf62bf35,0xbdc93e483ef13f35
.quad 0xbec4bf35bf6dbf80,0xbf6dbf35bec40000,0x3f223e48be95bf35,0xbf46bf7bbf75bf35,0x3f7b3f6d3f0e0000,0x3e48bec4bf55bf80,0x3e953f553f7f3f35,0x3f753f0ebdc9bf35
.quad 0xbf3500003f353f80,0x3f353f803f350000,0xbf75bf55bdc93f35,0xbe953f0e3f7f3f35,0xbe48bf6dbf550000,0xbf7bbec43f0e3f80,0x3f46be48bf75bf35,0xbf22bf7bbe953f35
.quad 0x3f6d3f35bec4bf80,0x3ec4bf35bf6d0000,0x3dc93f7b3ef1bf35,0x3f7f3e48bf62bf35,0xbf553ec43f7b0000,0x3f0e3f6dbe48bf80,0xbf62bf0e3f463f35,0xbef13f553f22bf35
.quad 0x3f803f803f803f80,0x0,0x3dc93e483e953ec4,0x3f7f3f7b3f753f6d,0xbf7bbf6dbf55bf35,0x3e483ec43f0e3f35,0xbe95bf0ebf46bf6d,0xbf75bf55bf22bec4
.quad 0x3f6d3f353ec40000,0xbec4bf35bf6dbf80,0x3ef13f553f7f3f6d,0x3f623f0e3dc9bec4,0xbf55bec43e483f35,0x3f0e3f6d3f7b3f35,0xbf22bf7bbf62bec4,0xbf46be483ef13f6d
.quad 0x3f350000bf35bf80,0xbf35bf80bf350000,0x3f463f7b3ef1bec4,0x3f22be48bf62bf6d,0xbf0e3ec43f7b3f35,0x3f553f6d3e48bf35,0xbf62bf553dc93f6d,0xbef13f0e3f7f3ec4
.quad 0x3ec4bf35bf6d0000,0xbf6dbf353ec43f80,0x3f753f0ebf22bf6d,0x3e95bf55bf463ec4,0xbe483f6d3f0ebf35,0x3f7b3ec4bf55bf35,0xbf7fbe483f753ec4,0xbdc93f7b3e95bf6d
.quad 0x3f803f803f803f80,0x0,0xbe95be48bdc90000,0x3f753f7b3f7f3f80,0xbf55bf6dbf7bbf80,0xbf0ebec4be480000,0x3f463f0e3e950000,0xbf22bf55bf75bf80
.quad 0x3ec43f353f6d3f80,0x3f6d3f353ec40000,0xbf7fbf55bef10000,0x3dc93f0e3f623f80,0x3e48bec4bf55bf80,0xbf7bbf6dbf0e0000,0x3f623f7b3f220000,0x3ef1be48bf46bf80
.quad 0xbf3500003f353f80,0x3f353f803f350000,0xbef1bf7bbf460000,0xbf62be483f223f80,0x3f7b3ec4bf0ebf80,0xbe48bf6dbf550000,0xbdc93f553f620000,0x3f7f3f0ebef1bf80
.quad 0xbf6dbf353ec43f80,0xbec43f353f6d0000,0x3f22bf0ebf750000,0xbf46bf553e953f80,0x3f0e3f6dbe48bf80,0x3f55bec4bf7b0000,0xbf753e483f7f0000,0x3e953f7bbdc9bf80
.quad 0x3f803f803f803f80,0x0,0xbf22bf0ebef1bec4,0x3f463f553f623f6d,0xbe48bec4bf0ebf35,0xbf7bbf6dbf55bf35,0x3f623f7b3f7f3f6d,0x3ef13e48bdc9bec4
.quad 0xbf6dbf35bec40000,0x3ec43f353f6d3f80,0x3e95be48bf22bf6d,0xbf75bf7bbf46bec4,0x3f0e3f6d3f7b3f35,0x3f553ec4be48bf35,0xbf7fbf55be953ec4,0xbdc93f0e3f753f6d
.quad 0x3f350000bf35bf80,0xbf35bf80bf350000,0x3dc93f553f753ec4,0x3f7f3f0ebe95bf6d,0xbf55bf6dbe483f35,0xbf0e3ec43f7b3f35,0x3f753e48bf46bf6d,0xbe95bf7bbf223ec4
.quad 0xbec43f353f6d0000,0x3f6d3f35bec4bf80,0xbef1bf7bbdc93f6d,0xbf623e483f7f3ec4,0x3f7b3ec4bf55bf35,0x3e48bf6dbf0e3f35,0xbf463f0e3f62bec4,0x3f223f55bef1bf6d
.quad 0x3f803f803f803f80,0x0,0xbf62bf55bf46bf35,0x3ef13f0e3f223f35,0x3f0e3ec43e480000,0xbf55bf6dbf7bbf80,0xbdc93e483ef13f35,0x3f7f3f7b3f623f35
.quad 0xbec4bf35bf6dbf80,0xbf6dbf35bec40000,0x3f463f7b3f753f35,0x3f223e48be95bf35,0xbf7bbf6dbf0e0000,0xbe483ec43f553f80,0x3f753f0ebdc9bf35,0xbe95bf55bf7fbf35
.quad 0xbf3500003f353f80,0x3f353f803f350000,0x3e95bf0ebf7fbf35,0xbf75bf55bdc93f35,0x3e483f6d3f550000,0x3f7b3ec4bf0ebf80,0xbf22bf7bbe953f35,0xbf463e483f753f35
.quad 0x3f6d3f35bec4bf80,0x3ec4bf35bf6d0000,0xbf7fbe483f623f35,0x3dc93f7b3ef1bf35,0x3f55bec4bf7b0000,0xbf0ebf6d3e483f80,0xbef13f553f22bf35,0x3f623f0ebf46bf35
.quad 0x3f803f803f803f80,0x0,0xbf7fbf7bbf75bf6d,0x3dc93e483e953ec4,0x3f7b3f6d3f553f35,0xbe48bec4bf0ebf35,0xbf75bf55bf22bec4,0x3e953f0e3f463f6d
.quad 0x3f6d3f353ec40000,0xbec4bf35bf6dbf80,0xbf62bf0ebdc93ec4,0x3ef13f553f7f3f6d,0x3f553ec4be48bf35,0xbf0ebf6dbf7bbf35,0xbf46be483ef13f6d,0x3f223f7b3f623ec4
.quad 0x3f350000bf35bf80,0xbf35bf80bf350000,0xbf223e483f623f6d,0x3f463f7b3ef1bec4,0x3f0ebec4bf7bbf35,0xbf55bf6dbe483f35,0xbef13f0e3f7f3ec4,0x3f623f55bdc9bf6d
.quad 0x3ec4bf35bf6d0000,0xbf6dbf353ec43f80,0xbe953f553f46bec4,0x3f753f0ebf22bf6d,0x3e48bf6dbf0e3f35,0xbf7bbec43f553f35,0xbdc93f7b3e95bf6d,0x3f7f3e48bf75bec4
.quad 0x3f803f803f803f80,0x0,0xbf75bf7bbf7fbf80,0xbe95be48bdc90000,0x3f553f6d3f7b3f80,0x3f0e3ec43e480000,0xbf22bf55bf75bf80,0xbf46bf0ebe950000
.quad 0x3ec43f353f6d3f80,0x3f6d3f353ec40000,0xbdc9bf0ebf62bf80,0xbf7fbf55bef10000,0xbe483ec43f553f80,0x3f7b3f6d3f0e0000,0x3ef1be48bf46bf80,0xbf62bf7bbf220000
.quad 0xbf3500003f353f80,0x3f353f803f350000,0x3f623e48bf22bf80,0xbef1bf7bbf460000,0xbf7bbec43f0e3f80,0x3e483f6d3f550000,0x3f7f3f0ebef1bf80,0x3dc9bf55bf620000
.quad 0xbf6dbf353ec43f80,0xbec43f353f6d0000,0x3f463f55be95bf80,0x3f22bf0ebf750000,0xbf0ebf6d3e483f80,0xbf553ec43f7b0000,0x3e953f7bbdc9bf80,0x3f75be48bf7f0000
.quad 0x3f803f803f803f80,0x0,0xbf46bf55bf62bf6d,0xbf22bf0ebef1bec4,0x3e483ec43f0e3f35,0x3f7b3f6d3f553f35,0x3ef13e48bdc9bec4,0xbf62bf7bbf7fbf6d
.quad 0xbf6dbf35bec40000,0x3ec43f353f6d3f80,0x3f753f7b3f463ec4,0x3e95be48bf22bf6d,0xbf0ebf6dbf7bbf35,0xbf55bec43e483f35,0xbdc93f0e3f753f6d,0x3f7f3f553e95bec4
.quad 0x3f350000bf35bf80,0xbf35bf80bf350000,0xbf7fbf0e3e953f6d,0x3dc93f553f753ec4,0x3f553f6d3e48bf35,0x3f0ebec4bf7bbf35,0xbe95bf7bbf223ec4,0xbf75be483f463f6d
.quad 0xbec43f353f6d0000,0x3f6d3f35bec4bf80,0x3f62be48bf7fbec4,0xbef1bf7bbdc93f6d,0xbf7bbec43f553f35,0xbe483f6d3f0ebf35,0x3f223f55bef1bf6d,0x3f46bf0ebf623ec4
.quad 0x3f803f803f803f80,0x0,0xbef1bf0ebf22bf35,0xbf62bf55bf46bf35,0xbf0ebec4be480000,0x3f553f6d3f7b3f80,0x3f7f3f7b3f623f35,0x3dc9be48bef1bf35
.quad 0xbec4bf35bf6dbf80,0xbf6dbf35bec40000,0xbf22be483e953f35,0x3f463f7b3f753f35,0x3f7b3f6d3f0e0000,0x3e48bec4bf55bf80,0xbe95bf55bf7fbf35,0xbf75bf0e3dc93f35
.quad 0xbf3500003f353f80,0x3f353f803f350000,0x3f753f553dc9bf35,0x3e95bf0ebf7fbf35,0xbe48bf6dbf550000,0xbf7bbec43f0e3f80,0xbf463e483f753f35,0x3f223f7b3e95bf35
.quad 0x3f6d3f35bec4bf80,0x3ec4bf35bf6d0000,0xbdc9bf7bbef13f35,0xbf7fbe483f623f35,0xbf553ec43f7b0000,0x3f0e3f6dbe48bf80,0x3f623f0ebf46bf35,0x3ef1bf55bf223f35
.quad 0x3f803f803f803f80,0x0,0xbdc9be48be95bec4,0xbf7fbf7bbf75bf6d,0xbf7bbf6dbf55bf35,0x3e483ec43f0e3f35,0x3e953f0e3f463f6d,0x3f753f553f223ec4
.quad 0x3f6d3f353ec40000,0xbec4bf35bf6dbf80,0xbef1bf55bf7fbf6d,0xbf62bf0ebdc93ec4,0xbf55bec43e483f35,0x3f0e3f6d3f7b3f35,0x3f223f7b3f623ec4,0x3f463e48bef1bf6d
.quad 0x3f350000bf35bf80,0xbf35bf80bf350000,0xbf46bf7bbef13ec4,0xbf223e483f623f6d,0xbf0e3ec43f7b3f35,0x3f553f6d3e48bf35,0x3f623f55bdc9bf6d,0x3ef1bf0ebf7fbec4
.quad 0x3ec4bf35bf6d0000,0xbf6dbf353ec43f80,0xbf75bf0e3f223f6d,0xbe953f553f46bec4,0xbe483f6d3f0ebf35,0x3f7b3ec4bf55bf35,0x3f7f3e48bf75bec4,0x3dc9bf7bbe953f6d
.quad 0x3f803f803f803f80,0x0,0x3e953e483dc90000,0xbf75bf7bbf7fbf80,0xbf55bf6dbf7bbf80,0xbf0ebec4be480000,0xbf46bf0ebe950000,0x3f223f553f753f80
.quad 0x3ec43f353f6d3f80,0x3f6d3f353ec40000,0x3f7f3f553ef10000,0xbdc9bf0ebf62bf80,0x3e48bec4bf55bf80,0xbf7bbf6dbf0e0000,0xbf62bf7bbf220000,0xbef13e483f463f80
.quad 0xbf3500003f353f80,0x3f353f803f350000,0x3ef13f7b3f460000,0x3f623e48bf22bf80,0x3f7b3ec4bf0ebf80,0xbe48bf6dbf550000,0x3dc9bf55bf620000,0xbf7fbf0e3ef13f80
.quad 0xbf6dbf353ec43f80,0xbec43f353f6d0000,0xbf223f0e3f750000,0x3f463f55be95bf80,0x3f0e3f6dbe48bf80,0x3f55bec4bf7b0000,0x3f75be48bf7f0000,0xbe95bf7b3dc93f80
.quad 0x3f803f803f803f80,0x0,0x3f223f0e3ef13ec4,0xbf46bf55bf62bf6d,0xbe48bec4bf0ebf35,0xbf7bbf6dbf55bf35,0xbf62bf7bbf7fbf6d,0xbef1be483dc93ec4
.quad 0xbf6dbf35bec40000,0x3ec43f353f6d3f80,0xbe953e483f223f6d,0x3f753f7b3f463ec4,0x3f0e3f6d3f7b3f35,0x3f553ec4be48bf35,0x3f7f3f553e95bec4,0x3dc9bf0ebf75bf6d
.quad 0x3f350000bf35bf80,0xbf35bf80bf350000,0xbdc9bf55bf75bec4,0xbf7fbf0e3e953f6d,0xbf55bf6dbe483f35,0xbf0e3ec43f7b3f35,0xbf75be483f463f6d,0x3e953f7b3f22bec4
.quad 0xbec43f353f6d0000,0x3f6d3f35bec4bf80,0x3ef13f7b3dc9bf6d,0x3f62be48bf7fbec4,0x3f7b3ec4bf55bf35,0x3e48bf6dbf0e3f35,0x3f46bf0ebf623ec4,0xbf22bf553ef13f6d
.quad 0x3f803f803f803f80,0x0,0x3f623f553f463f35,0xbef1bf0ebf22bf35,0x3f0e3ec43e480000,0xbf55bf6dbf7bbf80,0x3dc9be48bef1bf35,0xbf7fbf7bbf62bf35
.quad 0xbec4bf35bf6dbf80,0xbf6dbf35bec40000,0xbf46bf7bbf75bf35,0xbf22be483e953f35,0xbf7bbf6dbf0e0000,0xbe483ec43f553f80,0xbf75bf0e3dc93f35,0x3e953f553f7f3f35
.quad 0xbf3500003f353f80,0x3f353f803f350000,0xbe953f0e3f7f3f35,0x3f753f553dc9bf35,0x3e483f6d3f550000,0x3f7b3ec4bf0ebf80,0x3f223f7b3e95bf35,0x3f46be48bf75bf35
.quad 0x3f6d3f35bec4bf80,0x3ec4bf35bf6d0000,0x3f7f3e48bf62bf35,0xbdc9bf7bbef13f35,0x3f55bec4bf7b0000,0xbf0ebf6d3e483f80,0x3ef1bf55bf223f35,0xbf62bf0e3f463f35
.quad 0x3f803f803f803f80,0x0,0x3f7f3f7b3f753f6d,0xbdc9be48be95bec4,0x3f7b3f6d3f553f35,0xbe48bec4bf0ebf35,0x3f753f553f223ec4,0xbe95bf0ebf46bf6d
.quad 0x3f6d3f353ec40000,0xbec4bf35bf6dbf80,0x3f623f0e3dc9bec4,0xbef1bf55bf7fbf6d,0x3f553ec4be48bf35,0xbf0ebf6dbf7bbf35,0x3f463e48bef1bf6d,0xbf22bf7bbf62bec4
.quad 0x3f350000bf35bf80,0xbf35bf80bf350000,0x3f22be48bf62bf6d,0xbf46bf7bbef13ec4,0x3f0ebec4bf7bbf35,0xbf55bf6dbe483f35,0x3ef1bf0ebf7fbec4,0xbf62bf553dc93f6d
.quad 0x3ec4bf35bf6d0000,0xbf6dbf353ec43f80,0x3e95bf55bf463ec4,0xbf75bf0e3f223f6d,0x3e48bf6dbf0e3f35,0xbf7bbec43f553f35,0x3dc9bf7bbe953f6d,0xbf7fbe483f753ec4
.quad 0xbf8000003f80,0xbf8000003f800000,0x3e95bf7bbdc93f80,0xbf75be483f7f0000,0x3f0ebf6dbe483f80,0xbf55bec43f7b0000,0x3f46bf55be953f80,0xbf22bf0e3f750000
.quad 0x3f6dbf35bec43f80,0xbec4bf353f6d0000,0x3f7fbf0ebef13f80,0xbdc9bf553f620000,0x3f7bbec4bf0e3f80,0x3e48bf6d3f550000,0x3f62be48bf223f80,0x3ef1bf7b3f460000
.quad 0x3f350000bf353f80,0x3f35bf803f350000,0x3ef13e48bf463f80,0x3f62bf7b3f220000,0x3e483ec4bf553f80,0x3f7bbf6d3f0e0000,0xbdc93f0ebf623f80,0x3f7fbf553ef10000
.quad 0xbec43f35bf6d3f80,0x3f6dbf353ec40000,0xbf223f55bf753f80,0x3f46bf0e3e950000,0xbf553f6dbf7b3f80,0x3f0ebec43e480000,0xbf753f7bbf7f3f80,0x3e95be483dc90000
.quad 0xbf8000003f80,0xbf8000003f800000,0x3f22bf55bef13f6d,0xbf46bf0e3f623ec4,0x3f7bbec4bf553f35,0xbe48bf6d3f0e3f35,0x3f623e48bf7f3ec4,0x3ef1bf7b3dc93f6d
.quad 0x3ec43f35bf6d0000,0x3f6dbf35bec43f80,0xbe953f7bbf22bec4,0x3f75be48bf463f6d,0xbf553f6dbe48bf35,0x3f0e3ec4bf7b3f35,0xbf7f3f0e3e95bf6d,0xbdc93f55bf753ec4
.quad 0xbf3500003f35bf80,0xbf353f80bf350000,0xbdc9bf0e3f75bf6d,0xbf7f3f55be95bec4,0x3f0ebf6d3f7bbf35,0xbf553ec43e48bf35,0x3f75bf7b3f46bec4,0xbe95be483f22bf6d
.quad 0x3f6dbf353ec40000,0x3ec4bf353f6dbf80,0x3ef1be48bdc93ec4,0x3f62bf7b3f7fbf6d,0xbe483ec4bf0e3f35,0x3f7bbf6d3f55bf35,0xbf463f55bf623f6d,0x3f22bf0e3ef1bec4
.quad 0xbf8000003f80,0xbf8000003f800000,0x3f62bf0ebf463f35,0xbef1bf553f223f35,0x3f553ec4bf7b0000,0x3f0ebf6dbe483f80,0xbdc93f7bbef1bf35,0x3f7fbe48bf623f35
.quad 0xbf6d3f353ec4bf80,0x3ec43f35bf6d0000,0xbf46be483f75bf35,0xbf223f7bbe95bf35,0x3e48bf6d3f550000,0xbf7b3ec43f0ebf80,0x3f75bf553dc93f35,0xbe95bf0e3f7fbf35
.quad 0x3f350000bf353f80,0x3f35bf803f350000,0xbe953f55bf7f3f35,0x3f75bf0ebdc93f35,0xbf7b3f6dbf0e0000,0x3e483ec4bf553f80,0xbf223e483e95bf35,0xbf463f7bbf753f35
.quad 0x3ec4bf353f6dbf80,0xbf6d3f35bec40000,0x3f7fbf7b3f62bf35,0xbdc9be483ef1bf35,0x3f0ebec43e480000,0x3f55bf6d3f7bbf80,0xbef13f0ebf223f35,0x3f62bf553f46bf35
.quad 0xbf8000003f80,0xbf8000003f800000,0x3f7fbe48bf753ec4,0xbdc9bf7b3e953f6d,0x3e483f6dbf0ebf35,0x3f7bbec4bf553f35,0xbf753f0e3f22bf6d,0x3e953f55bf46bec4
.quad 0xbec4bf353f6d0000,0xbf6d3f353ec4bf80,0x3f62bf55bdc93f6d,0xbef1bf0e3f7fbec4,0x3f0e3ec4bf7b3f35,0x3f55bf6d3e483f35,0xbf463f7bbef1bec4,0x3f223e48bf623f6d
.quad 0xbf3500003f35bf80,0xbf353f80bf350000,0x3f22bf7b3f62bec4,0xbf463e483ef1bf6d,0x3f55bec4be483f35,0x3f0ebf6d3f7bbf35,0xbef13f55bf7f3f6d,0x3f62bf0e3dc93ec4
.quad 0xbf6d3f35bec40000,0xbec43f35bf6d3f80,0x3e95bf0e3f46bf6d,0xbf753f55bf223ec4,0x3f7bbf6d3f55bf35,0x3e48bec43f0ebf35,0xbdc93e48be953ec4,0x3f7fbf7b3f75bf6d
.quad 0xbf8000003f80,0xbf8000003f800000,0x3f753e48bf7f0000,0x3e95bf7bbdc93f80,0xbf0e3f6d3e48bf80,0x3f553ec4bf7b0000,0xbf22bf0e3f750000,0xbf463f553e95bf80
.quad 0x3f6dbf35bec43f80,0xbec4bf353f6d0000,0x3dc93f55bf620000,0x3f7fbf0ebef13f80,0xbf7b3ec43f0ebf80,0xbe483f6dbf550000,0x3ef1bf7b3f460000,0xbf623e483f22bf80
.quad 0x3f350000bf353f80,0x3f35bf803f350000,0xbf623f7bbf220000,0x3ef13e48bf463f80,0xbe48bec43f55bf80,0xbf7b3f6dbf0e0000,0x3f7fbf553ef10000,0x3dc9bf0e3f62bf80
.quad 0xbec43f35bf6d3f80,0x3f6dbf353ec40000,0xbf463f0ebe950000,0xbf223f55bf753f80,0x3f55bf6d3f7bbf80,0xbf0e3ec4be480000,0x3e95be483dc90000,0x3f75bf7b3f7fbf80
.quad 0xbf8000003f80,0xbf8000003f800000,0x3f463f0ebf62bec4,0x3f22bf55bef13f6d,0xbf7b3ec43f55bf35,0x3e483f6dbf0ebf35,0x3ef1bf7b3dc93f6d,0xbf62be483f7fbec4
.quad 0x3ec43f35bf6d0000,0x3f6dbf35bec43f80,0xbf753e483f46bf6d,0xbe953f7bbf22bec4,0x3f55bf6d3e483f35,0xbf0ebec43f7bbf35,0xbdc93f55bf753ec4,0x3f7fbf0ebe953f6d
.quad 0xbf3500003f35bf80,0xbf353f80bf350000,0x3f7fbf553e953ec4,0xbdc9bf0e3f75bf6d,0xbf0e3f6dbf7b3f35,0x3f55bec4be483f35,0xbe95be483f22bf6d,0xbf753f7bbf463ec4
.quad 0x3f6dbf353ec40000,0x3ec4bf353f6dbf80,0xbf623f7bbf7f3f6d,0x3ef1be48bdc93ec4,0x3e48bec43f0ebf35,0xbf7b3f6dbf553f35,0x3f22bf0e3ef1bec4,0x3f46bf553f62bf6d
.quad 0xbf8000003f80,0xbf8000003f800000,0x3ef13f55bf22bf35,0x3f62bf0ebf463f35,0xbf55bec43f7b0000,0xbf0e3f6d3e48bf80,0x3f7fbe48bf623f35,0x3dc9bf7b3ef13f35
.quad 0xbf6d3f353ec4bf80,0x3ec43f35bf6d0000,0x3f22bf7b3e953f35,0xbf46be483f75bf35,0xbe483f6dbf550000,0x3f7bbec4bf0e3f80,0xbe95bf0e3f7fbf35,0xbf753f55bdc9bf35
.quad 0x3f350000bf353f80,0x3f35bf803f350000,0xbf753f0e3dc9bf35,0xbe953f55bf7f3f35,0x3f7bbf6d3f0e0000,0xbe48bec43f55bf80,0xbf463f7bbf753f35,0x3f22be48be953f35
.quad 0x3ec4bf353f6dbf80,0xbf6d3f35bec40000,0x3dc93e48bef13f35,0x3f7fbf7b3f62bf35,0xbf0e3ec4be480000,0xbf553f6dbf7b3f80,0x3f62bf553f46bf35,0x3ef1bf0e3f22bf35
.quad 0xbf8000003f80,0xbf8000003f800000,0x3dc93f7bbe95bf6d,0x3f7fbe48bf753ec4,0xbe48bf6d3f0e3f35,0xbf7b3ec43f55bf35,0x3e953f55bf46bec4,0x3f75bf0ebf223f6d
.quad 0xbec4bf353f6d0000,0xbf6d3f353ec4bf80,0x3ef13f0ebf7f3ec4,0x3f62bf55bdc93f6d,0xbf0ebec43f7bbf35,0xbf553f6dbe48bf35,0x3f223e48bf623f6d,0x3f46bf7b3ef13ec4
.quad 0xbf3500003f35bf80,0xbf353f80bf350000,0x3f46be48bef13f6d,0x3f22bf7b3f62bec4,0xbf553ec43e48bf35,0xbf0e3f6dbf7b3f35,0x3f62bf0e3dc93ec4,0x3ef1bf553f7fbf6d
.quad 0xbf6d3f35bec40000,0xbec43f35bf6d3f80,0x3f75bf553f22bec4,0x3e95bf0e3f46bf6d,0xbf7b3f6dbf553f35,0xbe483ec4bf0e3f35,0x3f7fbf7b3f75bf6d,0x3dc9be483e95bec4
.quad 0xbf8000003f80,0xbf8000003f800000,0xbe953f7b3dc9bf80,0x3f753e48bf7f0000,0x3f0ebf6dbe483f80,0xbf55bec43f7b0000,0xbf463f553e95bf80,0x3f223f0ebf750000
.quad 0x3f6dbf35bec43f80,0xbec4bf353f6d0000,0xbf7f3f0e3ef1bf80,0x3dc93f55bf620000,0x3f7bbec4bf0e3f80,0x3e48bf6d3f550000,0xbf623e483f22bf80,0xbef13f7bbf460000
.quad 0x3f350000bf353f80,0x3f35bf803f350000,0xbef1be483f46bf80,0xbf623f7bbf220000,0x3e483ec4bf553f80,0x3f7bbf6d3f0e0000,0x3dc9bf0e3f62bf80,0xbf7f3f55bef10000
.quad 0xbec43f35bf6d3f80,0x3f6dbf353ec40000,0x3f22bf553f75bf80,0xbf463f0ebe950000,0xbf553f6dbf7b3f80,0x3f0ebec43e480000,0x3f75bf7b3f7fbf80,0xbe953e48bdc90000
.quad 0xbf8000003f80,0xbf8000003f800000,0xbf223f553ef1bf6d,0x3f463f0ebf62bec4,0x3f7bbec4bf553f35,0xbe48bf6d3f0e3f35,0xbf62be483f7fbec4,0xbef13f7bbdc9bf6d
.quad 0x3ec43f35bf6d0000,0x3f6dbf35bec43f80,0x3e95bf7b3f223ec4,0xbf753e483f46bf6d,0xbf553f6dbe48bf35,0x3f0e3ec4bf7b3f35,0x3f7fbf0ebe953f6d,0x3dc9bf553f75bec4
.quad 0xbf3500003f35bf80,0xbf353f80bf350000,0x3dc93f0ebf753f6d,0x3f7fbf553e953ec4,0x3f0ebf6d3f7bbf35,0xbf553ec43e48bf35,0xbf753f7bbf463ec4,0x3e953e48bf223f6d
.quad 0x3f6dbf353ec40000,0x3ec4bf353f6dbf80,0xbef13e483dc9bec4,0xbf623f7bbf7f3f6d,0xbe483ec4bf0e3f35,0x3f7bbf6d3f55bf35,0x3f46bf553f62bf6d,0xbf223f0ebef13ec4
.quad 0xbf8000003f80,0xbf8000003f800000,0xbf623f0e3f46bf35,0x3ef13f55bf22bf35,0x3f553ec4bf7b0000,0x3f0ebf6dbe483f80,0x3dc9bf7b3ef13f35,0xbf7f3e483f62bf35
.quad 0xbf6d3f353ec4bf80,0x3ec43f35bf6d0000,0x3f463e48bf753f35,0x3f22bf7b3e953f35,0x3e48bf6d3f550000,0xbf7b3ec43f0ebf80,0xbf753f55bdc9bf35,0x3e953f0ebf7f3f35
.quad 0x3f350000bf353f80,0x3f35bf803f350000,0x3e95bf553f7fbf35,0xbf753f0e3dc9bf35,0xbf7b3f6dbf0e0000,0x3e483ec4bf553f80,0x3f22be48be953f35,0x3f46bf7b3f75bf35
.quad 0x3ec4bf353f6dbf80,0xbf6d3f35bec40000,0xbf7f3f7bbf623f35,0x3dc93e48bef13f35,0x3f0ebec43e480000,0x3f55bf6d3f7bbf80,0x3ef1bf0e3f22bf35,0xbf623f55bf463f35
.quad 0xbf8000003f80,0xbf8000003f800000,0xbf7f3e483f75bec4,0x3dc93f7bbe95bf6d,0x3e483f6dbf0ebf35,0x3f7bbec4bf553f35,0x3f75bf0ebf223f6d,0xbe95bf553f463ec4
.quad 0xbec4bf353f6d0000,0xbf6d3f353ec4bf80,0xbf623f553dc9bf6d,0x3ef13f0ebf7f3ec4,0x3f0e3ec4bf7b3f35,0x3f55bf6d3e483f35,0x3f46bf7b3ef13ec4,0xbf22be483f62bf6d
.quad 0xbf3500003f35bf80,0xbf353f80bf350000,0xbf223f7bbf623ec4,0x3f46be48bef13f6d,0x3f55bec4be483f35,0x3f0ebf6d3f7bbf35,0x3ef1bf553f7fbf6d,0xbf623f0ebdc9bec4
.quad 0xbf6d3f35bec40000,0xbec43f35bf6d3f80,0xbe953f0ebf463f6d,0x3f75bf553f22bec4,0x3f7bbf6d3f55bf35,0x3e48bec43f0ebf35,0x3dc9be483e95bec4,0xbf7f3f7bbf753f6d
.quad 0xbf8000003f80,0xbf8000003f800000,0xbf75be483f7f0000,0xbe953f7b3dc9bf80,0xbf0e3f6d3e48bf80,0x3f553ec4bf7b0000,0x3f223f0ebf750000,0x3f46bf55be953f80
.quad 0x3f6dbf35bec43f80,0xbec4bf353f6d0000,0xbdc9bf553f620000,0xbf7f3f0e3ef1bf80,0xbf7b3ec43f0ebf80,0xbe483f6dbf550000,0xbef13f7bbf460000,0x3f62be48bf223f80
.quad 0x3f350000bf353f80,0x3f35bf803f350000,0x3f62bf7b3f220000,0xbef1be483f46bf80,0xbe48bec43f55bf80,0xbf7b3f6dbf0e0000,0xbf7f3f55bef10000,0xbdc93f0ebf623f80
.quad 0xbec43f35bf6d3f80,0x3f6dbf353ec40000,0x3f46bf0e3e950000,0x3f22bf553f75bf80,0x3f55bf6d3f7bbf80,0xbf0e3ec4be480000,0xbe953e48bdc90000,0xbf753f7bbf7f3f80
.quad 0xbf8000003f80,0xbf8000003f800000,0xbf46bf0e3f623ec4,0xbf223f553ef1bf6d,0xbf7b3ec43f55bf35,0x3e483f6dbf0ebf35,0xbef13f7bbdc9bf6d,0x3f623e48bf7f3ec4
.quad 0x3ec43f35bf6d0000,0x3f6dbf35bec43f80,0x3f75be48bf463f6d,0x3e95bf7b3f223ec4,0x3f55bf6d3e483f35,0xbf0ebec43f7bbf35,0x3dc9bf553f75bec4,0xbf7f3f0e3e95bf6d
.quad 0xbf3500003f35bf80,0xbf353f80bf350000,0xbf7f3f55be95bec4,0x3dc93f0ebf753f6d,0xbf0e3f6dbf7b3f35,0x3f55bec4be483f35,0x3e953e48bf223f6d,0x3f75bf7b3f46bec4
.quad 0x3f6dbf353ec40000,0x3ec4bf353f6dbf80,0x3f62bf7b3f7fbf6d,0xbef13e483dc9bec4,0x3e48bec43f0ebf35,0xbf7b3f6dbf553f35,0xbf223f0ebef13ec4,0xbf463f55bf623f6d
.quad 0xbf8000003f80,0xbf8000003f800000,0xbef1bf553f223f35,0xbf623f0e3f46bf35,0xbf55bec43f7b0000,0xbf0e3f6d3e48bf80,0xbf7f3e483f62bf35,0xbdc93f7bbef1bf35
.quad 0xbf6d3f353ec4bf80,0x3ec43f35bf6d0000,0xbf223f7bbe95bf35,0x3f463e48bf753f35,0xbe483f6dbf550000,0x3f7bbec4bf0e3f80,0x3e953f0ebf7f3f35,0x3f75bf553dc93f35
.quad 0x3f350000bf353f80,0x3f35bf803f350000,0x3f75bf0ebdc93f35,0x3e95bf553f7fbf35,0x3f7bbf6d3f0e0000,0xbe48bec43f55bf80,0x3f46bf7b3f75bf35,0xbf223e483e95bf35
.quad 0x3ec4bf353f6dbf80,0xbf6d3f35bec40000,0xbdc9be483ef1bf35,0xbf7f3f7bbf623f35,0xbf0e3ec4be480000,0xbf553f6dbf7b3f80,0xbf623f55bf463f35,0xbef13f0ebf223f35
.quad 0xbf8000003f80,0xbf8000003f800000,0xbdc9bf7b3e953f6d,0xbf7f3e483f75bec4,0xbe48bf6d3f0e3f35,0xbf7b3ec43f55bf35,0xbe95bf553f463ec4,0xbf753f0e3f22bf6d
.quad 0xbec4bf353f6d0000,0xbf6d3f353ec4bf80,0xbef1bf0e3f7fbec4,0xbf623f553dc9bf6d,0xbf0ebec43f7bbf35,0xbf553f6dbe48bf35,0xbf22be483f62bf6d,0xbf463f7bbef1bec4
.quad 0xbf3500003f35bf80,0xbf353f80bf350000,0xbf463e483ef1bf6d,0xbf223f7bbf623ec4,0xbf553ec43e48bf35,0xbf0e3f6dbf7b3f35,0xbf623f0ebdc9bec4,0xbef13f55bf7f3f6d
.quad 0xbf6d3f35bec40000,0xbec43f35bf6d3f80,0xbf753f55bf223ec4,0xbe953f0ebf463f6d,0xbf7b3f6dbf553f35,0xbe483ec4bf0e3f35,0xbf7f3f7bbf753f6d,0xbdc93e48be953ec4
.quad 0xbf803f80bf803f80,0x0,0xbf753f7bbf7f3f80,0xbe953e48bdc90000,0xbf553f6dbf7b3f80,0xbf0e3ec4be480000,0xbf223f55bf753f80,0xbf463f0ebe950000
.quad 0xbec43f35bf6d3f80,0xbf6d3f35bec40000,0xbdc93f0ebf623f80,0xbf7f3f55bef10000,0x3e483ec4bf553f80,0xbf7b3f6dbf0e0000,0x3ef13e48bf463f80,0xbf623f7bbf220000
.quad 0x3f350000bf353f80,0xbf353f80bf350000,0x3f62be48bf223f80,0xbef13f7bbf460000,0x3f7bbec4bf0e3f80,0xbe483f6dbf550000,0x3f7fbf0ebef13f80,0x3dc93f55bf620000
.quad 0x3f6dbf35bec43f80,0x3ec43f35bf6d0000,0x3f46bf55be953f80,0x3f223f0ebf750000,0x3f0ebf6dbe483f80,0x3f553ec4bf7b0000,0x3e95bf7bbdc93f80,0x3f753e48bf7f0000
.quad 0xbf803f80bf803f80,0x0,0xbf463f55bf623f6d,0xbf223f0ebef13ec4,0xbe483ec4bf0e3f35,0xbf7b3f6dbf553f35,0x3ef1be48bdc93ec4,0xbf623f7bbf7f3f6d
.quad 0x3f6dbf353ec40000,0xbec43f35bf6d3f80,0x3f75bf7b3f46bec4,0x3e953e48bf223f6d,0x3f0ebf6d3f7bbf35,0x3f55bec4be483f35,0xbdc9bf0e3f75bf6d,0x3f7fbf553e953ec4
.quad 0xbf3500003f35bf80,0x3f35bf803f350000,0xbf7f3f0e3e95bf6d,0x3dc9bf553f75bec4,0xbf553f6dbe48bf35,0xbf0ebec43f7bbf35,0xbe953f7bbf22bec4,0xbf753e483f46bf6d
.quad 0x3ec43f35bf6d0000,0xbf6d3f353ec4bf80,0x3f623e48bf7f3ec4,0xbef13f7bbdc9bf6d,0x3f7bbec4bf553f35,0x3e483f6dbf0ebf35,0x3f22bf55bef13f6d,0x3f463f0ebf62bec4
.quad 0xbf803f80bf803f80,0x0,0xbef13f0ebf223f35,0xbf623f55bf463f35,0x3f0ebec43e480000,0xbf553f6dbf7b3f80,0x3f7fbf7b3f62bf35,0x3dc93e48bef13f35
.quad 0x3ec4bf353f6dbf80,0x3f6dbf353ec40000,0xbf223e483e95bf35,0x3f46bf7b3f75bf35,0xbf7b3f6dbf0e0000,0xbe48bec43f55bf80,0xbe953f55bf7f3f35,0xbf753f0e3dc9bf35
.quad 0x3f350000bf353f80,0xbf353f80bf350000,0x3f75bf553dc93f35,0x3e953f0ebf7f3f35,0x3e48bf6d3f550000,0x3f7bbec4bf0e3f80,0xbf46be483f75bf35,0x3f22bf7b3e953f35
.quad 0xbf6d3f353ec4bf80,0xbec4bf353f6d0000,0xbdc93f7bbef1bf35,0xbf7f3e483f62bf35,0x3f553ec4bf7b0000,0xbf0e3f6d3e48bf80,0x3f62bf0ebf463f35,0x3ef13f55bf22bf35
.quad 0xbf803f80bf803f80,0x0,0xbdc93e48be953ec4,0xbf7f3f7bbf753f6d,0x3f7bbf6d3f55bf35,0xbe483ec4bf0e3f35,0x3e95bf0e3f46bf6d,0x3f75bf553f22bec4
.quad 0xbf6d3f35bec40000,0x3ec4bf353f6dbf80,0xbef13f55bf7f3f6d,0xbf623f0ebdc9bec4,0x3f55bec4be483f35,0xbf0e3f6dbf7b3f35,0x3f22bf7b3f62bec4,0x3f46be48bef13f6d
.quad 0xbf3500003f35bf80,0x3f35bf803f350000,0xbf463f7bbef1bec4,0xbf22be483f62bf6d,0x3f0e3ec4bf7b3f35,0xbf553f6dbe48bf35,0x3f62bf55bdc93f6d,0x3ef13f0ebf7f3ec4
.quad 0xbec4bf353f6d0000,0x3f6dbf35bec43f80,0xbf753f0e3f22bf6d,0xbe95bf553f463ec4,0x3e483f6dbf0ebf35,0xbf7b3ec43f55bf35,0x3f7fbe48bf753ec4,0x3dc93f7bbe95bf6d
.quad 0xbf803f80bf803f80,0x0,0x3e95be483dc90000,0xbf753f7bbf7f3f80,0x3f55bf6d3f7bbf80,0x3f0ebec43e480000,0xbf463f0ebe950000,0x3f22bf553f75bf80
.quad 0xbec43f35bf6d3f80,0xbf6d3f35bec40000,0x3f7fbf553ef10000,0xbdc93f0ebf623f80,0xbe48bec43f55bf80,0x3f7bbf6d3f0e0000,0xbf623f7bbf220000,0xbef1be483f46bf80
.quad 0x3f350000bf353f80,0xbf353f80bf350000,0x3ef1bf7b3f460000,0x3f62be48bf223f80,0xbf7b3ec43f0ebf80,0x3e48bf6d3f550000,0x3dc93f55bf620000,0xbf7f3f0e3ef1bf80
.quad 0x3f6dbf35bec43f80,0x3ec43f35bf6d0000,0xbf22bf0e3f750000,0x3f46bf55be953f80,0xbf0e3f6d3e48bf80,0xbf55bec43f7b0000,0x3f753e48bf7f0000,0xbe953f7b3dc9bf80
.quad 0xbf803f80bf803f80,0x0,0x3f22bf0e3ef1bec4,0xbf463f55bf623f6d,0x3e48bec43f0ebf35,0x3f7bbf6d3f55bf35,0xbf623f7bbf7f3f6d,0xbef13e483dc9bec4
.quad 0x3f6dbf353ec40000,0xbec43f35bf6d3f80,0xbe95be483f22bf6d,0x3f75bf7b3f46bec4,0xbf0e3f6dbf7b3f35,0xbf553ec43e48bf35,0x3f7fbf553e953ec4,0x3dc93f0ebf753f6d
.quad 0xbf3500003f35bf80,0x3f35bf803f350000,0xbdc93f55bf753ec4,0xbf7f3f0e3e95bf6d,0x3f55bf6d3e483f35,0x3f0e3ec4bf7b3f35,0xbf753e483f46bf6d,0x3e95bf7b3f223ec4
.quad 0x3ec43f35bf6d0000,0xbf6d3f353ec4bf80,0x3ef1bf7b3dc93f6d,0x3f623e48bf7f3ec4,0xbf7b3ec43f55bf35,0xbe48bf6d3f0e3f35,0x3f463f0ebf62bec4,0xbf223f553ef1bf6d
.quad 0xbf803f80bf803f80,0x0,0x3f62bf553f46bf35,0xbef13f0ebf223f35,0xbf0e3ec4be480000,0x3f55bf6d3f7bbf80,0x3dc93e48bef13f35,0xbf7f3f7bbf623f35
.quad 0x3ec4bf353f6dbf80,0x3f6dbf353ec40000,0xbf463f7bbf753f35,0xbf223e483e95bf35,0x3f7bbf6d3f0e0000,0x3e483ec4bf553f80,0xbf753f0e3dc9bf35,0x3e95bf553f7fbf35
.quad 0x3f350000bf353f80,0xbf353f80bf350000,0xbe95bf0e3f7fbf35,0x3f75bf553dc93f35,0xbe483f6dbf550000,0xbf7b3ec43f0ebf80,0x3f22bf7b3e953f35,0x3f463e48bf753f35
.quad 0xbf6d3f353ec4bf80,0xbec4bf353f6d0000,0x3f7fbe48bf623f35,0xbdc93f7bbef1bf35,0xbf55bec43f7b0000,0x3f0ebf6dbe483f80,0x3ef13f55bf22bf35,0xbf623f0e3f46bf35
.quad 0xbf803f80bf803f80,0x0,0x3f7fbf7b3f75bf6d,0xbdc93e48be953ec4,0xbf7b3f6dbf553f35,0x3e48bec43f0ebf35,0x3f75bf553f22bec4,0xbe953f0ebf463f6d
.quad 0xbf6d3f35bec40000,0x3ec4bf353f6dbf80,0x3f62bf0e3dc93ec4,0xbef13f55bf7f3f6d,0xbf553ec43e48bf35,0x3f0ebf6d3f7bbf35,0x3f46be48bef13f6d,0xbf223f7bbf623ec4
.quad 0xbf3500003f35bf80,0x3f35bf803f350000,0x3f223e48bf623f6d,0xbf463f7bbef1bec4,0xbf0ebec43f7bbf35,0x3f55bf6d3e483f35,0x3ef13f0ebf7f3ec4,0xbf623f553dc9bf6d
.quad 0xbec4bf353f6d0000,0x3f6dbf35bec43f80,0x3e953f55bf46bec4,0xbf753f0e3f22bf6d,0xbe48bf6d3f0e3f35,0x3f7bbec4bf553f35,0x3dc93f7bbe95bf6d,0xbf7f3e483f75bec4
.quad 0xbf803f80bf803f80,0x0,0x3f75bf7b3f7fbf80,0x3e95be483dc90000,0xbf553f6dbf7b3f80,0xbf0e3ec4be480000,0x3f22bf553f75bf80,0x3f46bf0e3e950000
.quad 0xbec43f35bf6d3f80,0xbf6d3f35bec40000,0x3dc9bf0e3f62bf80,0x3f7fbf553ef10000,0x3e483ec4bf553f80,0xbf7b3f6dbf0e0000,0xbef1be483f46bf80,0x3f62bf7b3f220000
.quad 0x3f350000bf353f80,0xbf353f80bf350000,0xbf623e483f22bf80,0x3ef1bf7b3f460000,0x3f7bbec4bf0e3f80,0xbe483f6dbf550000,0xbf7f3f0e3ef1bf80,0xbdc9bf553f620000
.quad 0x3f6dbf35bec43f80,0x3ec43f35bf6d0000,0xbf463f553e95bf80,0xbf22bf0e3f750000,0x3f0ebf6dbe483f80,0x3f553ec4bf7b0000,0xbe953f7b3dc9bf80,0xbf75be483f7f0000
.quad 0xbf803f80bf803f80,0x0,0x3f46bf553f62bf6d,0x3f22bf0e3ef1bec4,0xbe483ec4bf0e3f35,0xbf7b3f6dbf553f35,0xbef13e483dc9bec4,0x3f62bf7b3f7fbf6d
.quad 0x3f6dbf353ec40000,0xbec43f35bf6d3f80,0xbf753f7bbf463ec4,0xbe95be483f22bf6d,0x3f0ebf6d3f7bbf35,0x3f55bec4be483f35,0x3dc93f0ebf753f6d,0xbf7f3f55be95bec4
.quad 0xbf3500003f35bf80,0x3f35bf803f350000,0x3f7fbf0ebe953f6d,0xbdc93f55bf753ec4,0xbf553f6dbe48bf35,0xbf0ebec43f7bbf35,0x3e95bf7b3f223ec4,0x3f75be48bf463f6d
.quad 0x3ec43f35bf6d0000,0xbf6d3f353ec4bf80,0xbf62be483f7fbec4,0x3ef1bf7b3dc93f6d,0x3f7bbec4bf553f35,0x3e483f6dbf0ebf35,0xbf223f553ef1bf6d,0xbf46bf0e3f623ec4
.quad 0xbf803f80bf803f80,0x0,0x3ef1bf0e3f22bf35,0x3f62bf553f46bf35,0x3f0ebec43e480000,0xbf553f6dbf7b3f80,0xbf7f3f7bbf623f35,0xbdc9be483ef1bf35
.quad 0x3ec4bf353f6dbf80,0x3f6dbf353ec40000,0x3f22be48be953f35,0xbf463f7bbf753f35,0xbf7b3f6dbf0e0000,0xbe48bec43f55bf80,0x3e95bf553f7fbf35,0x3f75bf0ebdc93f35
.quad 0x3f350000bf353f80,0xbf353f80bf350000,0xbf753f55bdc9bf35,0xbe95bf0e3f7fbf35,0x3e48bf6d3f550000,0x3f7bbec4bf0e3f80,0x3f463e48bf753f35,0xbf223f7bbe95bf35
.quad 0xbf6d3f353ec4bf80,0xbec4bf353f6d0000,0x3dc9bf7b3ef13f35,0x3f7fbe48bf623f35,0x3f553ec4bf7b0000,0xbf0e3f6d3e48bf80,0xbf623f0e3f46bf35,0xbef1bf553f223f35
.quad 0xbf803f80bf803f80,0x0,0x3dc9be483e95bec4,0x3f7fbf7b3f75bf6d,0x3f7bbf6d3f55bf35,0xbe483ec4bf0e3f35,0xbe953f0ebf463f6d,0xbf753f55bf223ec4
.quad 0xbf6d3f35bec40000,0x3ec4bf353f6dbf80,0x3ef1bf553f7fbf6d,0x3f62bf0e3dc93ec4,0x3f55bec4be483f35,0xbf0e3f6dbf7b3f35,0xbf223f7bbf623ec4,0xbf463e483ef1bf6d
.quad 0xbf3500003f35bf80,0x3f35bf803f350000,0x3f46bf7b3ef13ec4,0x3f223e48bf623f6d,0x3f0e3ec4bf7b3f35,0xbf553f6dbe48bf35,0xbf623f553dc9bf6d,0xbef1bf0e3f7fbec4
.quad 0xbec4bf353f6d0000,0x3f6dbf35bec43f80,0x3f75bf0ebf223f6d,0x3e953f55bf46bec4,0x3e483f6dbf0ebf35,0xbf7b3ec43f55bf35,0xbf7f3e483f75bec4,0xbdc9bf7b3e953f6d
.quad 0xbf803f80bf803f80,0x0,0xbe953e48bdc90000,0x3f75bf7b3f7fbf80,0x3f55bf6d3f7bbf80,0x3f0ebec43e480000,0x3f46bf0e3e950000,0xbf223f55bf753f80
.quad 0xbec43f35bf6d3f80,0xbf6d3f35bec40000,0xbf7f3f55bef10000,0x3dc9bf0e3f62bf80,0xbe48bec43f55bf80,0x3f7bbf6d3f0e0000,0x3f62bf7b3f220000,0x3ef13e48bf463f80
.quad 0x3f350000bf353f80,0xbf353f80bf350000,0xbef13f7bbf460000,0xbf623e483f22bf80,0xbf7b3ec43f0ebf80,0x3e48bf6d3f550000,0xbdc9bf553f620000,0x3f7fbf0ebef13f80
.quad 0x3f6dbf35bec43f80,0x3ec43f35bf6d0000,0x3f223f0ebf750000,0xbf463f553e95bf80,0xbf0e3f6d3e48bf80,0xbf55bec43f7b0000,0xbf75be483f7f0000,0x3e95bf7bbdc93f80
.quad 0xbf803f80bf803f80,0x0,0xbf223f0ebef13ec4,0x3f46bf553f62bf6d,0x3e48bec43f0ebf35,0x3f7bbf6d3f55bf35,0x3f62bf7b3f7fbf6d,0x3ef1be48bdc93ec4
.quad 0x3f6dbf353ec40000,0xbec43f35bf6d3f80,0x3e953e48bf223f6d,0xbf753f7bbf463ec4,0xbf0e3f6dbf7b3f35,0xbf553ec43e48bf35,0xbf7f3f55be95bec4,0xbdc9bf0e3f75bf6d
.quad 0xbf3500003f35bf80,0x3f35bf803f350000,0x3dc9bf553f75bec4,0x3f7fbf0ebe953f6d,0x3f55bf6d3e483f35,0x3f0e3ec4bf7b3f35,0x3f75be48bf463f6d,0xbe953f7bbf22bec4
.quad 0x3ec43f35bf6d0000,0xbf6d3f353ec4bf80,0xbef13f7bbdc9bf6d,0xbf62be483f7fbec4,0xbf7b3ec43f55bf35,0xbe48bf6d3f0e3f35,0xbf46bf0e3f623ec4,0x3f22bf55bef13f6d
.quad 0xbf803f80bf803f80,0x0,0xbf623f55bf463f35,0x3ef1bf0e3f22bf35,0xbf0e3ec4be480000,0x3f55bf6d3f7bbf80,0xbdc9be483ef1bf35,0x3f7fbf7b3f62bf35
.quad 0x3ec4bf353f6dbf80,0x3f6dbf353ec40000,0x3f46bf7b3f75bf35,0x3f22be48be953f35,0x3f7bbf6d3f0e0000,0x3e483ec4bf553f80,0x3f75bf0ebdc93f35,0xbe953f55bf7f3f35
.quad 0x3f350000bf353f80,0xbf353f80bf350000,0x3e953f0ebf7f3f35,0xbf753f55bdc9bf35,0xbe483f6dbf550000,0xbf7b3ec43f0ebf80,0xbf223f7bbe95bf35,0xbf46be483f75bf35
.quad 0xbf6d3f353ec4bf80,0xbec4bf353f6d0000,0xbf7f3e483f62bf35,0x3dc9bf7b3ef13f35,0xbf55bec43f7b0000,0x3f0ebf6dbe483f80,0xbef1bf553f223f35,0x3f62bf0ebf463f35
.quad 0xbf803f80bf803f80,0x0,0xbf7f3f7bbf753f6d,0x3dc9be483e95bec4,0xbf7b3f6dbf553f35,0x3e48bec43f0ebf35,0xbf753f55bf223ec4,0x3e95bf0e3f46bf6d
.quad 0xbf6d3f35bec40000,0x3ec4bf353f6dbf80,0xbf623f0ebdc9bec4,0x3ef1bf553f7fbf6d,0xbf553ec43e48bf35,0x3f0ebf6d3f7bbf35,0xbf463e483ef1bf6d,0x3f22bf7b3f62bec4
.quad 0xbf3500003f35bf80,0x3f35bf803f350000,0xbf22be483f62bf6d,0x3f46bf7b3ef13ec4,0xbf0ebec43f7bbf35,0x3f55bf6d3e483f35,0xbef1bf0e3f7fbec4,0x3f62bf55bdc93f6d
.quad 0xbec4bf353f6d0000,0x3f6dbf35bec43f80,0xbe95bf553f463ec4,0x3f75bf0ebf223f6d,0xbe48bf6d3f0e3f35,0x3f7bbec4bf553f35,0xbdc9bf7b3e953f6d,0x3f7fbe48bf753ec4
.quad 0xbf8000003f80,0x3f800000bf800000,0xbe95bf7b3dc93f80,0x3f75be48bf7f0000,0xbf0ebf6d3e483f80,0x3f55bec4bf7b0000,0xbf46bf553e953f80,0x3f22bf0ebf750000
.quad 0xbf6dbf353ec43f80,0x3ec4bf35bf6d0000,0xbf7fbf0e3ef13f80,0x3dc9bf55bf620000,0xbf7bbec43f0e3f80,0xbe48bf6dbf550000,0xbf62be483f223f80,0xbef1bf7bbf460000
.quad 0xbf3500003f353f80,0xbf35bf80bf350000,0xbef13e483f463f80,0xbf62bf7bbf220000,0xbe483ec43f553f80,0xbf7bbf6dbf0e0000,0x3dc93f0e3f623f80,0xbf7fbf55bef10000
.quad 0x3ec43f353f6d3f80,0xbf6dbf35bec40000,0x3f223f553f753f80,0xbf46bf0ebe950000,0x3f553f6d3f7b3f80,0xbf0ebec4be480000,0x3f753f7b3f7f3f80,0xbe95be48bdc90000
.quad 0xbf8000003f80,0x3f800000bf800000,0xbf22bf553ef13f6d,0x3f46bf0ebf623ec4,0xbf7bbec43f553f35,0x3e48bf6dbf0e3f35,0xbf623e483f7f3ec4,0xbef1bf7bbdc93f6d
.quad 0xbec43f353f6d0000,0xbf6dbf353ec43f80,0x3e953f7b3f22bec4,0xbf75be483f463f6d,0x3f553f6d3e48bf35,0xbf0e3ec43f7b3f35,0x3f7f3f0ebe95bf6d,0x3dc93f553f753ec4
.quad 0x3f350000bf35bf80,0x3f353f803f350000,0x3dc9bf0ebf75bf6d,0x3f7f3f553e95bec4,0xbf0ebf6dbf7bbf35,0x3f553ec4be48bf35,0xbf75bf7bbf46bec4,0x3e95be48bf22bf6d
.quad 0xbf6dbf35bec40000,0xbec4bf35bf6dbf80,0xbef1be483dc93ec4,0xbf62bf7bbf7fbf6d,0x3e483ec43f0e3f35,0xbf7bbf6dbf55bf35,0x3f463f553f623f6d,0xbf22bf0ebef1bec4
.quad 0xbf8000003f80,0x3f800000bf800000,0xbf62bf0e3f463f35,0x3ef1bf55bf223f35,0xbf553ec43f7b0000,0xbf0ebf6d3e483f80,0x3dc93f7b3ef1bf35,0xbf7fbe483f623f35
.quad 0x3f6d3f35bec4bf80,0xbec43f353f6d0000,0x3f46be48bf75bf35,0x3f223f7b3e95bf35,0xbe48bf6dbf550000,0x3f7b3ec4bf0ebf80,0xbf75bf55bdc93f35,0x3e95bf0ebf7fbf35
.quad 0xbf3500003f353f80,0xbf35bf80bf350000,0x3e953f553f7f3f35,0xbf75bf0e3dc93f35,0x3f7b3f6d3f0e0000,0xbe483ec43f553f80,0x3f223e48be95bf35,0x3f463f7b3f753f35
.quad 0xbec4bf35bf6dbf80,0x3f6d3f353ec40000,0xbf7fbf7bbf62bf35,0x3dc9be48bef1bf35,0xbf0ebec4be480000,0xbf55bf6dbf7bbf80,0x3ef13f0e3f223f35,0xbf62bf55bf46bf35
.quad 0xbf8000003f80,0x3f800000bf800000,0xbf7fbe483f753ec4,0x3dc9bf7bbe953f6d,0xbe483f6d3f0ebf35,0xbf7bbec43f553f35,0x3f753f0ebf22bf6d,0xbe953f553f46bec4
.quad 0x3ec4bf35bf6d0000,0x3f6d3f35bec4bf80,0xbf62bf553dc93f6d,0x3ef1bf0ebf7fbec4,0xbf0e3ec43f7b3f35,0xbf55bf6dbe483f35,0x3f463f7b3ef1bec4,0xbf223e483f623f6d
.quad 0x3f350000bf35bf80,0x3f353f803f350000,0xbf22bf7bbf62bec4,0x3f463e48bef1bf6d,0xbf55bec43e483f35,0xbf0ebf6dbf7bbf35,0x3ef13f553f7f3f6d,0xbf62bf0ebdc93ec4
.quad 0x3f6d3f353ec40000,0x3ec43f353f6d3f80,0xbe95bf0ebf46bf6d,0x3f753f553f223ec4,0xbf7bbf6dbf55bf35,0xbe48bec4bf0ebf35,0x3dc93e483e953ec4,0xbf7fbf7bbf75bf6d
.quad 0xbf8000003f80,0x3f800000bf800000,0xbf753e483f7f0000,0xbe95bf7b3dc93f80,0x3f0e3f6dbe48bf80,0xbf553ec43f7b0000,0x3f22bf0ebf750000,0x3f463f55be95bf80
.quad 0xbf6dbf353ec43f80,0x3ec4bf35bf6d0000,0xbdc93f553f620000,0xbf7fbf0e3ef13f80,0x3f7b3ec4bf0ebf80,0x3e483f6d3f550000,0xbef1bf7bbf460000,0x3f623e48bf22bf80
.quad 0xbf3500003f353f80,0xbf35bf80bf350000,0x3f623f7b3f220000,0xbef13e483f463f80,0x3e48bec4bf55bf80,0x3f7b3f6d3f0e0000,0xbf7fbf55bef10000,0xbdc9bf0ebf62bf80
.quad 0x3ec43f353f6d3f80,0xbf6dbf35bec40000,0x3f463f0e3e950000,0x3f223f553f753f80,0xbf55bf6dbf7bbf80,0x3f0e3ec43e480000,0xbe95be48bdc90000,0xbf75bf7bbf7fbf80
.quad 0xbf8000003f80,0x3f800000bf800000,0xbf463f0e3f62bec4,0xbf22bf553ef13f6d,0x3f7b3ec4bf55bf35,0xbe483f6d3f0ebf35,0xbef1bf7bbdc93f6d,0x3f62be48bf7fbec4
.quad 0xbec43f353f6d0000,0xbf6dbf353ec43f80,0x3f753e48bf46bf6d,0x3e953f7b3f22bec4,0xbf55bf6dbe483f35,0x3f0ebec4bf7bbf35,0x3dc93f553f753ec4,0xbf7fbf0e3e953f6d
.quad 0x3f350000bf35bf80,0x3f353f803f350000,0xbf7fbf55be953ec4,0x3dc9bf0ebf75bf6d,0x3f0e3f6d3f7b3f35,0xbf55bec43e483f35,0x3e95be48bf22bf6d,0x3f753f7b3f463ec4
.quad 0xbf6dbf35bec40000,0xbec4bf35bf6dbf80,0x3f623f7b3f7f3f6d,0xbef1be483dc93ec4,0xbe48bec4bf0ebf35,0x3f7b3f6d3f553f35,0xbf22bf0ebef1bec4,0xbf46bf55bf62bf6d
.quad 0xbf8000003f80,0x3f800000bf800000,0xbef13f553f22bf35,0xbf62bf0e3f463f35,0x3f55bec4bf7b0000,0x3f0e3f6dbe48bf80,0xbf7fbe483f623f35,0xbdc9bf7bbef13f35
.quad 0x3f6d3f35bec4bf80,0xbec43f353f6d0000,0xbf22bf7bbe953f35,0x3f46be48bf75bf35,0x3e483f6d3f550000,0xbf7bbec43f0e3f80,0x3e95bf0ebf7fbf35,0x3f753f553dc9bf35
.quad 0xbf3500003f353f80,0xbf35bf80bf350000,0x3f753f0ebdc9bf35,0x3e953f553f7f3f35,0xbf7bbf6dbf0e0000,0x3e48bec4bf55bf80,0x3f463f7b3f753f35,0xbf22be483e953f35
.quad 0xbec4bf35bf6dbf80,0x3f6d3f353ec40000,0xbdc93e483ef13f35,0xbf7fbf7bbf62bf35,0x3f0e3ec43e480000,0x3f553f6d3f7b3f80,0xbf62bf55bf46bf35,0xbef1bf0ebf22bf35
.quad 0xbf8000003f80,0x3f800000bf800000,0xbdc93f7b3e95bf6d,0xbf7fbe483f753ec4,0x3e48bf6dbf0e3f35,0x3f7b3ec4bf55bf35,0xbe953f553f46bec4,0xbf75bf0e3f223f6d
.quad 0x3ec4bf35bf6d0000,0x3f6d3f35bec4bf80,0xbef13f0e3f7f3ec4,0xbf62bf553dc93f6d,0x3f0ebec4bf7bbf35,0x3f553f6d3e48bf35,0xbf223e483f623f6d,0xbf46bf7bbef13ec4
.quad 0x3f350000bf35bf80,0x3f353f803f350000,0xbf46be483ef13f6d,0xbf22bf7bbf62bec4,0x3f553ec4be48bf35,0x3f0e3f6d3f7b3f35,0xbf62bf0ebdc93ec4,0xbef1bf55bf7fbf6d
.quad 0x3f6d3f353ec40000,0x3ec43f353f6d3f80,0xbf75bf55bf22bec4,0xbe95bf0ebf46bf6d,0x3f7b3f6d3f553f35,0x3e483ec43f0e3f35,0xbf7fbf7bbf75bf6d,0xbdc9be48be95bec4
.quad 0xbf8000003f80,0x3f800000bf800000,0x3e953f7bbdc9bf80,0xbf753e483f7f0000,0xbf0ebf6d3e483f80,0x3f55bec4bf7b0000,0x3f463f55be95bf80,0xbf223f0e3f750000
.quad 0xbf6dbf353ec43f80,0x3ec4bf35bf6d0000,0x3f7f3f0ebef1bf80,0xbdc93f553f620000,0xbf7bbec43f0e3f80,0xbe48bf6dbf550000,0x3f623e48bf22bf80,0x3ef13f7b3f460000
.quad 0xbf3500003f353f80,0xbf35bf80bf350000,0x3ef1be48bf46bf80,0x3f623f7b3f220000,0xbe483ec43f553f80,0xbf7bbf6dbf0e0000,0xbdc9bf0ebf62bf80,0x3f7f3f553ef10000
.quad 0x3ec43f353f6d3f80,0xbf6dbf35bec40000,0xbf22bf55bf75bf80,0x3f463f0e3e950000,0x3f553f6d3f7b3f80,0xbf0ebec4be480000,0xbf75bf7bbf7fbf80,0x3e953e483dc90000
.quad 0xbf8000003f80,0x3f800000bf800000,0x3f223f55bef1bf6d,0xbf463f0e3f62bec4,0xbf7bbec43f553f35,0x3e48bf6dbf0e3f35,0x3f62be48bf7fbec4,0x3ef13f7b3dc9bf6d
.quad 0xbec43f353f6d0000,0xbf6dbf353ec43f80,0xbe95bf7bbf223ec4,0x3f753e48bf46bf6d,0x3f553f6d3e48bf35,0xbf0e3ec43f7b3f35,0xbf7fbf0e3e953f6d,0xbdc9bf55bf75bec4
.quad 0x3f350000bf35bf80,0x3f353f803f350000,0xbdc93f0e3f753f6d,0xbf7fbf55be953ec4,0xbf0ebf6dbf7bbf35,0x3f553ec4be48bf35,0x3f753f7b3f463ec4,0xbe953e483f223f6d
.quad 0xbf6dbf35bec40000,0xbec4bf35bf6dbf80,0x3ef13e48bdc9bec4,0x3f623f7b3f7f3f6d,0x3e483ec43f0e3f35,0xbf7bbf6dbf55bf35,0xbf46bf55bf62bf6d,0x3f223f0e3ef13ec4
.quad 0xbf8000003f80,0x3f800000bf800000,0x3f623f0ebf46bf35,0xbef13f553f22bf35,0xbf553ec43f7b0000,0xbf0ebf6d3e483f80,0xbdc9bf7bbef13f35,0x3f7f3e48bf62bf35
.quad 0x3f6d3f35bec4bf80,0xbec43f353f6d0000,0xbf463e483f753f35,0xbf22bf7bbe953f35,0xbe48bf6dbf550000,0x3f7b3ec4bf0ebf80,0x3f753f553dc9bf35,0xbe953f0e3f7f3f35
.quad 0xbf3500003f353f80,0xbf35bf80bf350000,0xbe95bf55bf7fbf35,0x3f753f0ebdc9bf35,0x3f7b3f6d3f0e0000,0xbe483ec43f553f80,0xbf22be483e953f35,0xbf46bf7bbf75bf35
.quad 0xbec4bf35bf6dbf80,0x3f6d3f353ec40000,0x3f7f3f7b3f623f35,0xbdc93e483ef13f35,0xbf0ebec4be480000,0xbf55bf6dbf7bbf80,0xbef1bf0ebf22bf35,0x3f623f553f463f35
.quad 0xbf8000003f80,0x3f800000bf800000,0x3f7f3e48bf75bec4,0xbdc93f7b3e95bf6d,0xbe483f6d3f0ebf35,0xbf7bbec43f553f35,0xbf75bf0e3f223f6d,0x3e95bf55bf463ec4
.quad 0x3ec4bf35bf6d0000,0x3f6d3f35bec4bf80,0x3f623f55bdc9bf6d,0xbef13f0e3f7f3ec4,0xbf0e3ec43f7b3f35,0xbf55bf6dbe483f35,0xbf46bf7bbef13ec4,0x3f22be48bf62bf6d
.quad 0x3f350000bf35bf80,0x3f353f803f350000,0x3f223f7b3f623ec4,0xbf46be483ef13f6d,0xbf55bec43e483f35,0xbf0ebf6dbf7bbf35,0xbef1bf55bf7fbf6d,0x3f623f0e3dc9bec4
.quad 0x3f6d3f353ec40000,0x3ec43f353f6d3f80,0x3e953f0e3f463f6d,0xbf75bf55bf22bec4,0xbf7bbf6dbf55bf35,0xbe48bec4bf0ebf35,0xbdc9be48be95bec4,0x3f7f3f7b3f753f6d
.quad 0xbf8000003f80,0x3f800000bf800000,0x3f75be48bf7f0000,0x3e953f7bbdc9bf80,0x3f0e3f6dbe48bf80,0xbf553ec43f7b0000,0xbf223f0e3f750000,0xbf46bf553e953f80
.quad 0xbf6dbf353ec43f80,0x3ec4bf35bf6d0000,0x3dc9bf55bf620000,0x3f7f3f0ebef1bf80,0x3f7b3ec4bf0ebf80,0x3e483f6d3f550000,0x3ef13f7b3f460000,0xbf62be483f223f80
.quad 0xbf3500003f353f80,0xbf35bf80bf350000,0xbf62bf7bbf220000,0x3ef1be48bf46bf80,0x3e48bec4bf55bf80,0x3f7b3f6d3f0e0000,0x3f7f3f553ef10000,0x3dc93f0e3f623f80
.quad 0x3ec43f353f6d3f80,0xbf6dbf35bec40000,0xbf46bf0ebe950000,0xbf22bf55bf75bf80,0xbf55bf6dbf7bbf80,0x3f0e3ec43e480000,0x3e953e483dc90000,0x3f753f7b3f7f3f80
.quad 0xbf8000003f80,0x3f800000bf800000,0x3f46bf0ebf623ec4,0x3f223f55bef1bf6d,0x3f7b3ec4bf55bf35,0xbe483f6d3f0ebf35,0x3ef13f7b3dc9bf6d,0xbf623e483f7f3ec4
.quad 0xbec43f353f6d0000,0xbf6dbf353ec43f80,0xbf75be483f463f6d,0xbe95bf7bbf223ec4,0xbf55bf6dbe483f35,0x3f0ebec4bf7bbf35,0xbdc9bf55bf75bec4,0x3f7f3f0ebe95bf6d
.quad 0x3f350000bf35bf80,0x3f353f803f350000,0x3f7f3f553e95bec4,0xbdc93f0e3f753f6d,0x3f0e3f6d3f7b3f35,0xbf55bec43e483f35,0xbe953e483f223f6d,0xbf75bf7bbf46bec4
.quad 0xbf6dbf35bec40000,0xbec4bf35bf6dbf80,0xbf62bf7bbf7fbf6d,0x3ef13e48bdc9bec4,0xbe48bec4bf0ebf35,0x3f7b3f6d3f553f35,0x3f223f0e3ef13ec4,0x3f463f553f623f6d
.quad 0xbf8000003f80,0x3f800000bf800000,0x3ef1bf55bf223f35,0x3f623f0ebf46bf35,0x3f55bec4bf7b0000,0x3f0e3f6dbe48bf80,0x3f7f3e48bf62bf35,0x3dc93f7b3ef1bf35
.quad 0x3f6d3f35bec4bf80,0xbec43f353f6d0000,0x3f223f7b3e95bf35,0xbf463e483f753f35,0x3e483f6d3f550000,0xbf7bbec43f0e3f80,0xbe953f0e3f7f3f35,0xbf75bf55bdc93f35
.quad 0xbf3500003f353f80,0xbf35bf80bf350000,0xbf75bf0e3dc93f35,0xbe95bf55bf7fbf35,0xbf7bbf6dbf0e0000,0x3e48bec4bf55bf80,0xbf46bf7bbf75bf35,0x3f223e48be95bf35
.quad 0xbec4bf35bf6dbf80,0x3f6d3f353ec40000,0x3dc9be48bef1bf35,0x3f7f3f7b3f623f35,0x3f0e3ec43e480000,0x3f553f6d3f7b3f80,0x3f623f553f463f35,0x3ef13f0e3f223f35
.quad 0xbf8000003f80,0x3f800000bf800000,0x3dc9bf7bbe953f6d,0x3f7f3e48bf75bec4,0x3e48bf6dbf0e3f35,0x3f7b3ec4bf55bf35,0x3e95bf55bf463ec4,0x3f753f0ebf22bf6d
.quad 0x3ec4bf35bf6d0000,0x3f6d3f35bec4bf80,0x3ef1bf0ebf7fbec4,0x3f623f55bdc9bf6d,0x3f0ebec4bf7bbf35,0x3f553f6d3e48bf35,0x3f22be48bf62bf6d,0x3f463f7b3ef1bec4
.quad 0x3f350000bf35bf80,0x3f353f803f350000,0x3f463e48bef1bf6d,0x3f223f7b3f623ec4,0x3f553ec4be48bf35,0x3f0e3f6d3f7b3f35,0x3f623f0e3dc9bec4,0x3ef13f553f7f3f6d
.quad 0x3f6d3f353ec40000,0x3ec43f353f6d3f80,0x3f753f553f223ec4,0x3e953f0e3f463f6d,0x3f7b3f6d3f553f35,0x3e483ec43f0e3f35,0x3f7f3f7b3f753f6d,0x3dc93e483e953ec4
.quad 0x3c0000003c00,0x3c0000003c00,0x9a483c0000003c00,0xa0b63c009e483c00,0x9e483c0000003c00,0xa4b63c00a2483c00,0xa0b63c0000003c00,0xa7113bffa4b63c00
.quad 0xa2483c0000003c00,0xa8b63bffa6483bff,0xa3db3c0000003c00,0xa9e33bfea7da3bff,0xa4b63c0000003c00,0xab113bfda8b63bff,0xa57f3c0000003c00,0xac1f3bfca97f3bfe
.quad 0xa6483bff00003c00,0xacb53bfaaa483bfe,0xa7113bff00003c00,0xad4c3bf9ab113bfd,0xa7da3bff00003c00,0xade23bf7abd93bfc,0xa8523bff00003c00,0xae783bf6ac513bfb
.quad 0xa8b63bff00003c00,0xaf0e3bf4acb53bfa,0xa91b3bfe00003c00,0xafa43bf1ad1a3bf9,0xa97f3bfe00003c00,0xb01d3befad7e3bf8,0xa9e33bfe00003c00,0xb0673bedade23bf7
.quad 0x3c0000003c00,0x3c0000003c00,0xa3db3c00a2483c00,0xa57f3c00a4b63c00,0xa7da3bffa6483bff,0xa97f3bfea8b63bff,0xa9e33bfea8b63bff,0xac1f3bfcab113bfd
.quad 0xabd93bfcaa483bfe,0xad7e3bf8acb53bfa,0xace73bfaabd93bfc,0xaedc3bf4ade23bf7,0xade23bf7acb53bfa,0xb01d3befaf0e3bf4,0xaedc3bf4ad7e3bf8,0xb0cb3be9b01d3bef
.quad 0xafd63bf1ae463bf6,0xb1793be2b0b23bea,0xb0673bedaf0e3bf4,0xb2263bdab1473be4,0xb0e43be8afd63bf1,0xb2d23bd1b1db3bdd,0xb1603be3b04e3bed,0xb37d3bc7b26f3bd6
.quad 0xb1db3bddb0b23bea,0xb4143bbcb3033bce,0xb2573bd7b1153be6,0xb4693bb1b3963bc6,0xb2d23bd1b1793be2,0xb4bd3ba4b4143bbc,0xb34c3bcab1db3bdd,0xb5113b97b45d3bb2
.quad 0x3c0000003c00,0x3c0000003c00,0xa7113bffa6483bff,0xa8523bffa7da3bff,0xab113bfdaa483bfe,0xac513bfbabd93bfc,0xad4c3bf9acb53bfa,0xae783bf6ade23bf7
.quad 0xaf0e3bf4ae463bf6,0xb04e3bedafd63bf1,0xb0673bedafd63bf1,0xb1603be3b0e43be8,0xb1473be4b0b23bea,0xb26f3bd6b1db3bdd,0xb2263bdab1793be2,0xb37d3bc7b2d23bd1
.quad 0xb3033bceb23e3bd9,0xb4443bb6b3c63bc3,0xb3df3bc1b3033bce,0xb4c93ba2b45d3bb2,0xb45d3bb2b3c63bc3,0xb54c3b8cb4d53ba0,0xb4c93ba2b4443bb6,0xb5ce3b74b54c3b8c
.quad 0xb5343b91b4a53ba8,0xb64e3b5ab5c23b77,0xb59f3b7db5053b99,0xb6cc3b3eb6373b5f,0xb6083b69b5643b88,0xb7483b20b6aa3b46,0xb6703b53b5c23b77,0xb7c23affb71b3b2b
.quad 0x3c0000003c00,0x3c0000003c00,0xa91b3bfea8b63bff,0xa9e33bfea97f3bfe,0xad1a3bf9acb53bfa,0xade23bf7ad7e3bf8,0xafa43bf1af0e3bf4,0xb0673bedb01d3bef
.quad 0xb1153be6b0b23bea,0xb1db3bddb1793be2,0xb2573bd7b1db3bdd,0xb34c3bcab2d23bd1,0xb3963bc6b3033bce,0xb45d3bb2b4143bbc,0xb4693bb1b4143bbc,0xb5113b97b4bd3ba4
.quad 0xb5053b99b4a53ba8,0xb5c23b77b5643b88,0xb59f3b7db5343b91,0xb6703b53b6083b69,0xb6373b5fb5c23b77,0xb71b3b2bb6aa3b46,0xb6cc3b3eb64e3b5a,0xb7c23affb7483b20
.quad 0xb75e3b1ab6d73b3b,0xb8323ad0b7e33af6,0xb7ee3af3b75e3b1a,0xb8813a9cb83d3ac9,0xb83d3ac9b7e33af6,0xb8ce3a65b8873a99,0xb8813a9cb8323ad0,0xb9183a2bb8ce3a65
.quad 0xaa483bfe00003c00,0xb0b23beaae463bf6,0xaaac3bfd00003c00,0xb0fd3be7aeaa3bf5,0xab113bfd00003c00,0xb1473be4af0e3bf4,0xab753bfd00003c00,0xb1913be1af723bf2
.quad 0xabd93bfc00003c00,0xb1db3bddafd63bf1,0xac1f3bfc00003c00,0xb2263bdab01d3bef,0xac513bfb00003c00,0xb26f3bd6b04e3bed,0xac833bfb00003c00,0xb2b93bd2b0803bec
.quad 0xacb53bfa00003c00,0xb3033bceb0b23bea,0xace73bfa00003c00,0xb34c3bcab0e43be8,0xad1a3bf900003c00,0xb3963bc6b1153be6,0xad4c3bf900003c00,0xb3df3bc1b1473be4
.quad 0xad7e3bf800003c00,0xb4143bbcb1793be2,0xadb03bf800003c00,0xb4383bb7b1aa3be0,0xade23bf700003c00,0xb45d3bb2b1db3bdd,0xae143bf700003c00,0xb4813badb20d3bdb
.quad 0xb3c63bc3b23e3bd9,0xb5643b88b4a53ba8,0xb4203bbbb2a13bd4,0xb5b63b79b4ed3b9d,0xb45d3bb2b3033bce,0xb6083b69b5343b91,0xb4993baab3653bc9,0xb6593b58b57c3b84
.quad 0xb4d53ba0b3c63bc3,0xb6aa3b46b5c23b77,0xb5113b97b4143bbc,0xb6f93b33b6083b69,0xb54c3b8cb4443bb6,0xb7483b20b64e3b5a,0xb5873b82b4753baf,0xb7963b0bb6933b4b
.quad 0xb5c23b77b4a53ba8,0xb7e33af6b6d73b3b,0xb5fd3b6bb4d53ba0,0xb8173ae0b71b3b2b,0xb6373b5fb5053b99,0xb83d3ac9b75e3b1a,0xb6703b53b5343b91,0xb8623ab1b7a13b08
.quad 0xb6aa3b46b5643b88,0xb8873a99b7e33af6,0xb6e33b39b5933b80,0xb8ab3a7fb8123ae3,0xb71b3b2bb5c23b77,0xb8ce3a65b8323ad0,0xb7533b1db5f13b6e,0xb8f13a4bb8523abc
.quad 0xb6d73b3bb61f3b64,0xb81d3addb78b3b0e,0xb73d3b22b67c3b50,0xb8583ab8b7f93af0,0xb7a13b08b6d73b3b,0xb8913a92b8323ad0,0xb8023aedb7323b25,0xb8c93a69b8673aae
.quad 0xb8323ad0b78b3b0e,0xb9003a3fb89b3a8a,0xb8623ab1b7e33af6,0xb9353a13b8ce3a65,0xb8913a92b81d3add,0xb96939e5b9003a3f,0xb8bf3a71b8483ac2,0xb99b39b5b9303a17
.quad 0xb8ec3a4fb8723aa7,0xb9cb3984b95f39ed,0xb9183a2bb89b3a8a,0xb9fa3951b98d39c3,0xb9433a07b8c43a6d,0xba27391db9ba3996,0xb96d39e1b8ec3a4f,0xba5238e7b9e53969
.quad 0xb99639bab9133a2f,0xba7c38b0ba0f393a,0xb9be3992b93a3a0f,0xbaa33877ba373909,0xb9e53969b95f39ed,0xbac9383dba5e38d8,0xba0b393eb98439cb,0xbaed3802ba8338a6
.quad 0xb8c43a6db8723aa7,0xb95f39edb9133a2f,0xb9053a3bb8b03a7c,0xb9a439adb95639f6,0xb9433a07b8ec3a4f,0xb9e53969b99639ba,0xb98039d0b9273a1f,0xba233922b9d4397b
.quad 0xb9ba3996b95f39ed,0xba5e38d8ba0f393a,0xb9f2395bb99639ba,0xba95388cba4738f6,0xba27391db9cb3984,0xbac9383dba7c38b0,0xba5a38ddb9fe394d,0xbaf937d8baae3867
.quad 0xba8a389bba2f3913,0xbb253732badd381d,0xbab83858ba5e38d8,0xbb4e3687bb0837a1,0xbae33812ba8a389b,0xbb7235dabb303705,0xbb0b3796bab5385d,0xbb933529bb553665
.quad 0xbb303705badd381d,0xbbaf3475bb7735c2,0xbb533670bb0237b7,0xbbc7337dbb95351d,0xbb7235dabb253732,0xbbdb320dbbaf3475,0xbb8f3540bb4636aa,0xbbeb3099bbc63396
.quad 0x3c0000003c00,0x3c0000003c00,0xaaac3bfdaa483bfe,0xab753bfdab113bfd,0xaeaa3bf5ae463bf6,0xaf723bf2af0e3bf4,0xb0fd3be7b0b23bea,0xb1913be1b1473be4
.quad 0xb2a13bd4b23e3bd9,0xb3653bc9b3033bce,0xb4203bbbb3c63bc3,0xb4993baab45d3bb2,0xb4ed3b9db4a53ba8,0xb57c3b84b5343b91,0xb5b63b79b5643b88,0xb6593b58b6083b69
.quad 0xb67c3b50b61f3b64,0xb7323b25b6d73b3b,0xb73d3b22b6d73b3b,0xb8023aedb7a13b08,0xb7f93af0b78b3b0e,0xb8673aaeb8323ad0,0xb8583ab8b81d3add,0xb8c93a69b8913a92
.quad 0xb8b03a7cb8723aa7,0xb9273a1fb8ec3a4f,0xb9053a3bb8c43a6d,0xb98039d0b9433a07,0xb95639f6b9133a2f,0xb9d4397bb99639ba,0xb9a439adb95f39ed,0xba233922b9e53969
.quad 0x3c0000003c00,0x3c0000003c00,0xac1f3bfcabd93bfc,0xac833bfbac513bfb,0xb01d3befafd63bf1,0xb0803becb04e3bed,0xb2263bdab1db3bdd,0xb2b93bd2b26f3bd6
.quad 0xb4143bbcb3c63bc3,0xb4753bafb4443bb6,0xb5113b97b4d53ba0,0xb5873b82b54c3b8c,0xb6083b69b5c23b77,0xb6933b4bb64e3b5a,0xb6f93b33b6aa3b46,0xb7963b0bb7483b20
.quad 0xb7e33af6b78b3b0e,0xb8483ac2b81d3add,0xb8623ab1b8323ad0,0xb8bf3a71b8913a92,0xb8ce3a65b89b3a8a,0xb9303a17b9003a3f,0xb9353a13b9003a3f,0xb99b39b5b96939e5
.quad 0xb99639bab95f39ed,0xb9fe394db9cb3984,0xb9f2395bb9ba3996,0xba5a38ddba27391d,0xba4738f6ba0f393a,0xbaae3867ba7c38b0,0xba95388cba5e38d8,0xbaf937d8bac9383d
.quad 0x3c0000003c00,0x3c0000003c00,0xace73bfaacb53bfa,0xad4c3bf9ad1a3bf9,0xb0e43be8b0b23bea,0xb1473be4b1153be6,0xb34c3bcab3033bce,0xb3df3bc1b3963bc6
.quad 0xb4d53ba0b4a53ba8,0xb5343b91b5053b99,0xb5fd3b6bb5c23b77,0xb6703b53b6373b5f,0xb71b3b2bb6d73b3b,0xb7a13b08b75e3b1a,0xb8173ae0b7e33af6,0xb8623ab1b83d3ac9
.quad 0xb89b3a8ab8723aa7,0xb8ec3a4fb8c43a6d,0xb9183a2bb8ec3a4f,0xb96d39e1b9433a07,0xb98d39c3b95f39ed,0xb9e53969b9ba3996,0xb9fa3951b9cb3984,0xba5238e7ba27391d
.quad 0xba5e38d8ba2f3913,0xbab5385dba8a389b,0xbab83858ba8a389b,0xbb0b3796bae33812,0xbb0837a1badd381d,0xbb553665bb303705,0xbb4e3687bb253732,0xbb933529bb7235da
.quad 0x3c0000003c00,0x3c0000003c00,0xadb03bf8ad7e3bf8,0xae143bf7ade23bf7,0xb1aa3be0b1793be2,0xb20d3bdbb1db3bdd,0xb4383bb7b4143bbc,0xb4813badb45d3bb2
.quad 0xb5933b80b5643b88,0xb5f13b6eb5c23b77,0xb6e33b39b6aa3b46,0xb7533b1db71b3b2b,0xb8123ae3b7e33af6,0xb8523abcb8323ad0,0xb8ab3a7fb8873a99,0xb8f13a4bb8ce3a65
.quad 0xb93a3a0fb9133a2f,0xb98439cbb95f39ed,0xb9be3992b99639ba,0xba0b393eb9e53969,0xba373909ba0f393a,0xba8338a6ba5e38d8,0xbaa33877ba7c38b0,0xbaed3802bac9383d
.quad 0xbb0237b7badd381d,0xbb4636aabb253732,0xbb533670bb303705,0xbb8f3540bb7235da,0xbb95351dbb7735c2,0xbbc63396bbaf3475,0xbbc7337dbbaf3475,0xbbeb3099bbdb320d
.quad 0xb9ed395fb9a839a8,0xba6d38c4ba2f3913,0xba33390eb9ed395f,0xbab13862ba7438ba,0xba7438baba2f3913,0xbaf037f9bab5385d,0xbab13862ba6d38c4,0xbb283726baf037f9
.quad 0xbae93807baa73872,0xbb5a364ebb253732,0xbb1d3753badd381d,0xbb863570bb553665,0xbb4b3693bb0e378b,0xbbab348dbb803593,0xbb7435cebb3b36d7,0xbbca334cbba434bd
.quad 0xbb993505bb64361f,0xbbe23179bbc333c6,0xbbb73438bb883564,0xbbf32f40bbdb320d,0xbbd132d2bba834a5,0xbbfd2b11bbed304e,0xbbe5312ebbc333c6,0xbc009a48bbf92d1a
.quad 0xbbf42f0ebbd9323e,0xbbfcabd9bbff2648,0xbbfd2b75bbea30b2,0xbbf1afa4bbffa7da,0xbc001e48bbf62e46,0xbbe0b1aabbf8ad7e,0xbbfea9e3bbfe2a48,0xbbc7b37dbbecb080
.quad 0xbadd381dbaa73872,0xbb3b36d7bb0e378b,0xbb1d3753bae93807,0xbb7435cebb4b3693,0xbb553665bb253732,0xbba434bdbb803593,0xbb863570bb5a364e,0xbbca334cbbab348d
.quad 0xbbaf3475bb883564,0xbbe63115bbce3303,0xbbd032eabbaf3475,0xbbf82db0bbe830e4,0xbbe830e4bbce3303,0xbc0024b6bbf82d7e,0xbbf82db0bbe63115,0xbbfdaaacbc0024b6
.quad 0xbbff2648bbf62e46,0xbbf1afd6bbfeaa48,0xbbfea91bbbff28b6,0xbbdab226bbf2af72,0xbbf5aeaabbffa648,0xbbb9b42cbbddb1db,0xbbe3b160bbf8ad7e,0xbb8fb540bbc0b3f7
.quad 0xbbc9b365bbeab0b2,0xbb5ab64ebb99b505,0xbba6b4b1bbd4b2a1,0xbb1db753bb69b608,0xbb7bb5abbbb6b444,0xbad6b828bb30b705,0xbb49b69ebb91b534,0xba87b8a0baf0b7f9
.quad 0xbb883564bb64361f,0xbbc333c6bba834a5,0xbbb73438bb993505,0xbbe5312ebbd132d2,0xbbdb320dbbc333c6,0xbbf92d1abbed304e,0xbbf32f40bbe23179,0xbc009a48bbfd2b11
.quad 0xbbff28b6bbf62e46,0xbbf8ad7ebbffa648,0xbbfea91bbbff2648,0xbbe3b160bbf5aeaa,0xbbf2af72bbfeaa48,0xbbc0b3f7bbddb1db,0xbbdab226bbf1afd6,0xbb8fb540bbb9b42c
.quad 0xbbb6b444bbd9b23e,0xbb50b67cbb88b564,0xbb86b570bbb6b444,0xbb05b7acbb4bb693,0xbb4bb693bb88b564,0xbaaeb867bb02b7b7,0xbb05b7acbb50b67c,0xba4bb8f1baaeb867
.quad 0xbab5b85dbb0eb78b,0xb9dcb972ba4fb8ec,0xba5ab8ddbac2b848,0xb964b9e9b9e5b969,0xb9f6b956ba6db8c4,0xb8e2ba56b972b9dc,0xb989b9c7ba0fb93a,0xb858bab8b8f6ba47
.quad 0xbbea30b2bbd9323e,0xbbfe2a48bbf62e46,0xbbfd2b75bbf42f0e,0xbbfea9e3bc001e48,0xbbffa7dabbff2648,0xbbecb080bbf8ad7e,0xbbf1afa4bbfcabd9,0xbbc7b37dbbe0b1aa
.quad 0xbbd4b2a1bbeab0b2,0xbb91b534bbb6b444,0xbba6b4b1bbc9b365,0xbb49b69ebb7bb5ab,0xbb69b608bb99b505,0xbaf0b7f9bb30b705,0xbb1db753bb5ab64e,0xba87b8a0bad6b828
.quad 0xbac2b848bb0eb78b,0xba0fb93aba6db8c4,0xba5ab8ddbab5b85d,0xb989b9c7b9f6b956,0xb9e5b969ba4fb8ec,0xb8f6ba47b972b9dc,0xb964b9e9b9dcb972,0xb858bab8b8e2ba56
.quad 0xb8d8ba5eb95fb9ed,0xb75ebb1ab848bac2,0xb842bac6b8d8ba5e,0xb5fdbb6bb748bb20,0xb748bb20b848bac2,0xb48dbbabb5f1bb6e,0xb5fdbb6bb75ebb1a,0xb226bbdab48dbbab
.quad 0x3c0000003c00,0x3c0000003c00,0xae783bf6ae463bf6,0xaedc3bf4aeaa3bf5,0xb26f3bd6b23e3bd9,0xb2d23bd1b2a13bd4,0xb4c93ba2b4a53ba8,0xb5113b97b4ed3b9d
.quad 0xb64e3b5ab61f3b64,0xb6aa3b46b67c3b50,0xb7c23affb78b3b0e,0xb8173ae0b7f93af0,0xb8913a92b8723aa7,0xb8ce3a65b8b03a7c,0xb9353a13b9133a2f,0xb97639d8b95639f6
.quad 0xb9cb3984b9a839a8,0xba0f393ab9ed395f,0xba5238e7ba2f3913,0xba95388cba7438ba,0xbac9383dbaa73872,0xbb0837a1bae93807,0xbb2e3710bb0e378b,0xbb673614bb4b3693
.quad 0xbb803593bb64361f,0xbbaf3475bb993505,0xbbbe3408bba834a5,0xbbe13191bbd132d2,0xbbe830e4bbd9323e,0xbbfb2c51bbf42f0e,0xbbfd2aacbbf62e46,0xbbfea91bbc001e48
.quad 0x3c0000003c00,0x3c0000003c00,0xaf403bf3af0e3bf4,0xafa43bf1af723bf2,0xb3343bcbb3033bce,0xb3963bc6b3653bc9,0xb5583b8ab5343b91,0xb59f3b7db57c3b84
.quad 0xb7053b30b6d73b3b,0xb75e3b1ab7323b25,0xb84d3abfb8323ad0,0xb8813a9cb8673aae,0xb9093a37b8ec3a4f,0xb9433a07b9273a1f,0xb9b5399bb99639ba,0xb9f2395bb9d4397b
.quad 0xba4f38ecba2f3913,0xba8a389bba6d38c4,0xbad3382dbab5385d,0xbb0b3796baf037f9,0xbb4136c1bb253732,0xbb7235dabb5a364e,0xbb973511bb803593,0xbbbe3408bbab348d
.quad 0xbbd432a1bbc333c6,0xbbed304ebbe23179,0xbbf72e14bbed304e,0xbc0023dbbbfd2b11,0xbc00a4b6bbff2648,0xbbf5aeaabbfcabd9,0xbbeeb036bbf8ad7e,0xbbcdb31bbbe0b1aa
.quad 0x3c0000003c00,0x3c0000003c00,0xb0043bf0afd63bf1,0xb0363beeb01d3bef,0xb3f73bc0b3c63bc3,0xb42c3bb9b4143bbc,0xb5e53b70b5c23b77,0xb62b3b62b6083b69
.quad 0xb7b73b02b78b3b0e,0xb8073ae9b7e33af6,0xb8b53a78b89b3a8a,0xb8e73a52b8ce3a65,0xb97b39d4b95f39ed,0xb9b1399fb99639ba,0xba2b3918ba0f393a,0xba6238d3ba4738f6
.quad 0xbac23848baa73872,0xbaf637e3badd381d,0xbb3e36ccbb253732,0xbb6b35fdbb553665,0xbb9d34edbb883564,0xbbc033f7bbaf3475,0xbbdc31f4bbce3303,0xbbf12fa4bbe830e4
.quad 0xbbfc2bd9bbf62e46,0xbc00a248bbff2648,0xbbfcac1fbbffa648,0xbbebb099bbf5aeaa,0xbbdbb20dbbeab0b2,0xbbb2b45dbbc9b365,0xbb9bb4f9bbb6b444,0xbb58b659bb7bb5ab
.quad 0x3c0000003c00,0x3c0000003c00,0xb0673bedb04e3bed,0xb0993bebb0803bec,0xb45d3bb2b4443bb6,0xb48d3babb4753baf,0xb6703b53b64e3b5a,0xb6b53b43b6933b4b
.quad 0xb8323ad0b81d3add,0xb85d3ab5b8483ac2,0xb9183a2bb9003a3f,0xb9483a02b9303a17,0xb9e53969b9cb3984,0xba173930b9fe394d,0xba95388cba7c38b0,0xbac63842baae3867
.quad 0xbb253732bb0e378b,0xbb50367cbb3b36d7,0xbb933529bb803593,0xbbb43451bba434bd,0xbbdb320dbbce3303,0xbbef301dbbe63115,0xbbfd2aacbbf82d7e,0xbc00a3dbbc0024b6
.quad 0xbbf8ad7ebbfeaa48,0xbbe6b115bbf1afd6,0xbbcdb31bbbddb1db,0xbba2b4c9bbb9b42c,0xbb7bb5abbb99b505,0xbb36b6eebb5ab64e,0xbb05b7acbb30b705,0xbaa3b877bad6b828
.quad 0xbbfeaa48bc000000,0xbbeab0b2bbf6ae46,0xbbe9b0cbbbf6ae46,0xbbbeb408bbd6b26f,0xbbc0b3f7bbd9b23e,0xbb7bb5abbba0b4d5,0xbb82b587bba8b4a5,0xbb22b73dbb55b665
.quad 0xbb30b705bb64b61f,0xbab5b85dbaf6b7e3,0xbaccb838bb0eb78b,0xba33b90eba83b8a6,0xba56b8e2baa7b872,0xb99fb9b1b9feb94d,0xb9d0b980ba2fb913,0xb8fbba43b969b9e5
.quad 0xb93aba0fb9a8b9a8,0xb848bac2b8c4ba6d,0xb896ba8eb913ba2f,0xb710bb2eb812bae3,0xb7cdbafcb872baa7,0xb57cbb84b6aabb46,0xb659bb58b78bbb0e,0xb3aebbc4b51dbb95
.quad 0xb4d5bba0b61fbb64,0xb04ebbedb303bbce,0xb288bbd5b4a5bba8,0xa711bbffaf72bbf2,0xaeaabbf5b23ebbd9,0x2d1abbf9a248bc00,0x9a48bc00ae46bbf6,0x31f4bbdc2de2bbf7
.quad 0xbbc3b3c6bbd9b23e,0xbb88b564bba8b4a5,0xbb7db59fbba0b4d5,0xbb28b726bb55b665,0xbb20b748bb50b67c,0xbaaeb867bae9b807,0xbaaab86dbae9b807,0xba1bb92bba65b8ce
.quad 0xba1fb927ba6db8c4,0xb972b9dcb9cbb984,0xb980b9d0b9dcb972,0xb8b5ba78b91dba27,0xb8ceba65b93aba0f,0xb7cdbafcb85dbab5,0xb80dbae6b887ba99,0xb614bb67b71bbb2b
.quad 0xb67cbb50b78bbb0e,0xb444bbb6b564bb88,0xb4c9bba2b5f1bb6e,0xb0cbbbe9b334bbcb,0xb20dbbdbb444bbb6,0xa7dabbffaf0ebbf4,0xace7bbfab115bbe6,0x2db0bbf81e48bc00
.quad 0x28b6bbffaa48bbfe,0x32a1bbd42fd6bbf1,0x30cbbbe92bd9bbfc,0x3529bb933396bbc6,0x342cbbb93179bbe2,0x36eebb363593bb80,0x35e5bb703475bbaf,0x384dbabf3748bb20
.quad 0xbb3bb6d7bb64b61f,0xbaddb81dbb0eb78b,0xbabfb84dbaf6b7e3,0xba43b8fbba83b8a6,0xba27b91dba6db8c4,0xb98db9c3b9dcb972,0xb976b9d8b9cbb984,0xb8bfba71b91dba27
.quad 0xb8b0ba7cb913ba2f,0xb7b7bb02b848bac2,0xb7acbb05b848bac2,0xb5cebb74b6c1bb41,0xb5dabb72b6d7bb3b,0xb396bbc6b4d5bba0,0xb3dfbbc1b505bb99,0xaedcbbf4b1aabbe0
.quad 0xafd6bbf1b23ebbd9,0x2648bbffaa48bbfe,0x1a48bc00acb5bbfa,0x30fdbbe72d1abbf9,0x301dbbef2a48bbfe,0x348dbbab32a1bbd4,0x3408bbbe3179bbe2,0x3687bb4e354cbb8c
.quad 0x35f1bb6e34a5bba8,0x3832bad03732bb25,0x37c2baff367cbb50,0x390eba33387cbaa0,0x38baba74381dbadd,0x39d4b97b394db9fe,0x3980b9d038ecba4f,0x3a7fb8ab3a07b943
.quad 0xba6db8c4baa7b872,0xb9edb95fba2fb913,0xb9b5b99bb9feb94d,0xb918ba2bb969b9e5,0xb8e2ba56b93aba0f,0xb828bad6b887ba99,0xb7eebaf3b85dbab5,0xb642bb5db71bbb2b
.quad 0xb5f1bb6eb6d7bb3b,0xb414bbbcb505bb99,0xb3aebbc4b4d5bba0,0xaf40bbf3b1aabbe0,0xaeaabbf5b179bbe2,0x27dabbffa8b6bbff,0x2852bbffa8b6bbff,0x3191bbe12eaabbf5
.quad 0x3179bbe22e46bbf6,0x3505bb9933c6bbc3,0x34e1bb9e3365bbc9,0x3726bb283608bb69,0x36eebb3635c2bb77,0x3891ba923807bae9,0x386dbaaa37b7bb02,0x3976b9d838f6ba47
.quad 0x394db9fe38c4ba6d,0x3a3fb90039cbb984,0x3a13b9353996b9ba,0x3ae6b80d3a83b8a6,0x3abcb8523a4fb8ec,0x3b69b6083b1ab75e,0x3b43b6b53ae9b807,0x3bc4b3ae3b8cb54c
.quad 0x3c0000003c00,0x3c0000003c00,0xb0cb3be9b0b23bea,0xb0fd3be7b0e43be8,0xb4bd3ba4b4a53ba8,0xb4ed3b9db4d53ba0,0xb6f93b33b6d73b3b,0xb73d3b22b71b3b2b
.quad 0xb8873a99b8723aa7,0xb8b03a7cb89b3a8a,0xb97639d8b95f39ed,0xb9a439adb98d39c3,0xba4738f6ba2f3913,0xba7438baba5e38d8,0xbaf337eebadd381d,0xbb1d3753bb0837a1
.quad 0xbb7735c2bb64361f,0xbb993505bb883564,0xbbd032eabbc333c6,0xbbe5312ebbdb320d,0xbbfb2c51bbf62e46,0xbc001e48bbff28b6,0xbbf9ad4cbbfeaa48,0xbbe9b0cbbbf2af72
.quad 0xbbc9b365bbd9b23e,0xbba0b4d5bbb6b444,0xbb6bb5fdbb88b564,0xbb28b726bb4bb693,0xbae3b812bb0eb78b,0xba83b8a6bab5b85d,0xba33b90eba6db8c4,0xb9b5b99bb9f6b956
.quad 0x3c0000003c00,0x3c0000003c00,0xb12e3be5b1153be6,0xb1603be3b1473be4,0xb51d3b95b5053b99,0xb54c3b8cb5343b91,0xb7803b11b75e3b1a,0xb7c23affb7a13b08
.quad 0xb8d83a5eb8c43a6d,0xb9003a3fb8ec3a4f,0xb9d03980b9ba3996,0xb9fa3951b9e53969,0xbaa0387cba8a389b,0xbac9383dbab5385d,0xbb4336b5bb303705,0xbb673614bb553665
.quad 0xbbb63444bba834a5,0xbbce3303bbc333c6,0xbbf42edcbbed304e,0xbbfd2aacbbf92d1a,0xbbfdab11bbffa648,0xbbf2af72bbf8ad7e,0xbbd0b2eabbddb1db,0xbbadb481bbc0b3f7
.quad 0xbb6eb5f1bb88b564,0xbb30b705bb50b67c,0xbad9b822bb02b7b7,0xba7fb8abbaaeb867,0xba17b930ba4fb8ec,0xb99fb9b1b9dcb972,0xb92bba1bb972b9dc,0xb896ba8eb8e2ba56
.quad 0x3c0000003c00,0x3c0000003c00,0xb1913be1b1793be2,0xb1c33bdfb1aa3be0,0xb57c3b84b5643b88,0xb5ab3b7bb5933b80,0xb8023aedb7e33af6,0xb8223ad9b8123ae3
.quad 0xb9273a1fb9133a2f,0xb94d39feb93a3a0f,0xba233922ba0f393a,0xba4b38f1ba373909,0xbaf037f9badd381d,0xbb143775bb0237b7,0xbb863570bb7735c2,0xbba234c9bb95351d
.quad 0xbbe23179bbd9323e,0xbbf12fd6bbea30b2,0xbc009a48bbff2648,0xbbfdab75bbffa7da,0xbbe0b1aabbeab0b2,0xbbc6b396bbd4b2a1,0xbb82b587bb99b505,0xbb4eb687bb69b608
.quad 0xbae9b807bb0eb78b,0xba99b887bac2b848,0xba1bb92bba4fb8ec,0xb9adb9a4b9e5b969,0xb91dba27b95fb9ed,0xb891ba92b8d8ba5e,0xb7eebaf3b848bac2,0xb69ebb49b748bb20
.quad 0x3c0000003c00,0x3c0000003c00,0xb1f43bdcb1db3bdd,0xb2263bdab20d3bdb,0xb5da3b72b5c23b77,0xb6083b69b5f13b6e,0xb8423ac6b8323ad0,0xb8623ab1b8523abc
.quad 0xb97239dcb95f39ed,0xb99639bab98439cb,0xba7138bfba5e38d8,0xba95388cba8338a6,0xbb3636eebb253732,0xbb553665bb4636aa,0xbbbb3420bbaf3475,0xbbd032eabbc63396
.quad 0xbbfa2cb5bbf62e46,0xbbff2648bbfe2a48,0xbbf3af40bbf8ad7e,0xbbe3b160bbecb080,0xbba4b4bdbbb6b444,0xbb7bb5abbb91b534,0xbb11b780bb30b705,0xbaccb838baf0b7f9
.quad 0xba3fb900ba6db8c4,0xb9dcb972ba0fb93a,0xb935ba13b972b9dc,0xb8b5ba78b8f6ba47,0xb7f9baf0b848bac2,0xb6c1bb41b75ebb1a,0xb540bb8fb5f1bb6e,0xb3aebbc4b48dbbab
.quad 0xb95fb9edb9a8b9a8,0xb8c4ba6db913ba2f,0xb86dbaaab8c4ba6d,0xb76abb17b812bae3,0xb6c1bb41b78bbb0e,0xb51dbb95b5f1bb6e,0xb481bbadb564bb88,0xb160bbe3b334bbcb
.quad 0xb04ebbedb23ebbd9,0xa248bc00acb5bbfa,0x23dbbc00aa48bbfe,0x3099bbeb2d1abbf9,0x3147bbe42e46bbf6,0x34bdbba43365bbc9,0x34f9bb9b33c6bbc3,0x3710bb2e3608bb69
.quad 0x3732bb25361fbb64,0x389bba8a381dbadd,0x38a0ba87381dbadd,0x3992b9be391dba27,0x398db9c33913ba2f,0x3a65b8ce39feb94d,0x3a5ab8dd39edb95f,0x3b11b7803abcb852
.quad 0x3b02b7b73aa7b872,0x3b91b5343b50b67c,0x3b82b5873b3bb6d7,0x3be1b1913bb9b42c,0x3bd6b26f3ba8b4a5,0x3c00a4b63bf4af0e,0x3bfdaaac3beab0b2,0x3bed30673bfe297f
.quad 0xb81dbaddb872baa7,0xb6d7bb3bb78bbb0e,0xb5e5bb70b6aabb46,0xb451bbb4b51dbb95,0xb2d2bbd1b444bbb6,0xaeaabbf5b115bbe6,0xaaacbbfdaf0ebbf4,0x2c1fbbfc1e48bc00
.quad 0x2f0ebbf42a48bbfe,0x3365bbc93179bbe2,0x3451bbb432a1bbd4,0x3642bb5d354cbb8c,0x36c1bb4135c2bb77,0x3852babc37b7bb02,0x3881ba9c3807bae9,0x3964b9e938f6ba47
.quad 0x3984b9cb3913ba2f,0x3a4fb8ec39edb95f,0x3a62b8d339feb94d,0x3b0bb7963abcb852,0x3b14b7753ac2b848,0x3b95b51d3b5ab64e,0x3b97b5113b5ab64e,0x3be7b0fd3bc6b396
.quad 0x3be6b1153bc3b3c6,0x3c0022483bfaacb5,0x3c001a483bf8ad7e,0x3bdf31c33bf72de2,0x3be431473bfa2cb5,0x3b84357c3bbc3414,0x3b9335293bc93365,0x3af337ee3b4b3693
.quad 0xb564bb88b61fbb64,0xb3c6bbc3b4a5bba8,0xb160bbe3b303bbce,0xac1fbbfcaf72bbf2,0x1e48bc00aa48bbfe,0x2f72bbf22bd9bbfc,0x31c3bbdf2fd6bbf1,0x34b1bba63396bbc6
.quad 0x3593bb8034a5bba8,0x375ebb1a367cbb50,0x380dbae63732bb25,0x38e7ba52387cbaa0,0x3930ba1738c4ba6d,0x39f6b9563996b9ba,0x3a2bb91839cbb984,0x3ad3b82d3a83b8a6
.quad 0x3af6b7e33aa7b872,0x3b77b5c23b3bb6d7,0x3b8ab5583b50b67c,0x3bdcb1f43bb9b42c,0x3be4b1473bc3b3c6,0x3c009e483bf8ad7e,0x3c0020b63bfaacb5,0x3be131913bf72de2
.quad 0x3bdd31db3bf62e46,0x3b8035933bb63444,0x3b7d359f3bb63444,0x3ae038173b3636ee,0x3ae338123b3b36d7,0x3a0739433a7c38b0,0x3a1339353a8a389b,0x38fb3a43398d39c3
.quad 0xb0b2bbeab23ebbd9,0xaa48bbfeae46bbf6,0x291bbbfea248bc00,0x3099bbeb2de2bbf7,0x3334bbcb3179bbe2,0x354cbb8c3475bbaf,0x3670bb533593bb80,0x380dbae63748bb20
.quad 0x3887ba99381dbadd,0x394db9fe38ecba4f,0x39adb9a4394db9fe,0x3a5ab8dd3a07b943,0x3aa0b87c3a4fb8ec,0x3b2bb71b3ae9b807,0x3b58b6593b1ab75e,0x3bb7b4383b8cb54c
.quad 0x3bceb3033ba8b4a5,0x3bfaacb53beab0b2,0x3bffa8523bf4af0e,0x3bf12fa43bfe297f,0x3be830e43bfa2cb5,0x3b9d34ed3bc93365,0x3b8a35583bbc3414,0x3aff37c23b4b3693
.quad 0x3ae938073b3b36d7,0x3a1f39273a8a389b,0x3a0b393e3a7c38b0,0x39053a3b398d39c3,0x38f63a47398439cb,0x37753b14385d3ab5,0x376a3b17385d3ab5,0x34993baa36083b69
.quad 0x3c0000003c00,0x3c0000003c00,0x9a483c0000003c00,0xa0b63c009e483c00,0x9e483c0000003c00,0xa4b63c00a2483c00,0xa0b63c0000003c00,0xa7113bffa4b63c00
.quad 0xa2483c0000003c00,0xa8b63bffa6483bff,0xa3db3c0000003c00,0xa9e33bfea7da3bff,0xa4b63c0000003c00,0xab113bfda8b63bff,0xa57f3c0000003c00,0xac1f3bfca97f3bfe
.quad 0xa6483bff00003c00,0xacb53bfaaa483bfe,0xa7113bff00003c00,0xad4c3bf9ab113bfd,0xa7da3bff00003c00,0xade23bf7abd93bfc,0xa8523bff00003c00,0xae783bf6ac513bfb
.quad 0xa8b63bff00003c00,0xaf0e3bf4acb53bfa,0xa91b3bfe00003c00,0xafa43bf1ad1a3bf9,0xa97f3bfe00003c00,0xb01d3befad7e3bf8,0xa9e33bfe00003c00,0xb0673bedade23bf7
.quad 0x3c0000003c00,0x3c0000003c00,0xa3db3c00a2483c00,0xa57f3c00a4b63c00,0xa7da3bffa6483bff,0xa97f3bfea8b63bff,0xa9e33bfea8b63bff,0xac1f3bfcab113bfd
.quad 0xabd93bfcaa483bfe,0xad7e3bf8acb53bfa,0xace73bfaabd93bfc,0xaedc3bf4ade23bf7,0xade23bf7acb53bfa,0xb01d3befaf0e3bf4,0xaedc3bf4ad7e3bf8,0xb0cb3be9b01d3bef
.quad 0xafd63bf1ae463bf6,0xb1793be2b0b23bea,0xb0673bedaf0e3bf4,0xb2263bdab1473be4,0xb0e43be8afd63bf1,0xb2d23bd1b1db3bdd,0xb1603be3b04e3bed,0xb37d3bc7b26f3bd6
.quad 0xb1db3bddb0b23bea,0xb4143bbcb3033bce,0xb2573bd7b1153be6,0xb4693bb1b3963bc6,0xb2d23bd1b1793be2,0xb4bd3ba4b4143bbc,0xb34c3bcab1db3bdd,0xb5113b97b45d3bb2
.quad 0x3c0000003c00,0x3c0000003c00,0xa7113bffa6483bff,0xa8523bffa7da3bff,0xab113bfdaa483bfe,0xac513bfbabd93bfc,0xad4c3bf9acb53bfa,0xae783bf6ade23bf7
.quad 0xaf0e3bf4ae463bf6,0xb04e3bedafd63bf1,0xb0673bedafd63bf1,0xb1603be3b0e43be8,0xb1473be4b0b23bea,0xb26f3bd6b1db3bdd,0xb2263bdab1793be2,0xb37d3bc7b2d23bd1
.quad 0xb3033bceb23e3bd9,0xb4443bb6b3c63bc3,0xb3df3bc1b3033bce,0xb4c93ba2b45d3bb2,0xb45d3bb2b3c63bc3,0xb54c3b8cb4d53ba0,0xb4c93ba2b4443bb6,0xb5ce3b74b54c3b8c
.quad 0xb5343b91b4a53ba8,0xb64e3b5ab5c23b77,0xb59f3b7db5053b99,0xb6cc3b3eb6373b5f,0xb6083b69b5643b88,0xb7483b20b6aa3b46,0xb6703b53b5c23b77,0xb7c23affb71b3b2b
.quad 0x3c0000003c00,0x3c0000003c00,0xa91b3bfea8b63bff,0xa9e33bfea97f3bfe,0xad1a3bf9acb53bfa,0xade23bf7ad7e3bf8,0xafa43bf1af0e3bf4,0xb0673bedb01d3bef
.quad 0xb1153be6b0b23bea,0xb1db3bddb1793be2,0xb2573bd7b1db3bdd,0xb34c3bcab2d23bd1,0xb3963bc6b3033bce,0xb45d3bb2b4143bbc,0xb4693bb1b4143bbc,0xb5113b97b4bd3ba4
.quad 0xb5053b99b4a53ba8,0xb5c23b77b5643b88,0xb59f3b7db5343b91,0xb6703b53b6083b69,0xb6373b5fb5c23b77,0xb71b3b2bb6aa3b46,0xb6cc3b3eb64e3b5a,0xb7c23affb7483b20
.quad 0xb75e3b1ab6d73b3b,0xb8323ad0b7e33af6,0xb7ee3af3b75e3b1a,0xb8813a9cb83d3ac9,0xb83d3ac9b7e33af6,0xb8ce3a65b8873a99,0xb8813a9cb8323ad0,0xb9183a2bb8ce3a65
.quad 0x3c0000003c00,0x3c0000003c00,0xaaac3bfdaa483bfe,0xab753bfdab113bfd,0xaeaa3bf5ae463bf6,0xaf723bf2af0e3bf4,0xb0fd3be7b0b23bea,0xb1913be1b1473be4
.quad 0xb2a13bd4b23e3bd9,0xb3653bc9b3033bce,0xb4203bbbb3c63bc3,0xb4993baab45d3bb2,0xb4ed3b9db4a53ba8,0xb57c3b84b5343b91,0xb5b63b79b5643b88,0xb6593b58b6083b69
.quad 0xb67c3b50b61f3b64,0xb7323b25b6d73b3b,0xb73d3b22b6d73b3b,0xb8023aedb7a13b08,0xb7f93af0b78b3b0e,0xb8673aaeb8323ad0,0xb8583ab8b81d3add,0xb8c93a69b8913a92
.quad 0xb8b03a7cb8723aa7,0xb9273a1fb8ec3a4f,0xb9053a3bb8c43a6d,0xb98039d0b9433a07,0xb95639f6b9133a2f,0xb9d4397bb99639ba,0xb9a439adb95f39ed,0xba233922b9e53969
.quad 0x3c0000003c00,0x3c0000003c00,0xac1f3bfcabd93bfc,0xac833bfbac513bfb,0xb01d3befafd63bf1,0xb0803becb04e3bed,0xb2263bdab1db3bdd,0xb2b93bd2b26f3bd6
.quad 0xb4143bbcb3c63bc3,0xb4753bafb4443bb6,0xb5113b97b4d53ba0,0xb5873b82b54c3b8c,0xb6083b69b5c23b77,0xb6933b4bb64e3b5a,0xb6f93b33b6aa3b46,0xb7963b0bb7483b20
.quad 0xb7e33af6b78b3b0e,0xb8483ac2b81d3add,0xb8623ab1b8323ad0,0xb8bf3a71b8913a92,0xb8ce3a65b89b3a8a,0xb9303a17b9003a3f,0xb9353a13b9003a3f,0xb99b39b5b96939e5
.quad 0xb99639bab95f39ed,0xb9fe394db9cb3984,0xb9f2395bb9ba3996,0xba5a38ddba27391d,0xba4738f6ba0f393a,0xbaae3867ba7c38b0,0xba95388cba5e38d8,0xbaf937d8bac9383d
.quad 0x3c0000003c00,0x3c0000003c00,0xace73bfaacb53bfa,0xad4c3bf9ad1a3bf9,0xb0e43be8b0b23bea,0xb1473be4b1153be6,0xb34c3bcab3033bce,0xb3df3bc1b3963bc6
.quad 0xb4d53ba0b4a53ba8,0xb5343b91b5053b99,0xb5fd3b6bb5c23b77,0xb6703b53b6373b5f,0xb71b3b2bb6d73b3b,0xb7a13b08b75e3b1a,0xb8173ae0b7e33af6,0xb8623ab1b83d3ac9
.quad 0xb89b3a8ab8723aa7,0xb8ec3a4fb8c43a6d,0xb9183a2bb8ec3a4f,0xb96d39e1b9433a07,0xb98d39c3b95f39ed,0xb9e53969b9ba3996,0xb9fa3951b9cb3984,0xba5238e7ba27391d
.quad 0xba5e38d8ba2f3913,0xbab5385dba8a389b,0xbab83858ba8a389b,0xbb0b3796bae33812,0xbb0837a1badd381d,0xbb553665bb303705,0xbb4e3687bb253732,0xbb933529bb7235da
.quad 0x3c0000003c00,0x3c0000003c00,0xadb03bf8ad7e3bf8,0xae143bf7ade23bf7,0xb1aa3be0b1793be2,0xb20d3bdbb1db3bdd,0xb4383bb7b4143bbc,0xb4813badb45d3bb2
.quad 0xb5933b80b5643b88,0xb5f13b6eb5c23b77,0xb6e33b39b6aa3b46,0xb7533b1db71b3b2b,0xb8123ae3b7e33af6,0xb8523abcb8323ad0,0xb8ab3a7fb8873a99,0xb8f13a4bb8ce3a65
.quad 0xb93a3a0fb9133a2f,0xb98439cbb95f39ed,0xb9be3992b99639ba,0xba0b393eb9e53969,0xba373909ba0f393a,0xba8338a6ba5e38d8,0xbaa33877ba7c38b0,0xbaed3802bac9383d
.quad 0xbb0237b7badd381d,0xbb4636aabb253732,0xbb533670bb303705,0xbb8f3540bb7235da,0xbb95351dbb7735c2,0xbbc63396bbaf3475,0xbbc7337dbbaf3475,0xbbeb3099bbdb320d
.quad 0xaa483bfe00003c00,0xb0b23beaae463bf6,0xaaac3bfd00003c00,0xb0fd3be7aeaa3bf5,0xab113bfd00003c00,0xb1473be4af0e3bf4,0xab753bfd00003c00,0xb1913be1af723bf2
.quad 0xabd93bfc00003c00,0xb1db3bddafd63bf1,0xac1f3bfc00003c00,0xb2263bdab01d3bef,0xac513bfb00003c00,0xb26f3bd6b04e3bed,0xac833bfb00003c00,0xb2b93bd2b0803bec
.quad 0xacb53bfa00003c00,0xb3033bceb0b23bea,0xace73bfa00003c00,0xb34c3bcab0e43be8,0xad1a3bf900003c00,0xb3963bc6b1153be6,0xad4c3bf900003c00,0xb3df3bc1b1473be4
.quad 0xad7e3bf800003c00,0xb4143bbcb1793be2,0xadb03bf800003c00,0xb4383bb7b1aa3be0,0xade23bf700003c00,0xb45d3bb2b1db3bdd,0xae143bf700003c00,0xb4813badb20d3bdb
.quad 0xb3c63bc3b23e3bd9,0xb5643b88b4a53ba8,0xb4203bbbb2a13bd4,0xb5b63b79b4ed3b9d,0xb45d3bb2b3033bce,0xb6083b69b5343b91,0xb4993baab3653bc9,0xb6593b58b57c3b84
.quad 0xb4d53ba0b3c63bc3,0xb6aa3b46b5c23b77,0xb5113b97b4143bbc,0xb6f93b33b6083b69,0xb54c3b8cb4443bb6,0xb7483b20b64e3b5a,0xb5873b82b4753baf,0xb7963b0bb6933b4b
.quad 0xb5c23b77b4a53ba8,0xb7e33af6b6d73b3b,0xb5fd3b6bb4d53ba0,0xb8173ae0b71b3b2b,0xb6373b5fb5053b99,0xb83d3ac9b75e3b1a,0xb6703b53b5343b91,0xb8623ab1b7a13b08
.quad 0xb6aa3b46b5643b88,0xb8873a99b7e33af6,0xb6e33b39b5933b80,0xb8ab3a7fb8123ae3,0xb71b3b2bb5c23b77,0xb8ce3a65b8323ad0,0xb7533b1db5f13b6e,0xb8f13a4bb8523abc
.quad 0xb6d73b3bb61f3b64,0xb81d3addb78b3b0e,0xb73d3b22b67c3b50,0xb8583ab8b7f93af0,0xb7a13b08b6d73b3b,0xb8913a92b8323ad0,0xb8023aedb7323b25,0xb8c93a69b8673aae
.quad 0xb8323ad0b78b3b0e,0xb9003a3fb89b3a8a,0xb8623ab1b7e33af6,0xb9353a13b8ce3a65,0xb8913a92b81d3add,0xb96939e5b9003a3f,0xb8bf3a71b8483ac2,0xb99b39b5b9303a17
.quad 0xb8ec3a4fb8723aa7,0xb9cb3984b95f39ed,0xb9183a2bb89b3a8a,0xb9fa3951b98d39c3,0xb9433a07b8c43a6d,0xba27391db9ba3996,0xb96d39e1b8ec3a4f,0xba5238e7b9e53969
.quad 0xb99639bab9133a2f,0xba7c38b0ba0f393a,0xb9be3992b93a3a0f,0xbaa33877ba373909,0xb9e53969b95f39ed,0xbac9383dba5e38d8,0xba0b393eb98439cb,0xbaed3802ba8338a6
.quad 0xb8c43a6db8723aa7,0xb95f39edb9133a2f,0xb9053a3bb8b03a7c,0xb9a439adb95639f6,0xb9433a07b8ec3a4f,0xb9e53969b99639ba,0xb98039d0b9273a1f,0xba233922b9d4397b
.quad 0xb9ba3996b95f39ed,0xba5e38d8ba0f393a,0xb9f2395bb99639ba,0xba95388cba4738f6,0xba27391db9cb3984,0xbac9383dba7c38b0,0xba5a38ddb9fe394d,0xbaf937d8baae3867
.quad 0xba8a389bba2f3913,0xbb253732badd381d,0xbab83858ba5e38d8,0xbb4e3687bb0837a1,0xbae33812ba8a389b,0xbb7235dabb303705,0xbb0b3796bab5385d,0xbb933529bb553665
.quad 0xbb303705badd381d,0xbbaf3475bb7735c2,0xbb533670bb0237b7,0xbbc7337dbb95351d,0xbb7235dabb253732,0xbbdb320dbbaf3475,0xbb8f3540bb4636aa,0xbbeb3099bbc63396
.quad 0xb9ed395fb9a839a8,0xba6d38c4ba2f3913,0xba33390eb9ed395f,0xbab13862ba7438ba,0xba7438baba2f3913,0xbaf037f9bab5385d,0xbab13862ba6d38c4,0xbb283726baf037f9
.quad 0xbae93807baa73872,0xbb5a364ebb253732,0xbb1d3753badd381d,0xbb863570bb553665,0xbb4b3693bb0e378b,0xbbab348dbb803593,0xbb7435cebb3b36d7,0xbbca334cbba434bd
.quad 0xbb993505bb64361f,0xbbe23179bbc333c6,0xbbb73438bb883564,0xbbf32f40bbdb320d,0xbbd132d2bba834a5,0xbbfd2b11bbed304e,0xbbe5312ebbc333c6,0xbc009a48bbf92d1a
.quad 0xbbf42f0ebbd9323e,0xbbfcabd9bbff2648,0xbbfd2b75bbea30b2,0xbbf1afa4bbffa7da,0xbc001e48bbf62e46,0xbbe0b1aabbf8ad7e,0xbbfea9e3bbfe2a48,0xbbc7b37dbbecb080
.quad 0xbadd381dbaa73872,0xbb3b36d7bb0e378b,0xbb1d3753bae93807,0xbb7435cebb4b3693,0xbb553665bb253732,0xbba434bdbb803593,0xbb863570bb5a364e,0xbbca334cbbab348d
.quad 0xbbaf3475bb883564,0xbbe63115bbce3303,0xbbd032eabbaf3475,0xbbf82db0bbe830e4,0xbbe830e4bbce3303,0xbc0024b6bbf82d7e,0xbbf82db0bbe63115,0xbbfdaaacbc0024b6
.quad 0xbbff2648bbf62e46,0xbbf1afd6bbfeaa48,0xbbfea91bbbff28b6,0xbbdab226bbf2af72,0xbbf5aeaabbffa648,0xbbb9b42cbbddb1db,0xbbe3b160bbf8ad7e,0xbb8fb540bbc0b3f7
.quad 0xbbc9b365bbeab0b2,0xbb5ab64ebb99b505,0xbba6b4b1bbd4b2a1,0xbb1db753bb69b608,0xbb7bb5abbbb6b444,0xbad6b828bb30b705,0xbb49b69ebb91b534,0xba87b8a0baf0b7f9
.quad 0xbb883564bb64361f,0xbbc333c6bba834a5,0xbbb73438bb993505,0xbbe5312ebbd132d2,0xbbdb320dbbc333c6,0xbbf92d1abbed304e,0xbbf32f40bbe23179,0xbc009a48bbfd2b11
.quad 0xbbff28b6bbf62e46,0xbbf8ad7ebbffa648,0xbbfea91bbbff2648,0xbbe3b160bbf5aeaa,0xbbf2af72bbfeaa48,0xbbc0b3f7bbddb1db,0xbbdab226bbf1afd6,0xbb8fb540bbb9b42c
.quad 0xbbb6b444bbd9b23e,0xbb50b67cbb88b564,0xbb86b570bbb6b444,0xbb05b7acbb4bb693,0xbb4bb693bb88b564,0xbaaeb867bb02b7b7,0xbb05b7acbb50b67c,0xba4bb8f1baaeb867
.quad 0xbab5b85dbb0eb78b,0xb9dcb972ba4fb8ec,0xba5ab8ddbac2b848,0xb964b9e9b9e5b969,0xb9f6b956ba6db8c4,0xb8e2ba56b972b9dc,0xb989b9c7ba0fb93a,0xb858bab8b8f6ba47
.quad 0xbbea30b2bbd9323e,0xbbfe2a48bbf62e46,0xbbfd2b75bbf42f0e,0xbbfea9e3bc001e48,0xbbffa7dabbff2648,0xbbecb080bbf8ad7e,0xbbf1afa4bbfcabd9,0xbbc7b37dbbe0b1aa
.quad 0xbbd4b2a1bbeab0b2,0xbb91b534bbb6b444,0xbba6b4b1bbc9b365,0xbb49b69ebb7bb5ab,0xbb69b608bb99b505,0xbaf0b7f9bb30b705,0xbb1db753bb5ab64e,0xba87b8a0bad6b828
.quad 0xbac2b848bb0eb78b,0xba0fb93aba6db8c4,0xba5ab8ddbab5b85d,0xb989b9c7b9f6b956,0xb9e5b969ba4fb8ec,0xb8f6ba47b972b9dc,0xb964b9e9b9dcb972,0xb858bab8b8e2ba56
.quad 0xb8d8ba5eb95fb9ed,0xb75ebb1ab848bac2,0xb842bac6b8d8ba5e,0xb5fdbb6bb748bb20,0xb748bb20b848bac2,0xb48dbbabb5f1bb6e,0xb5fdbb6bb75ebb1a,0xb226bbdab48dbbab
.quad 0xae463bf600003c00,0xb4a53ba8b23e3bd9,0xae783bf600003c00,0xb4c93ba2b26f3bd6,0xaeaa3bf500003c00,0xb4ed3b9db2a13bd4,0xaedc3bf400003c00,0xb5113b97b2d23bd1
.quad 0xaf0e3bf400003c00,0xb5343b91b3033bce,0xaf403bf300003c00,0xb5583b8ab3343bcb,0xaf723bf200003c00,0xb57c3b84b3653bc9,0xafa43bf100003c00,0xb59f3b7db3963bc6
.quad 0xafd63bf100003c00,0xb5c23b77b3c63bc3,0xb0043bf000003c00,0xb5e53b70b3f73bc0,0xb01d3bef00003c00,0xb6083b69b4143bbc,0xb0363bee00003c00,0xb62b3b62b42c3bb9
.quad 0xb04e3bed00003c00,0xb64e3b5ab4443bb6,0xb0673bed00003c00,0xb6703b53b45d3bb2,0xb0803bec00003c00,0xb6933b4bb4753baf,0xb0993beb00003c00,0xb6b53b43b48d3bab
.quad 0xb78b3b0eb61f3b64,0xb9133a2fb8723aa7,0xb7c23affb64e3b5a,0xb9353a13b8913a92,0xb7f93af0b67c3b50,0xb95639f6b8b03a7c,0xb8173ae0b6aa3b46,0xb97639d8b8ce3a65
.quad 0xb8323ad0b6d73b3b,0xb99639bab8ec3a4f,0xb84d3abfb7053b30,0xb9b5399bb9093a37,0xb8673aaeb7323b25,0xb9d4397bb9273a1f,0xb8813a9cb75e3b1a,0xb9f2395bb9433a07
.quad 0xb89b3a8ab78b3b0e,0xba0f393ab95f39ed,0xb8b53a78b7b73b02,0xba2b3918b97b39d4,0xb8ce3a65b7e33af6,0xba4738f6b99639ba,0xb8e73a52b8073ae9,0xba6238d3b9b1399f
.quad 0xb9003a3fb81d3add,0xba7c38b0b9cb3984,0xb9183a2bb8323ad0,0xba95388cb9e53969,0xb9303a17b8483ac2,0xbaae3867b9fe394d,0xb9483a02b85d3ab5,0xbac63842ba173930
.quad 0xba2f3913b9a839a8,0xbb0e378bbaa73872,0xba5238e7b9cb3984,0xbb2e3710bac9383d,0xba7438bab9ed395f,0xbb4b3693bae93807,0xba95388cba0f393a,0xbb673614bb0837a1
.quad 0xbab5385dba2f3913,0xbb803593bb253732,0xbad3382dba4f38ec,0xbb973511bb4136c1,0xbaf037f9ba6d38c4,0xbbab348dbb5a364e,0xbb0b3796ba8a389b,0xbbbe3408bb7235da
.quad 0xbb253732baa73872,0xbbce3303bb883564,0xbb3e36ccbac23848,0xbbdc31f4bb9d34ed,0xbb553665badd381d,0xbbe830e4bbaf3475,0xbb6b35fdbaf637e3,0xbbf12fa4bbc033f7
.quad 0xbb803593bb0e378b,0xbbf82d7ebbce3303,0xbb933529bb253732,0xbbfd2aacbbdb320d,0xbba434bdbb3b36d7,0xbc0024b6bbe63115,0xbbb43451bb50367c,0xbc00a3dbbbef301d
.quad 0xbba834a5bb64361f,0xbbf62e46bbd9323e,0xbbbe3408bb803593,0xbbfd2aacbbe830e4,0xbbd132d2bb993505,0xbc001e48bbf42f0e,0xbbe13191bbaf3475,0xbbfea91bbbfb2c51
.quad 0xbbed304ebbc333c6,0xbbf8ad7ebbff2648,0xbbf72e14bbd432a1,0xbbeeb036bc00a4b6,0xbbfd2b11bbe23179,0xbbe0b1aabbfcabd9,0xbc0023dbbbed304e,0xbbcdb31bbbf5aeaa
.quad 0xbbffa648bbf62e46,0xbbb6b444bbeab0b2,0xbbfcac1fbbfc2bd9,0xbb9bb4f9bbdbb20d,0xbbf5aeaabbff2648,0xbb7bb5abbbc9b365,0xbbebb099bc00a248,0xbb58b659bbb2b45d
.quad 0xbbddb1dbbbfeaa48,0xbb30b705bb99b505,0xbbcdb31bbbf8ad7e,0xbb05b7acbb7bb5ab,0xbbb9b42cbbf1afd6,0xbad6b828bb5ab64e,0xbba2b4c9bbe6b115,0xbaa3b877bb36b6ee
.quad 0xbbf6ae46bc000000,0xbba8b4a5bbd9b23e,0xbbe9b0cbbbfeaa48,0xbb82b587bbc0b3f7,0xbbd6b26fbbf6ae46,0xbb55b665bba0b4d5,0xbbbeb408bbeab0b2,0xbb22b73dbb7bb5ab
.quad 0xbba0b4d5bbd9b23e,0xbae9b807bb50b67c,0xbb7db59fbbc3b3c6,0xbaaab86dbb20b748,0xbb55b665bba8b4a5,0xba65b8cebae9b807,0xbb28b726bb88b564,0xba1bb92bbaaeb867
.quad 0xbaf6b7e3bb64b61f,0xb9cbb984ba6db8c4,0xbabfb84dbb3bb6d7,0xb976b9d8ba27b91d,0xba83b8a6bb0eb78b,0xb91dba27b9dcb972,0xba43b8fbbaddb81d,0xb8bfba71b98db9c3
.quad 0xb9feb94dbaa7b872,0xb85dbab5b93aba0f,0xb9b5b99bba6db8c4,0xb7eebaf3b8e2ba56,0xb969b9e5ba2fb913,0xb71bbb2bb887ba99,0xb918ba2bb9edb95f,0xb642bb5db828bad6
.quad 0xbb0eb78bbb64b61f,0xba2fb913baa7b872,0xbaccb838bb30b705,0xb9d0b980ba56b8e2,0xba83b8a6baf6b7e3,0xb969b9e5b9feb94d,0xba33b90ebab5b85d,0xb8fbba43b99fb9b1
.quad 0xb9dcb972ba6db8c4,0xb887ba99b93aba0f,0xb980b9d0ba1fb927,0xb80dbae6b8ceba65,0xb91dba27b9cbb984,0xb71bbb2bb85dbab5,0xb8b5ba78b972b9dc,0xb614bb67b7cdbafc
.quad 0xb848bac2b913ba2f,0xb505bb99b6d7bb3b,0xb7acbb05b8b0ba7c,0xb3dfbbc1b5dabb72,0xb6c1bb41b848bac2,0xb1aabbe0b4d5bba0,0xb5cebb74b7b7bb02,0xaedcbbf4b396bbc6
.quad 0xb4d5bba0b6d7bb3b,0xa8b6bbffb179bbe2,0xb3aebbc4b5f1bb6e,0x2852bbffaeaabbf5,0xb1aabbe0b505bb99,0x2eaabbf5a8b6bbff,0xaf40bbf3b414bbbc,0x3191bbe127dabbff
.quad 0xb913ba2fb9a8b9a8,0xb78bbb0eb872baa7,0xb896ba8eb93aba0f,0xb659bb58b7cdbafc,0xb812bae3b8c4ba6d,0xb51dbb95b6aabb46,0xb710bb2eb848bac2,0xb3aebbc4b57cbb84
.quad 0xb5f1bb6eb78bbb0e,0xb115bbe6b444bbb6,0xb4c9bba2b67cbb50,0xace7bbfab20dbbdb,0xb334bbcbb564bb88,0x1e48bc00af0ebbf4,0xb0cbbbe9b444bbb6,0x2db0bbf8a7dabbff
.quad 0xacb5bbfab23ebbd9,0x3179bbe22a48bbfe,0x1a48bc00afd6bbf1,0x3408bbbe301dbbef,0x2d1abbf9aa48bbfe,0x354cbb8c32a1bbd4,0x30fdbbe72648bbff,0x3687bb4e348dbbab
.quad 0x3365bbc92e46bbf6,0x37b7bb0235c2bb77,0x34e1bb9e3179bbe2,0x386dbaaa36eebb36,0x3608bb6933c6bbc3,0x38f6ba473807bae9,0x3726bb283505bb99,0x3976b9d83891ba92
.quad 0xb4a5bba8b61fbb64,0xae46bbf6b23ebbd9,0xb288bbd5b4d5bba0,0x9a48bc00aeaabbf5,0xaf72bbf2b303bbce,0x2de2bbf7a248bc00,0xa711bbffb04ebbed,0x31f4bbdc2d1abbf9
.quad 0x2bd9bbfcaa48bbfe,0x3475bbaf3179bbe2,0x30cbbbe928b6bbff,0x35e5bb70342cbbb9,0x3396bbc62fd6bbf1,0x3748bb203593bb80,0x3529bb9332a1bbd4,0x384dbabf36eebb36
.quad 0x367cbb5034a5bba8,0x38ecba4f381dbadd,0x37c2baff35f1bb6e,0x3980b9d038baba74,0x387cbaa03732bb25,0x3a07b943394db9fe,0x390eba333832bad0,0x3a7fb8ab39d4b97b
.quad 0x3996b9ba38c4ba6d,0x3ae9b8073a4fb8ec,0x3a13b935394db9fe,0x3b43b6b53abcb852,0x3a83b8a639cbb984,0x3b8cb54c3b1ab75e,0x3ae6b80d3a3fb900,0x3bc4b3ae3b69b608
.quad 0xb0b23bea00003c00,0xb6d73b3bb4a53ba8,0xb0cb3be900003c00,0xb6f93b33b4bd3ba4,0xb0e43be800003c00,0xb71b3b2bb4d53ba0,0xb0fd3be700003c00,0xb73d3b22b4ed3b9d
.quad 0xb1153be600003c00,0xb75e3b1ab5053b99,0xb12e3be500003c00,0xb7803b11b51d3b95,0xb1473be400003c00,0xb7a13b08b5343b91,0xb1603be300003c00,0xb7c23affb54c3b8c
.quad 0xb1793be200003c00,0xb7e33af6b5643b88,0xb1913be100003c00,0xb8023aedb57c3b84,0xb1aa3be000003c00,0xb8123ae3b5933b80,0xb1c33bdf00003c00,0xb8223ad9b5ab3b7b
.quad 0xb1db3bdd00003c00,0xb8323ad0b5c23b77,0xb1f43bdc00003c00,0xb8423ac6b5da3b72,0xb20d3bdb00003c00,0xb8523abcb5f13b6e,0xb2263bda00003c00,0xb8623ab1b6083b69
.quad 0xb95f39edb8723aa7,0xbadd381dba2f3913,0xb97639d8b8873a99,0xbaf337eeba4738f6,0xb98d39c3b89b3a8a,0xbb0837a1ba5e38d8,0xb9a439adb8b03a7c,0xbb1d3753ba7438ba
.quad 0xb9ba3996b8c43a6d,0xbb303705ba8a389b,0xb9d03980b8d83a5e,0xbb4336b5baa0387c,0xb9e53969b8ec3a4f,0xbb553665bab5385d,0xb9fa3951b9003a3f,0xbb673614bac9383d
.quad 0xba0f393ab9133a2f,0xbb7735c2badd381d,0xba233922b9273a1f,0xbb863570baf037f9,0xba373909b93a3a0f,0xbb95351dbb0237b7,0xba4b38f1b94d39fe,0xbba234c9bb143775
.quad 0xba5e38d8b95f39ed,0xbbaf3475bb253732,0xba7138bfb97239dc,0xbbbb3420bb3636ee,0xba8338a6b98439cb,0xbbc63396bb4636aa,0xba95388cb99639ba,0xbbd032eabb553665
.quad 0xbbc333c6bb64361f,0xbbfeaa48bbf62e46,0xbbd032eabb7735c2,0xbbf9ad4cbbfb2c51,0xbbdb320dbb883564,0xbbf2af72bbff28b6,0xbbe5312ebb993505,0xbbe9b0cbbc001e48
.quad 0xbbed304ebba834a5,0xbbddb1dbbbffa648,0xbbf42edcbbb63444,0xbbd0b2eabbfdab11,0xbbf92d1abbc333c6,0xbbc0b3f7bbf8ad7e,0xbbfd2aacbbce3303,0xbbadb481bbf2af72
.quad 0xbbff2648bbd9323e,0xbb99b505bbeab0b2,0xbc009a48bbe23179,0xbb82b587bbe0b1aa,0xbbffa7dabbea30b2,0xbb69b608bbd4b2a1,0xbbfdab75bbf12fd6,0xbb4eb687bbc6b396
.quad 0xbbf8ad7ebbf62e46,0xbb30b705bbb6b444,0xbbf3af40bbfa2cb5,0xbb11b780bba4b4bd,0xbbecb080bbfe2a48,0xbaf0b7f9bb91b534,0xbbe3b160bbff2648,0xbaccb838bb7bb5ab
.quad 0xbb88b564bbd9b23e,0xba6db8c4bb0eb78b,0xbb6bb5fdbbc9b365,0xba33b90ebae3b812,0xbb4bb693bbb6b444,0xb9f6b956bab5b85d,0xbb28b726bba0b4d5,0xb9b5b99bba83b8a6
.quad 0xbb02b7b7bb88b564,0xb972b9dcba4fb8ec,0xbad9b822bb6eb5f1,0xb92bba1bba17b930,0xbaaeb867bb50b67c,0xb8e2ba56b9dcb972,0xba7fb8abbb30b705,0xb896ba8eb99fb9b1
.quad 0xba4fb8ecbb0eb78b,0xb848bac2b95fb9ed,0xba1bb92bbae9b807,0xb7eebaf3b91dba27,0xb9e5b969bac2b848,0xb748bb20b8d8ba5e,0xb9adb9a4ba99b887,0xb69ebb49b891ba92
.quad 0xb972b9dcba6db8c4,0xb5f1bb6eb848bac2,0xb935ba13ba3fb900,0xb540bb8fb7f9baf0,0xb8f6ba47ba0fb93a,0xb48dbbabb75ebb1a,0xb8b5ba78b9dcb972,0xb3aebbc4b6c1bb41
.quad 0xb8c4ba6db9a8b9a8,0xb564bb88b78bbb0e,0xb86dbaaab95fb9ed,0xb481bbadb6c1bb41,0xb812bae3b913ba2f,0xb334bbcbb5f1bb6e,0xb76abb17b8c4ba6d,0xb160bbe3b51dbb95
.quad 0xb6aabb46b872baa7,0xaf0ebbf4b444bbb6,0xb5e5bb70b81dbadd,0xaaacbbfdb2d2bbd1,0xb51dbb95b78bbb0e,0x1e48bc00b115bbe6,0xb451bbb4b6d7bb3b,0x2c1fbbfcaeaabbf5
.quad 0xb303bbceb61fbb64,0x2fd6bbf1aa48bbfe,0xb160bbe3b564bb88,0x31c3bbdf1e48bc00,0xaf72bbf2b4a5bba8,0x3396bbc62bd9bbfc,0xac1fbbfcb3c6bbc3,0x34b1bba62f72bbf2
.quad 0xa248bc00b23ebbd9,0x3593bb803179bbe2,0x291bbbfeb0b2bbea,0x3670bb533334bbcb,0x2de2bbf7ae46bbf6,0x3748bb203475bbaf,0x3099bbebaa48bbfe,0x380dbae6354cbb8c
.quad 0xaa48bbfeb23ebbd9,0x33c6bbc32e46bbf6,0x23dbbc00b04ebbed,0x34f9bb9b3147bbe4,0x2d1abbf9acb5bbfa,0x3608bb693365bbc9,0x3099bbeba248bc00,0x3710bb2e34bdbba4
.quad 0x32a1bbd42a48bbfe,0x3807bae935c2bb77,0x3451bbb42f0ebbf4,0x3881ba9c36c1bb41,0x354cbb8c3179bbe2,0x38f6ba4737b7bb02,0x3642bb5d3365bbc9,0x3964b9e93852babc
.quad 0x3732bb2534a5bba8,0x39cbb98438c4ba6d,0x380dbae63593bb80,0x3a2bb9183930ba17,0x387cbaa0367cbb50,0x3a83b8a63996b9ba,0x38e7ba52375ebb1a,0x3ad3b82d39f6b956
.quad 0x394db9fe381dbadd,0x3b1ab75e3a4fb8ec,0x39adb9a43887ba99,0x3b58b6593aa0b87c,0x3a07b94338ecba4f,0x3b8cb54c3ae9b807,0x3a5ab8dd394db9fe,0x3bb7b4383b2bb71b
.quad 0x381dbadd361fbb64,0x39edb95f3913ba2f,0x38a0ba873732bb25,0x3a5ab8dd398db9c3,0x391dba27381dbadd,0x3abcb85239feb94d,0x3992b9be389bba8a,0x3b11b7803a65b8ce
.quad 0x39feb94d3913ba2f,0x3b5ab64e3ac2b848,0x3a62b8d33984b9cb,0x3b97b5113b14b775,0x3abcb85239edb95f,0x3bc6b3963b5ab64e,0x3b0bb7963a4fb8ec,0x3be7b0fd3b95b51d
.quad 0x3b50b67c3aa7b872,0x3bfaacb53bc3b3c6,0x3b8ab5583af6b7e3,0x3c0020b63be4b147,0x3bb9b42c3b3bb6d7,0x3bf72de23bf8ad7e,0x3bdcb1f43b77b5c2,0x3be131913c009e48
.quad 0x3bf4af0e3ba8b4a5,0x3bbc34143bfa2cb5,0x3bffa8523bceb303,0x3b8a35583be830e4,0x3bfe297f3beab0b2,0x3b4b36933bc93365,0x3bf12fa43bfaacb5,0x3aff37c23b9d34ed
.quad 0x3b3bb6d73aa7b872,0x3beab0b23ba8b4a5,0x3b82b5873b02b7b7,0x3bfdaaac3bd6b26f,0x3bb9b42c3b50b67c,0x3bfe297f3bf4af0e,0x3be1b1913b91b534,0x3bed30673c00a4b6
.quad 0x3bf8ad7e3bc3b3c6,0x3bc933653bfa2cb5,0x3c001a483be6b115,0x3b9335293be43147,0x3bf72de23bfaacb5,0x3b4b36933bbc3414,0x3bdf31c33c002248,0x3af337ee3b84357c
.quad 0x3bb634443bf62e46,0x3a8a389b3b3b36d7,0x3b7d359f3bdd31db,0x3a1339353ae33812,0x3b3636ee3bb63444,0x398d39c33a7c38b0,0x3ae038173b803593,0x38fb3a433a073943
.quad 0x3a7c38b03b3b36d7,0x385d3ab5398439cb,0x3a0b393e3ae93807,0x376a3b1738f63a47,0x398d39c33a8a389b,0x36083b69385d3ab5,0x39053a3b3a1f3927,0x34993baa37753b14
.quad 0x43e00000,0x0,0x0,0x0,0x0,0x0,0x0,0x0
.quad 0x0,0x0,0x0,0x0,0x0,0x0,0x0,0x0
.quad 0x0,0x0,0x0,0x0,0x0,0x0,0x0,0x0
.quad 0x0,0x0,0x0,0x0,0x0,0x0,0x0,0x0
.quad 0x0,0x0,0x0,0x0,0x0,0x0,0x0,0x0
.quad 0x0,0x0,0x0,0x0,0x0,0x0,0x0,0x0
.quad 0x0,0x0,0x0,0x0,0x0,0x0,0x0,0x0
.quad 0x0,0x0,0x0,0x0,0x0,0x0,0x0,0x0
.quad 0x0,0x0,0x0,0x0,0x0,0x0,0x0,0x0
.quad 0x0,0x0,0x0,0x0,0x0,0x0,0x0,0x0
.quad 0x0,0x0,0x0,0x0,0x0,0x0,0x0,0x0
.quad 0x0,0x0,0x0,0x0,0x0,0x0,0x0,0x0
.quad 0x0,0x0,0x0,0x0,0x0,0x0,0x0,0x0
.quad 0x0,0x0,0x0,0x0,0x0,0x0,0x0,0x0
.quad 0x0,0x0,0x0,0x0,0x0,0x0,0x0,0x0
.quad 0x0,0x0,0x0,0x0,0x0,0x0,0x0,0x0
.quad 0x0,0x0,0x0,0x0,0x0,0x0,0x0,0x0
.quad 0x0,0x0,0x0,0x0,0x0,0x0,0x0,0x0
.quad 0x0,0x0,0x0,0x0,0x0,0x0,0x0,0x0
.quad 0x0,0x0,0x0,0x0,0x0,0x0,0x0,0x0
.quad 0x0,0x0,0x0,0x0,0x0,0x0,0x0,0x0
.quad 0x0,0x0,0x0,0x0,0x0,0x0,0x0,0x0
.quad 0x0,0x0,0x0,0x0,0x0,0x0,0x0,0x0
.quad 0x0,0x0,0x0,0x0,0x0,0x0,0x0,0x0
.quad 0x0,0x0,0x0,0x0,0x0,0x0,0x0,0x0
.quad 0x0,0x0,0x0,0x0,0x0,0x0,0x0,0x0
.quad 0x0,0x0,0x0,0x0,0x0,0x0,0x0,0x0
.quad 0x0,0x0,0x0,0x0,0x0,0x0,0x0,0x0
```
